```python
import torch

def _softmax(x, axis=-1):
    return torch.softmax(x, dim=axis)

def _gelu(x):
    return torch.nn.functional.gelu(x, approximate='tanh')

def _silu(x):
    return torch.nn.functional.silu(x)

def _sigmoid(x):
    return torch.sigmoid(x)

def _layernorm(x, axis=-1, eps=1e-05):
    m = x.mean(dim=axis, keepdim=True)
    v = x.var(dim=axis, keepdim=True, unbiased=False)
    return (x - m) / torch.sqrt(v + eps)

def _scatter_add(tgt, idx, src, axis=0):
    return tgt.clone().index_add_(axis, idx, src)

def _segment_sum(src, seg, n):
    out = torch.zeros((n,) + src.shape[1:], dtype=src.dtype)
    return out.index_add_(0, seg, src)

def _pad(x, pw):
    flat = tuple((v for pair in reversed(pw) for v in pair))
    return torch.nn.functional.pad(x, flat)
kernel_name = 'gated_mix__grouped_kv_mqa__memory_aug_recurrent_mem_tr__prompt'

def setup_inputs():

    _w = lambda a: (lambda t: t.to(torch.bfloat16) if t.is_floating_point() else t)(torch.as_tensor(a))

    def _A_setup():
        B, S, D, H = (1, 2048, 640, 32)
        Dh = D // H
        return {'x': _w((lambda *s: torch.randn(*s, dtype=torch.bfloat16) * 0.05)(B, S, D)), 'wq': _w((lambda *s: torch.randn(*s, dtype=torch.bfloat16) * 0.8)(D, H * Dh)), 'wk': _w((lambda *s: torch.randn(*s, dtype=torch.bfloat16) * 0.8)(D, Dh)), 'wv': _w((lambda *s: torch.randn(*s, dtype=torch.bfloat16) * 0.05)(D, Dh)), 'wo': _w((lambda *s: torch.randn(*s, dtype=torch.bfloat16) * 0.05)(H * Dh, D))}
    _A_in = _A_setup()

    def _B_setup():
        B, S, Dm = (1, 2048, 640)
        H, Dh = (32, 128)
        M, seg = (8, 32)
        seg = min(seg, S)
        S = S // seg * seg
        return {'x': _w((lambda *s: torch.randn(*s, dtype=torch.bfloat16) * 0.05)(B, S, Dm)), 'mem0': _w((lambda *s: torch.randn(*s, dtype=torch.bfloat16) * 0.4)(B, M, Dm)), 'Wq': _w((lambda *s: torch.randn(*s, dtype=torch.bfloat16) * 6.4)(Dm, H, Dh) * Dm ** (-0.5)), 'Wk': _w((lambda *s: torch.randn(*s, dtype=torch.bfloat16) * 6.4)(Dm, H, Dh) * Dm ** (-0.5)), 'Wv': _w((lambda *s: torch.randn(*s, dtype=torch.bfloat16) * 0.4)(Dm, H, Dh) * Dm ** (-0.5)), 'Wo': _w((lambda *s: torch.randn(*s, dtype=torch.bfloat16) * 0.4)(H, Dh, Dm) * (H * Dh) ** (-0.5)), 'seg_len': seg}
    _B_in = _B_setup()
    return {'A_x': _A_in['x'], 'A_wq': _A_in['wq'], 'A_wk': _A_in['wk'], 'A_wv': _A_in['wv'], 'A_wo': _A_in['wo'], 'B_x': _B_in['x'], 'B_mem0': _B_in['mem0'], 'B_Wq': _B_in['Wq'], 'B_Wk': _B_in['Wk'], 'B_Wv': _B_in['Wv'], 'B_Wo': _B_in['Wo'], 'B_seg_len': _B_in['seg_len'], 'gate_w': _w((lambda *s: torch.randn(*s, dtype=torch.bfloat16) * 0.05)(640) * 16.0)}

def reference(A_x, A_wq, A_wk, A_wv, A_wo, B_x, B_mem0, B_Wq, B_Wk, B_Wv, B_Wo, B_seg_len, gate_w):

    def _A_ref(x, wq, wk, wv, wo):
        B, S, D = x.shape
        H = 32
        Dh = D // H
        q = (lambda x, *d: x.permute(*d))((x @ wq).reshape(B, S, H, Dh), 0, 2, 1, 3)
        k = x @ wk
        v = x @ wv
        scores = torch.einsum('bhqd,bkd->bhqk', q, k) * Dh ** (-0.5)
        p = _softmax(scores, axis=-1)
        o = torch.einsum('bhqk,bkd->bhqd', p, v)
        return (lambda x, *d: x.permute(*d))(o, 0, 2, 1, 3).reshape(B, S, H * Dh) @ wo

    def _B_ref(x, mem0, Wq, Wk, Wv, Wo, seg_len):
        B, S, Dm = x.shape
        H, Dh = (Wq.shape[1], Wq.shape[2])
        M = mem0.shape[1]
        scale = Dh ** (-0.5)
        n_seg = S // seg_len
        L = M + seg_len
        idx = torch.arange(L)
        mask = (idx[:, None] < M) | (idx[:, None] >= idx[None, :])
        mem = mem0
        outs = []
        for s in range(n_seg):
            xs = x[:, s * seg_len:(s + 1) * seg_len, :].clone()
            h = torch.concatenate([mem, xs], axis=1)
            q = torch.einsum('btd,dhe->bhte', h, Wq)
            k = torch.einsum('btd,dhe->bhte', h, Wk)
            v = torch.einsum('btd,dhe->bhte', h, Wv)
            scores = torch.einsum('bhqe,bhke->bhqk', q, k) * scale
            scores = torch.where(mask[None, None], scores, -1000000000.0)
            p = _softmax(scores, axis=-1)
            o = torch.einsum('bhqk,bhke->bhqe', p, v)
            o = torch.einsum('bhte,hed->btd', o, Wo)
            mem = o[:, :M, :].clone()
            outs.append(o[:, M:, :])
        return torch.concatenate(outs, axis=1)
    x = A_x
    g = _sigmoid((x * gate_w).sum(-1, keepdims=True))
    a = _A_ref(x, A_wq, A_wk, A_wv, A_wo)
    b = _B_ref(x, B_mem0, B_Wq, B_Wk, B_Wv, B_Wo, B_seg_len)
    return g * a + (1 - g) * b
```

```asm
; @launch grid=(256,1,1) block=(256,1,1) lds=163840
.amdgcn_target "amdgcn-amd-amdhsa--gfx950"
.text
.globl gated_mix__grouped_kv_mqa__memory_aug_recurrent_mem_tr__prompt_kernel
.p2align 8
.type gated_mix__grouped_kv_mqa__memory_aug_recurrent_mem_tr__prompt_kernel,@function
gated_mix__grouped_kv_mqa__memory_aug_recurrent_mem_tr__prompt_kernel:
  s_cmp_ge_u32 s2, 256
  s_cbranch_scc1 L_exit
  s_load_dwordx16 s[64:79], s[0:1], 0
  s_load_dwordx16 s[80:95], s[0:1], 64
  s_getreg_b32 s3, hwreg(HW_REG_XCC_ID, 0, 4)
  v_lshrrev_b32 v1, 6, v0
  v_and_b32 v0, 63, v0
  v_readfirstlane_b32 s28, v1
  s_mov_b32 s30, 0x40000
  v_lshlrev_b32 v1, 4, v0
  s_waitcnt lgkmcnt(0)
  s_mov_b32 s4, s94
  s_mov_b32 s5, s95
  s_mov_b32 s6, 268435456
  s_mov_b32 s7, 0x20000
  s_mov_b32 s8, s64
  s_mov_b32 s9, s65
  s_mov_b32 s10, 2621440
  s_mov_b32 s11, 0x20000
  s_mov_b32 s20, s92
  s_mov_b32 s21, s93
  s_mov_b32 s22, 256
  s_mov_b32 s23, 0x20000
  s_cmp_eq_u32 s3, 0
  s_cselect_b32 s31, 0x401, 1
  s_cmp_eq_u32 s3, 1
  s_cselect_b32 s31, 0x100001, s31
  v_mov_b32 v2, s31
  v_mov_b32 v3, 0
  s_cmp_lg_u32 s28, 0
  s_cbranch_scc1 L_p1
  s_mov_b64 exec, 1
  buffer_atomic_add v2, off, s[20:23], 0 sc0 sc1
  s_waitcnt vmcnt(0)
  ds_write_b32 v3, v2
  s_waitcnt lgkmcnt(0)
  s_mov_b64 exec, -1
L_p1:
  s_barrier
  ds_read_b32 v2, v3
  s_waitcnt lgkmcnt(0)
  v_readfirstlane_b32 s32, v2
  s_barrier
  s_and_b32 s33, s32, 1023
  s_bfe_u32 s34, s32, 0xa000a
  s_bfe_u32 s35, s32, 0xa0014
  s_cmp_lg_u32 s33, 0
  s_cbranch_scc1 L_p2
  v_mov_b32 v4, 0
  v_mov_b32 v5, 0
  v_mov_b32 v6, 0
  v_mov_b32 v7, 0
  s_lshl_b32 s31, s28, 12
  buffer_store_dwordx4 v[4:7], v1, s[4:7], s31 offen offset:0 sc1
  buffer_store_dwordx4 v[4:7], v1, s[4:7], s31 offen offset:1024 sc1
  buffer_store_dwordx4 v[4:7], v1, s[4:7], s31 offen offset:2048 sc1
  buffer_store_dwordx4 v[4:7], v1, s[4:7], s31 offen offset:3072 sc1
  s_waitcnt vmcnt(0)
  v_mov_b32 v2, 1
  s_mov_b64 exec, 1
  buffer_atomic_add v2, off, s[20:23], 0 offset:128 sc1
  s_mov_b64 exec, -1
L_p2:
  s_cmp_eq_u32 s3, 0
  s_cselect_b32 s36, s34, 99
  s_cmp_eq_u32 s3, 1
  s_cselect_b32 s36, s35, s36
  s_cmp_lt_u32 s36, 32
  s_cbranch_scc1 L_rec
  s_min_u32 s34, s34, 32
  s_min_u32 s35, s35, 32
  s_sub_u32 s29, s33, s34
  s_sub_u32 s29, s29, s35
  s_cmp_lt_u32 s29, 192
  s_cbranch_scc1 L_bulk
wd_1:
  buffer_load_dword v2, off, s[20:23], 0 offset:0 sc1
  s_waitcnt vmcnt(0)
  v_readfirstlane_b32 s32, v2
  s_and_b32 s33, s32, 1023
  s_cmp_ge_u32 s33, 256
  s_cbranch_scc1 wd_2
  s_sleep 2
  s_sub_u32 s30, s30, 1
  s_cbranch_scc0 wd_1
  s_mov_b32 s30, 0
wd_2:
  s_bfe_u32 s34, s32, 0xa000a
  s_bfe_u32 s35, s32, 0xa0014
  s_min_u32 s34, s34, 32
  s_min_u32 s35, s35, 32
  s_sub_u32 s36, s29, 192
  s_add_u32 s36, s36, s34
  s_mov_b32 s3, 0
  s_cmp_lt_u32 s36, 32
  s_cbranch_scc1 L_rec
  s_mov_b32 s3, 1
  s_sub_u32 s36, s36, 32
  s_add_u32 s36, s36, s35
  s_and_b32 s36, s36, 31
  s_branch L_rec
L_rec:
  s_lshl_b32 s97, s3, 5
  s_add_u32 s97, s97, s36
  s_add_u32 s97, s97, 192
  s_lshl_b32 s97, s97, 2
  s_add_u32 s97, s97, s28
  s_lshl_b32 s97, s97, 8
  s_add_u32 s97, s97, 65536
  v_mov_b32 v24, v0
  v_and_b32 v25, 15, v0
  v_lshrrev_b32 v26, 4, v0
  v_lshlrev_b32 v27, 13, v26
  v_and_b32 v31, 3, v0
  v_lshl_add_u32 v27, v25, 4, v27
  s_mul_i32 s33, s28, 36864
  s_lshl_b32 s34, s36, 8
  s_lshl_b32 s31, s28, 17
  s_add_u32 s34, s34, s31
  s_mul_i32 s31, s3, 2621440
  s_sub_u32 s35, 2621440, s31
  s_add_u32 s35, s35, s34
  s_add_u32 s34, s34, s31
  s_mul_i32 s62, s36, 163840
  s_mul_i32 s31, s3, 640
  s_add_u32 s62, s62, s31
  s_mul_i32 s31, s28, 160
  s_add_u32 s62, s62, s31
  s_mov_b32 s12, s78
  s_mov_b32 s13, s79
  s_mov_b32 s14, 5242880
  s_mov_b32 s15, 0x20000
  s_mov_b32 s16, s84
  s_mov_b32 s17, s85
  s_mov_b32 s18, 5242880
  s_mov_b32 s19, 0x20000
  s_add_u32 m0, s33, 0
  s_add_u32 s31, s34, 0
  buffer_load_dwordx4 v27, s[12:15], s31 offen lds
  s_add_u32 m0, s33, 1024
  s_add_u32 s31, s34, 32768
  buffer_load_dwordx4 v27, s[12:15], s31 offen lds
  s_add_u32 m0, s33, 2048
  s_add_u32 s31, s34, 65536
  buffer_load_dwordx4 v27, s[12:15], s31 offen lds
  s_add_u32 m0, s33, 3072
  s_add_u32 s31, s34, 98304
  buffer_load_dwordx4 v27, s[12:15], s31 offen lds
  s_add_u32 m0, s33, 4096
  s_add_u32 s31, s34, 524288
  buffer_load_dwordx4 v27, s[12:15], s31 offen lds
  s_add_u32 m0, s33, 5120
  s_add_u32 s31, s34, 557056
  buffer_load_dwordx4 v27, s[12:15], s31 offen lds
  s_add_u32 m0, s33, 6144
  s_add_u32 s31, s34, 589824
  buffer_load_dwordx4 v27, s[12:15], s31 offen lds
  s_add_u32 m0, s33, 7168
  s_add_u32 s31, s34, 622592
  buffer_load_dwordx4 v27, s[12:15], s31 offen lds
  s_add_u32 m0, s33, 8192
  s_add_u32 s31, s34, 1048576
  buffer_load_dwordx4 v27, s[12:15], s31 offen lds
  s_add_u32 m0, s33, 9216
  s_add_u32 s31, s34, 1081344
  buffer_load_dwordx4 v27, s[12:15], s31 offen lds
  s_add_u32 m0, s33, 10240
  s_add_u32 s31, s34, 1114112
  buffer_load_dwordx4 v27, s[12:15], s31 offen lds
  s_add_u32 m0, s33, 11264
  s_add_u32 s31, s34, 1146880
  buffer_load_dwordx4 v27, s[12:15], s31 offen lds
  s_add_u32 m0, s33, 12288
  s_add_u32 s31, s34, 1572864
  buffer_load_dwordx4 v27, s[12:15], s31 offen lds
  s_add_u32 m0, s33, 13312
  s_add_u32 s31, s34, 1605632
  buffer_load_dwordx4 v27, s[12:15], s31 offen lds
  s_add_u32 m0, s33, 14336
  s_add_u32 s31, s34, 1638400
  buffer_load_dwordx4 v27, s[12:15], s31 offen lds
  s_add_u32 m0, s33, 15360
  s_add_u32 s31, s34, 1671168
  buffer_load_dwordx4 v27, s[12:15], s31 offen lds
  s_add_u32 m0, s33, 16384
  s_add_u32 s31, s34, 2097152
  buffer_load_dwordx4 v27, s[12:15], s31 offen lds
  s_add_u32 m0, s33, 17408
  s_add_u32 s31, s34, 2129920
  buffer_load_dwordx4 v27, s[12:15], s31 offen lds
  s_add_u32 m0, s33, 18432
  s_add_u32 s31, s34, 2162688
  buffer_load_dwordx4 v27, s[12:15], s31 offen lds
  s_add_u32 m0, s33, 19456
  s_add_u32 s31, s34, 2195456
  buffer_load_dwordx4 v27, s[12:15], s31 offen lds
  s_add_u32 m0, s33, 20480
  s_add_u32 s31, s35, 0
  buffer_load_dwordx4 v27, s[12:15], s31 offen lds
  s_add_u32 m0, s33, 21504
  s_add_u32 s31, s35, 32768
  buffer_load_dwordx4 v27, s[12:15], s31 offen lds
  s_add_u32 m0, s33, 22528
  s_add_u32 s31, s35, 65536
  buffer_load_dwordx4 v27, s[12:15], s31 offen lds
  s_add_u32 m0, s33, 23552
  s_add_u32 s31, s35, 98304
  buffer_load_dwordx4 v27, s[12:15], s31 offen lds
  s_add_u32 m0, s33, 24576
  s_add_u32 s31, s35, 524288
  buffer_load_dwordx4 v27, s[12:15], s31 offen lds
  s_add_u32 m0, s33, 25600
  s_add_u32 s31, s35, 557056
  buffer_load_dwordx4 v27, s[12:15], s31 offen lds
  s_add_u32 m0, s33, 26624
  s_add_u32 s31, s35, 589824
  buffer_load_dwordx4 v27, s[12:15], s31 offen lds
  s_add_u32 m0, s33, 27648
  s_add_u32 s31, s35, 622592
  buffer_load_dwordx4 v27, s[12:15], s31 offen lds
  s_add_u32 m0, s33, 28672
  s_add_u32 s31, s35, 1048576
  buffer_load_dwordx4 v27, s[12:15], s31 offen lds
  s_add_u32 m0, s33, 29696
  s_add_u32 s31, s35, 1081344
  buffer_load_dwordx4 v27, s[12:15], s31 offen lds
  s_add_u32 m0, s33, 30720
  s_add_u32 s31, s35, 1114112
  buffer_load_dwordx4 v27, s[12:15], s31 offen lds
  s_add_u32 m0, s33, 31744
  s_add_u32 s31, s35, 1146880
  buffer_load_dwordx4 v27, s[12:15], s31 offen lds
  s_add_u32 m0, s33, 32768
  s_add_u32 s31, s35, 1572864
  buffer_load_dwordx4 v27, s[12:15], s31 offen lds
  s_add_u32 m0, s33, 33792
  s_add_u32 s31, s35, 1605632
  buffer_load_dwordx4 v27, s[12:15], s31 offen lds
  s_add_u32 m0, s33, 34816
  s_add_u32 s31, s35, 1638400
  buffer_load_dwordx4 v27, s[12:15], s31 offen lds
  s_add_u32 m0, s33, 35840
  s_add_u32 s31, s35, 1671168
  buffer_load_dwordx4 v27, s[12:15], s31 offen lds
  v_lshrrev_b32 v28, 1, v0
  v_mul_u32_u24 v28, 1280, v28
  v_and_b32 v32, 1, v0
  v_lshl_add_u32 v28, v32, 4, v28
  v_lshlrev_b32 v31, 3, v31
  v_add_u32 v31, s33, v31
  v_bfe_u32 v33, v0, 2, 1
  v_bfe_u32 v34, v0, 3, 1
  v_bfe_u32 v35, v0, 4, 1
  v_bfe_u32 v36, v0, 5, 1
  v_lshl_add_u32 v29, v34, 3, v33
  v_lshl_add_u32 v29, v35, 2, v29
  v_lshl_add_u32 v29, v29, 8, v31
  v_mul_u32_u24 v84, 36864, v36
  s_lshl_b32 s31, s28, 6
  s_sub_u32 s31, s31, s33
  v_add3_u32 v29, v29, v84, s31
  v_add_u32 v84, 73728, v29
  v_lshl_add_u32 v30, v34, 4, v33
  v_lshl_add_u32 v30, v35, 5, v30
  v_lshl_add_u32 v30, v36, 2, v30
  v_lshl_add_u32 v30, v30, 5, v31
  v_add_u32 v6, 147456, v1
  v_add_u32 v0, s33, v1
  v_lshrrev_b32 v37, 1, v25
  v_lshlrev_b32 v1, 8, v26
  v_lshl_add_u32 v1, v32, 7, v1
  v_lshl_add_u32 v1, v37, 4, v1
  v_add_u32 v1, 147456, v1
  s_lshl_b32 s31, s28, 10
  v_add_u32 v4, s31, v6
  v_lshlrev_b32 v7, 2, v24
  v_add_u32 v7, 151552, v7
  s_lshl_b32 s31, s28, 8
  v_add_u32 v5, s31, v7
  s_lshr_b32 s31, s28, 1
  s_lshl_b32 s31, s31, 10
  s_and_b32 s63, s28, 1
  s_lshl_b32 s32, s63, 3
  s_add_u32 s31, s31, s32
  s_add_u32 s31, s31, 10240
  v_add_u32 v8, s31, v6
  v_and_b32 v38, 7, v24
  v_lshlrev_b32 v10, 2, v38
  v_lshl_add_u32 v10, v26, 5, v10
  s_mov_b32 s100, 0xf0f0f0f0
  s_mov_b32 s101, 0xf0f0f0f0
  v_lshl_add_u32 v9, v34, 12, v10
  v_lshrrev_b32 v64, 1, v38
  v_lshl_add_u32 v64, v64, 1, v35
  v_lshlrev_b32 v65, 3, v32
  v_lshl_add_u32 v10, v64, 4, v65
  v_mul_u32_u24 v64, 1280, v64
  v_add_u32 v64, v64, v65
  v_lshrrev_b32 v66, 3, v24
  v_mul_u32_u24 v66, 1280, v66
  v_lshl_add_u32 v66, v38, 4, v66
  v_lshl_add_u32 v67, v35, 2, v36
  v_lshlrev_b32 v67, 9, v67
  v_lshl_add_u32 v67, v25, 3, v67
  v_add_u32 v67, s33, v67
  v_lshlrev_b32 v11, 12, v37
  v_lshl_add_u32 v11, v26, 5, v11
  v_lshl_add_u32 v11, v32, 4, v11
  v_or_b32 v65, v34, v36
  v_cmp_eq_u32 vcc, 0, v65
  v_mov_b32 v65, 0x7ff00000
  s_nop 0
  v_cndmask_b32 v10, v65, v10, vcc
  v_lshlrev_b32 v65, 7, v24
  v_add_u32 v65, 143360, v65
  s_cmp_eq_u32 s28, 2
  s_cselect_b64 vcc, -1, 0
  v_cndmask_b32 v10, v10, v65, vcc
  v_min_u32 v65, 1, v24
  v_lshlrev_b32 v65, 30, v65
  s_cmp_eq_u32 s28, 3
  s_cselect_b64 vcc, -1, 0
  v_cndmask_b32 v10, v10, v65, vcc
  v_lshl_add_u32 v12, v25, 2, 32
  s_mov_b32 s52, 0xaaaaaaaa
  s_mov_b32 s53, 0xaaaaaaaa
  v_mov_b32 v39, 0x4444
  v_mov_b32 v40, 0xeeee
  v_cndmask_b32 v15, v39, v40, s[52:53]
  v_mov_b32 v39, 0x3f80
  v_mov_b32 v40, 1.0
  v_and_b32 v41, 2, v24
  v_cmp_eq_u32 vcc, 0, v41
  s_nop 1
  v_cndmask_b32 v39, v40, v39, vcc
  v_lshrrev_b32 v41, 2, v25
  v_cmp_eq_u32 vcc, v41, v26
  s_nop 1
  v_cndmask_b32 v16, 0, v39, vcc
  v_mov_b32 v17, 0
  v_mov_b32 v18, 0
  v_mov_b32 v19, v16
  s_mov_b32 s49, 0x3e0293ee
  s_mov_b32 s51, 0x42800000
  s_mov_b32 s50, -1
  s_mov_b32 s37, 0
  v_mov_b32 v20, 0x3f803f80
  s_mov_b32 s54, 286331153
  s_mov_b32 s55, 286331153
  v_mov_b32 v44, -1
  v_mov_b32 v21, 0x3f803f80
  s_mov_b32 s56, 572662306
  s_mov_b32 s57, 572662306
  v_mov_b32 v45, -1
  v_mov_b32 v22, 0x3f803f80
  s_mov_b32 s58, 1145324612
  s_mov_b32 s59, 1145324612
  v_mov_b32 v46, -1
  v_mov_b32 v23, 0x3f803f80
  s_mov_b32 s60, 2290649224
  s_mov_b32 s61, 2290649224
  v_mov_b32 v47, -1
  s_add_u32 s31, s36, 32
  s_cmp_eq_u32 s28, 1
  s_cselect_b32 s31, s31, 99
  s_cmp_eq_u32 s28, 0
  s_cselect_b32 s38, s36, s31
  s_mul_i32 s31, s3, 327680
  s_add_u32 s39, s31, 901120
  s_lshl_b32 s32, s38, 7
  s_add_u32 s41, s31, s32
  s_add_u32 s41, s41, 1048576
  s_lshl_b32 s40, s3, 14
  s_add_u32 s29, s40, s32
  s_add_u32 s29, s29, 2097152
  s_sub_u32 s40, 1966080, s40
  s_add_u32 s31, s31, 11534336
  s_lshl_b32 s32, s38, 12
  s_add_u32 s45, s31, s32
  s_sub_u32 s45, s45, 147456
  s_mul_i32 s32, s28, 40960
  s_add_u32 s44, s31, s32
  s_lshl_b32 s32, s36, 7
  s_add_u32 s44, s44, s32
  s_mov_b32 s46, 163840
  s_mov_b32 s48, s32
  s_lshl_b32 s31, s3, 2
  s_add_u32 s31, s31, s28
  s_lshl_b32 s31, s31, 2
  s_add_u32 s47, s32, s31
  s_add_u32 s47, s47, 4096
  s_lshl_b32 s31, s36, 2
  s_add_u32 s31, s31, s28
  s_lshl_b32 s42, s31, 11
  s_add_u32 s42, s42, 50184192
  s_mul_i32 s31, s3, 9437184
  s_lshl_b32 s32, s36, 11
  s_add_u32 s32, s32, 16553984
  s_add_u32 s43, s31, s32
  s_cmp_eq_u32 s3, 0
  s_cselect_b64 s[26:27], 0, -1
wd_3:
  buffer_load_dword v42, off, s[20:23], 0 offset:0 sc1
  s_waitcnt vmcnt(0)
  v_readfirstlane_b32 s31, v42
  s_and_b32 s32, s31, 1023
  s_cmp_ge_u32 s32, 256
  s_cbranch_scc1 wd_4
  s_sleep 2
  s_sub_u32 s30, s30, 1
  s_cbranch_scc0 wd_3
  s_mov_b32 s30, 0
wd_4:
  s_bfe_u32 s32, s31, 0xa000a
  s_bfe_u32 s31, s31, 0xa0014
  s_min_u32 s63, s31, s32
  s_cmp_ge_u32 s38, 40
  s_cbranch_scc1 L_5
  v_lshrrev_b32 v42, 3, v24
  v_lshlrev_b32 v43, 15, v42
  v_lshl_add_u32 v43, v38, 4, v43
  v_mul_u32_u24 v42, 5120, v42
  v_lshl_add_u32 v42, v38, 4, v42
  s_add_u32 s31, s41, 0
  buffer_store_dwordx4 v[44:47], v42, s[4:7], s31 offen
  s_add_u32 s31, s29, 0
  buffer_store_dwordx4 v[44:47], v43, s[4:7], s31 offen sc1
  s_add_u32 s31, s29, 8192
  buffer_store_dwordx4 v[44:47], v43, s[4:7], s31 offen sc1
  s_add_u32 s31, s41, 40960
  buffer_store_dwordx4 v[44:47], v42, s[4:7], s31 offen
  s_add_u32 s31, s29, 262144
  buffer_store_dwordx4 v[44:47], v43, s[4:7], s31 offen sc1
  s_add_u32 s31, s29, 270336
  buffer_store_dwordx4 v[44:47], v43, s[4:7], s31 offen sc1
  s_add_u32 s31, s41, 81920
  buffer_store_dwordx4 v[44:47], v42, s[4:7], s31 offen
  s_add_u32 s31, s29, 524288
  buffer_store_dwordx4 v[44:47], v43, s[4:7], s31 offen sc1
  s_add_u32 s31, s29, 532480
  buffer_store_dwordx4 v[44:47], v43, s[4:7], s31 offen sc1
  s_add_u32 s31, s41, 122880
  buffer_store_dwordx4 v[44:47], v42, s[4:7], s31 offen
  s_add_u32 s31, s29, 786432
  buffer_store_dwordx4 v[44:47], v43, s[4:7], s31 offen sc1
  s_add_u32 s31, s29, 794624
  buffer_store_dwordx4 v[44:47], v43, s[4:7], s31 offen sc1
  s_add_u32 s31, s41, 163840
  buffer_store_dwordx4 v[44:47], v42, s[4:7], s31 offen
  s_add_u32 s31, s29, 1048576
  buffer_store_dwordx4 v[44:47], v43, s[4:7], s31 offen sc1
  s_add_u32 s31, s29, 1056768
  buffer_store_dwordx4 v[44:47], v43, s[4:7], s31 offen sc1
  s_add_u32 s31, s41, 204800
  buffer_store_dwordx4 v[44:47], v42, s[4:7], s31 offen
  s_add_u32 s31, s29, 1310720
  buffer_store_dwordx4 v[44:47], v43, s[4:7], s31 offen sc1
  s_add_u32 s31, s29, 1318912
  buffer_store_dwordx4 v[44:47], v43, s[4:7], s31 offen sc1
  s_add_u32 s31, s41, 245760
  buffer_store_dwordx4 v[44:47], v42, s[4:7], s31 offen
  s_add_u32 s31, s29, 1572864
  buffer_store_dwordx4 v[44:47], v43, s[4:7], s31 offen sc1
  s_add_u32 s31, s29, 1581056
  buffer_store_dwordx4 v[44:47], v43, s[4:7], s31 offen sc1
  s_add_u32 s31, s41, 286720
  buffer_store_dwordx4 v[44:47], v42, s[4:7], s31 offen
  s_add_u32 s31, s29, 1835008
  buffer_store_dwordx4 v[44:47], v43, s[4:7], s31 offen sc1
  s_add_u32 s31, s29, 1843200
  buffer_store_dwordx4 v[44:47], v43, s[4:7], s31 offen sc1
  s_add_u32 s31, s45, 163840
  s_cmp_ge_u32 s63, 32
  s_cbranch_scc1 L_6
  buffer_store_dwordx4 v[44:47], v6, s[4:7], s45 offen offset:0 sc1
  buffer_store_dwordx4 v[44:47], v6, s[4:7], s45 offen offset:1024 sc1
  buffer_store_dwordx4 v[44:47], v6, s[4:7], s45 offen offset:2048 sc1
  buffer_store_dwordx4 v[44:47], v6, s[4:7], s45 offen offset:3072 sc1
  buffer_store_dwordx4 v[44:47], v6, s[4:7], s31 offen offset:0 sc1
  buffer_store_dwordx4 v[44:47], v6, s[4:7], s31 offen offset:1024 sc1
  buffer_store_dwordx4 v[44:47], v6, s[4:7], s31 offen offset:2048 sc1
  buffer_store_dwordx4 v[44:47], v6, s[4:7], s31 offen offset:3072 sc1
  s_branch L_5
L_6:
  buffer_store_dwordx4 v[44:47], v6, s[4:7], s45 offen offset:0
  buffer_store_dwordx4 v[44:47], v6, s[4:7], s45 offen offset:1024
  buffer_store_dwordx4 v[44:47], v6, s[4:7], s45 offen offset:2048
  buffer_store_dwordx4 v[44:47], v6, s[4:7], s45 offen offset:3072
  buffer_store_dwordx4 v[44:47], v6, s[4:7], s31 offen offset:0
  buffer_store_dwordx4 v[44:47], v6, s[4:7], s31 offen offset:1024
  buffer_store_dwordx4 v[44:47], v6, s[4:7], s31 offen offset:2048
  buffer_store_dwordx4 v[44:47], v6, s[4:7], s31 offen offset:3072
L_5:
  s_waitcnt vmcnt(32)
  s_barrier
  ds_read_b64_tr_b16 a[0:1], v29 offset:0
  ds_read_b64_tr_b16 a[2:3], v29 offset:512
  ds_read_b64_tr_b16 a[4:5], v84 offset:0
  ds_read_b64_tr_b16 a[6:7], v84 offset:512
  ds_read_b64_tr_b16 a[8:9], v29 offset:32
  ds_read_b64_tr_b16 a[10:11], v29 offset:544
  ds_read_b64_tr_b16 a[12:13], v84 offset:32
  ds_read_b64_tr_b16 a[14:15], v84 offset:544
  s_waitcnt lgkmcnt(0)
  s_waitcnt vmcnt(28)
  s_barrier
  s_add_u32 m0, s33, 0
  s_add_u32 s31, s35, 2097152
  buffer_load_dwordx4 v27, s[12:15], s31 offen lds
  s_add_u32 m0, s33, 1024
  s_add_u32 s31, s35, 2129920
  buffer_load_dwordx4 v27, s[12:15], s31 offen lds
  s_add_u32 m0, s33, 2048
  s_add_u32 s31, s35, 2162688
  buffer_load_dwordx4 v27, s[12:15], s31 offen lds
  s_add_u32 m0, s33, 3072
  s_add_u32 s31, s35, 2195456
  buffer_load_dwordx4 v27, s[12:15], s31 offen lds
  ds_read_b64_tr_b16 a[16:17], v29 offset:4096
  ds_read_b64_tr_b16 a[18:19], v29 offset:4608
  ds_read_b64_tr_b16 a[20:21], v84 offset:4096
  ds_read_b64_tr_b16 a[22:23], v84 offset:4608
  ds_read_b64_tr_b16 a[24:25], v29 offset:4128
  ds_read_b64_tr_b16 a[26:27], v29 offset:4640
  ds_read_b64_tr_b16 a[28:29], v84 offset:4128
  ds_read_b64_tr_b16 a[30:31], v84 offset:4640
  s_waitcnt lgkmcnt(0)
  s_waitcnt vmcnt(28)
  s_barrier
  s_mov_b32 s12, s82
  s_mov_b32 s13, s83
  s_add_u32 m0, s33, 4096
  s_add_u32 s31, s34, 0
  buffer_load_dwordx4 v27, s[12:15], s31 offen lds
  s_add_u32 m0, s33, 5120
  s_add_u32 s31, s34, 32768
  buffer_load_dwordx4 v27, s[12:15], s31 offen lds
  s_add_u32 m0, s33, 6144
  s_add_u32 s31, s34, 65536
  buffer_load_dwordx4 v27, s[12:15], s31 offen lds
  s_add_u32 m0, s33, 7168
  s_add_u32 s31, s34, 98304
  buffer_load_dwordx4 v27, s[12:15], s31 offen lds
  ds_read_b64_tr_b16 a[32:33], v29 offset:8192
  ds_read_b64_tr_b16 a[34:35], v29 offset:8704
  ds_read_b64_tr_b16 a[36:37], v84 offset:8192
  ds_read_b64_tr_b16 a[38:39], v84 offset:8704
  ds_read_b64_tr_b16 a[40:41], v29 offset:8224
  ds_read_b64_tr_b16 a[42:43], v29 offset:8736
  ds_read_b64_tr_b16 a[44:45], v84 offset:8224
  ds_read_b64_tr_b16 a[46:47], v84 offset:8736
  s_waitcnt lgkmcnt(0)
  s_waitcnt vmcnt(28)
  s_barrier
  s_add_u32 m0, s33, 8192
  s_add_u32 s31, s34, 524288
  buffer_load_dwordx4 v27, s[12:15], s31 offen lds
  s_add_u32 m0, s33, 9216
  s_add_u32 s31, s34, 557056
  buffer_load_dwordx4 v27, s[12:15], s31 offen lds
  s_add_u32 m0, s33, 10240
  s_add_u32 s31, s34, 589824
  buffer_load_dwordx4 v27, s[12:15], s31 offen lds
  s_add_u32 m0, s33, 11264
  s_add_u32 s31, s34, 622592
  buffer_load_dwordx4 v27, s[12:15], s31 offen lds
  ds_read_b64_tr_b16 a[48:49], v29 offset:12288
  ds_read_b64_tr_b16 a[50:51], v29 offset:12800
  ds_read_b64_tr_b16 a[52:53], v84 offset:12288
  ds_read_b64_tr_b16 a[54:55], v84 offset:12800
  ds_read_b64_tr_b16 a[56:57], v29 offset:12320
  ds_read_b64_tr_b16 a[58:59], v29 offset:12832
  ds_read_b64_tr_b16 a[60:61], v84 offset:12320
  ds_read_b64_tr_b16 a[62:63], v84 offset:12832
  s_waitcnt lgkmcnt(0)
  s_waitcnt vmcnt(28)
  s_barrier
  s_add_u32 m0, s33, 12288
  s_add_u32 s31, s34, 1048576
  buffer_load_dwordx4 v27, s[12:15], s31 offen lds
  s_add_u32 m0, s33, 13312
  s_add_u32 s31, s34, 1081344
  buffer_load_dwordx4 v27, s[12:15], s31 offen lds
  s_add_u32 m0, s33, 14336
  s_add_u32 s31, s34, 1114112
  buffer_load_dwordx4 v27, s[12:15], s31 offen lds
  s_add_u32 m0, s33, 15360
  s_add_u32 s31, s34, 1146880
  buffer_load_dwordx4 v27, s[12:15], s31 offen lds
  ds_read_b64_tr_b16 a[64:65], v29 offset:16384
  ds_read_b64_tr_b16 a[66:67], v29 offset:16896
  ds_read_b64_tr_b16 a[68:69], v84 offset:16384
  ds_read_b64_tr_b16 a[70:71], v84 offset:16896
  ds_read_b64_tr_b16 a[72:73], v29 offset:16416
  ds_read_b64_tr_b16 a[74:75], v29 offset:16928
  ds_read_b64_tr_b16 a[76:77], v84 offset:16416
  ds_read_b64_tr_b16 a[78:79], v84 offset:16928
  s_waitcnt lgkmcnt(0)
  s_waitcnt vmcnt(28)
  s_barrier
  s_add_u32 m0, s33, 16384
  s_add_u32 s31, s34, 1572864
  buffer_load_dwordx4 v27, s[12:15], s31 offen lds
  s_add_u32 m0, s33, 17408
  s_add_u32 s31, s34, 1605632
  buffer_load_dwordx4 v27, s[12:15], s31 offen lds
  s_add_u32 m0, s33, 18432
  s_add_u32 s31, s34, 1638400
  buffer_load_dwordx4 v27, s[12:15], s31 offen lds
  s_add_u32 m0, s33, 19456
  s_add_u32 s31, s34, 1671168
  buffer_load_dwordx4 v27, s[12:15], s31 offen lds
  ds_read_b64_tr_b16 a[80:81], v29 offset:20480
  ds_read_b64_tr_b16 a[82:83], v29 offset:20992
  ds_read_b64_tr_b16 a[84:85], v84 offset:20480
  ds_read_b64_tr_b16 a[86:87], v84 offset:20992
  ds_read_b64_tr_b16 a[88:89], v29 offset:20512
  ds_read_b64_tr_b16 a[90:91], v29 offset:21024
  ds_read_b64_tr_b16 a[92:93], v84 offset:20512
  ds_read_b64_tr_b16 a[94:95], v84 offset:21024
  s_waitcnt lgkmcnt(0)
  s_waitcnt vmcnt(28)
  s_barrier
  s_add_u32 m0, s33, 20480
  s_add_u32 s31, s34, 2097152
  buffer_load_dwordx4 v27, s[12:15], s31 offen lds
  s_add_u32 m0, s33, 21504
  s_add_u32 s31, s34, 2129920
  buffer_load_dwordx4 v27, s[12:15], s31 offen lds
  s_add_u32 m0, s33, 22528
  s_add_u32 s31, s34, 2162688
  buffer_load_dwordx4 v27, s[12:15], s31 offen lds
  s_add_u32 m0, s33, 23552
  s_add_u32 s31, s34, 2195456
  buffer_load_dwordx4 v27, s[12:15], s31 offen lds
  ds_read_b64_tr_b16 a[96:97], v29 offset:24576
  ds_read_b64_tr_b16 a[98:99], v29 offset:25088
  ds_read_b64_tr_b16 a[100:101], v84 offset:24576
  ds_read_b64_tr_b16 a[102:103], v84 offset:25088
  ds_read_b64_tr_b16 a[104:105], v29 offset:24608
  ds_read_b64_tr_b16 a[106:107], v29 offset:25120
  ds_read_b64_tr_b16 a[108:109], v84 offset:24608
  ds_read_b64_tr_b16 a[110:111], v84 offset:25120
  s_waitcnt lgkmcnt(0)
  s_waitcnt vmcnt(28)
  s_barrier
  s_add_u32 m0, s33, 24576
  s_add_u32 s31, s35, 0
  buffer_load_dwordx4 v27, s[12:15], s31 offen lds
  s_add_u32 m0, s33, 25600
  s_add_u32 s31, s35, 32768
  buffer_load_dwordx4 v27, s[12:15], s31 offen lds
  s_add_u32 m0, s33, 26624
  s_add_u32 s31, s35, 65536
  buffer_load_dwordx4 v27, s[12:15], s31 offen lds
  s_add_u32 m0, s33, 27648
  s_add_u32 s31, s35, 98304
  buffer_load_dwordx4 v27, s[12:15], s31 offen lds
  ds_read_b64_tr_b16 a[112:113], v29 offset:28672
  ds_read_b64_tr_b16 a[114:115], v29 offset:29184
  ds_read_b64_tr_b16 a[116:117], v84 offset:28672
  ds_read_b64_tr_b16 a[118:119], v84 offset:29184
  ds_read_b64_tr_b16 a[120:121], v29 offset:28704
  ds_read_b64_tr_b16 a[122:123], v29 offset:29216
  ds_read_b64_tr_b16 a[124:125], v84 offset:28704
  ds_read_b64_tr_b16 a[126:127], v84 offset:29216
  s_waitcnt lgkmcnt(0)
  s_waitcnt vmcnt(28)
  s_barrier
  s_add_u32 m0, s33, 28672
  s_add_u32 s31, s35, 524288
  buffer_load_dwordx4 v27, s[12:15], s31 offen lds
  s_add_u32 m0, s33, 29696
  s_add_u32 s31, s35, 557056
  buffer_load_dwordx4 v27, s[12:15], s31 offen lds
  s_add_u32 m0, s33, 30720
  s_add_u32 s31, s35, 589824
  buffer_load_dwordx4 v27, s[12:15], s31 offen lds
  s_add_u32 m0, s33, 31744
  s_add_u32 s31, s35, 622592
  buffer_load_dwordx4 v27, s[12:15], s31 offen lds
  ds_read_b64_tr_b16 a[128:129], v29 offset:32768
  ds_read_b64_tr_b16 a[130:131], v29 offset:33280
  ds_read_b64_tr_b16 a[132:133], v84 offset:32768
  ds_read_b64_tr_b16 a[134:135], v84 offset:33280
  ds_read_b64_tr_b16 a[136:137], v29 offset:32800
  ds_read_b64_tr_b16 a[138:139], v29 offset:33312
  ds_read_b64_tr_b16 a[140:141], v84 offset:32800
  ds_read_b64_tr_b16 a[142:143], v84 offset:33312
  s_waitcnt lgkmcnt(0)
  s_waitcnt vmcnt(28)
  s_barrier
  s_add_u32 m0, s33, 32768
  s_add_u32 s31, s35, 1048576
  buffer_load_dwordx4 v27, s[12:15], s31 offen lds
  s_add_u32 m0, s33, 33792
  s_add_u32 s31, s35, 1081344
  buffer_load_dwordx4 v27, s[12:15], s31 offen lds
  s_add_u32 m0, s33, 34816
  s_add_u32 s31, s35, 1114112
  buffer_load_dwordx4 v27, s[12:15], s31 offen lds
  s_add_u32 m0, s33, 35840
  s_add_u32 s31, s35, 1146880
  buffer_load_dwordx4 v27, s[12:15], s31 offen lds
  ds_read_b64_tr_b16 a[144:145], v29 offset:0
  ds_read_b64_tr_b16 a[146:147], v29 offset:512
  ds_read_b64_tr_b16 a[148:149], v84 offset:0
  ds_read_b64_tr_b16 a[150:151], v84 offset:512
  ds_read_b64_tr_b16 a[152:153], v29 offset:32
  ds_read_b64_tr_b16 a[154:155], v29 offset:544
  ds_read_b64_tr_b16 a[156:157], v84 offset:32
  ds_read_b64_tr_b16 a[158:159], v84 offset:544
  s_waitcnt lgkmcnt(0)
  s_waitcnt vmcnt(28)
  s_barrier
  s_add_u32 m0, s33, 0
  s_add_u32 s31, s35, 1572864
  buffer_load_dwordx4 v27, s[12:15], s31 offen lds
  s_add_u32 m0, s33, 1024
  s_add_u32 s31, s35, 1605632
  buffer_load_dwordx4 v27, s[12:15], s31 offen lds
  s_add_u32 m0, s33, 2048
  s_add_u32 s31, s35, 1638400
  buffer_load_dwordx4 v27, s[12:15], s31 offen lds
  s_add_u32 m0, s33, 3072
  s_add_u32 s31, s35, 1671168
  buffer_load_dwordx4 v27, s[12:15], s31 offen lds
  s_cmp_ge_u32 s38, 40
  s_cbranch_scc1 L_7
  v_mov_b32 v42, 1
  s_mov_b64 exec, 1
  buffer_atomic_add v42, off, s[20:23], 0 offset:132 sc1
  s_mov_b64 exec, -1
L_7:
  ds_read_b64_tr_b16 a[160:161], v29 offset:4096
  ds_read_b64_tr_b16 a[162:163], v29 offset:4608
  ds_read_b64_tr_b16 a[164:165], v84 offset:4096
  ds_read_b64_tr_b16 a[166:167], v84 offset:4608
  ds_read_b64_tr_b16 a[168:169], v29 offset:4128
  ds_read_b64_tr_b16 a[170:171], v29 offset:4640
  ds_read_b64_tr_b16 a[172:173], v84 offset:4128
  ds_read_b64_tr_b16 a[174:175], v84 offset:4640
  s_waitcnt lgkmcnt(0)
  s_waitcnt vmcnt(28)
  s_barrier
  s_add_u32 m0, s33, 4096
  s_add_u32 s31, s35, 2097152
  buffer_load_dwordx4 v27, s[12:15], s31 offen lds
  s_add_u32 m0, s33, 5120
  s_add_u32 s31, s35, 2129920
  buffer_load_dwordx4 v27, s[12:15], s31 offen lds
  s_add_u32 m0, s33, 6144
  s_add_u32 s31, s35, 2162688
  buffer_load_dwordx4 v27, s[12:15], s31 offen lds
  s_add_u32 m0, s33, 7168
  s_add_u32 s31, s35, 2195456
  buffer_load_dwordx4 v27, s[12:15], s31 offen lds
  ds_read_b64_tr_b16 a[176:177], v29 offset:8192
  ds_read_b64_tr_b16 a[178:179], v29 offset:8704
  ds_read_b64_tr_b16 a[180:181], v84 offset:8192
  ds_read_b64_tr_b16 a[182:183], v84 offset:8704
  ds_read_b64_tr_b16 a[184:185], v29 offset:8224
  ds_read_b64_tr_b16 a[186:187], v29 offset:8736
  ds_read_b64_tr_b16 a[188:189], v84 offset:8224
  ds_read_b64_tr_b16 a[190:191], v84 offset:8736
  s_waitcnt lgkmcnt(0)
  s_waitcnt vmcnt(28)
  s_barrier
  s_mov_b32 s12, s80
  s_mov_b32 s13, s81
  s_add_u32 m0, s33, 8192
  s_add_u32 s31, s35, 0
  buffer_load_dwordx4 v27, s[12:15], s31 offen lds
  s_add_u32 m0, s33, 9216
  s_add_u32 s31, s35, 32768
  buffer_load_dwordx4 v27, s[12:15], s31 offen lds
  s_add_u32 m0, s33, 10240
  s_add_u32 s31, s35, 65536
  buffer_load_dwordx4 v27, s[12:15], s31 offen lds
  s_add_u32 m0, s33, 11264
  s_add_u32 s31, s35, 98304
  buffer_load_dwordx4 v27, s[12:15], s31 offen lds
  ds_read_b64_tr_b16 a[192:193], v29 offset:12288
  ds_read_b64_tr_b16 a[194:195], v29 offset:12800
  ds_read_b64_tr_b16 a[196:197], v84 offset:12288
  ds_read_b64_tr_b16 a[198:199], v84 offset:12800
  ds_read_b64_tr_b16 a[200:201], v29 offset:12320
  ds_read_b64_tr_b16 a[202:203], v29 offset:12832
  ds_read_b64_tr_b16 a[204:205], v84 offset:12320
  ds_read_b64_tr_b16 a[206:207], v84 offset:12832
  s_waitcnt lgkmcnt(0)
  s_waitcnt vmcnt(28)
  s_barrier
  s_add_u32 m0, s33, 12288
  s_add_u32 s31, s35, 524288
  buffer_load_dwordx4 v27, s[12:15], s31 offen lds
  s_add_u32 m0, s33, 13312
  s_add_u32 s31, s35, 557056
  buffer_load_dwordx4 v27, s[12:15], s31 offen lds
  s_add_u32 m0, s33, 14336
  s_add_u32 s31, s35, 589824
  buffer_load_dwordx4 v27, s[12:15], s31 offen lds
  s_add_u32 m0, s33, 15360
  s_add_u32 s31, s35, 622592
  buffer_load_dwordx4 v27, s[12:15], s31 offen lds
  ds_read_b64_tr_b16 a[208:209], v29 offset:16384
  ds_read_b64_tr_b16 a[210:211], v29 offset:16896
  ds_read_b64_tr_b16 a[212:213], v84 offset:16384
  ds_read_b64_tr_b16 a[214:215], v84 offset:16896
  ds_read_b64_tr_b16 a[216:217], v29 offset:16416
  ds_read_b64_tr_b16 a[218:219], v29 offset:16928
  ds_read_b64_tr_b16 a[220:221], v84 offset:16416
  ds_read_b64_tr_b16 a[222:223], v84 offset:16928
  s_waitcnt lgkmcnt(0)
  s_waitcnt vmcnt(28)
  s_barrier
  s_add_u32 m0, s33, 16384
  s_add_u32 s31, s35, 1048576
  buffer_load_dwordx4 v27, s[12:15], s31 offen lds
  s_add_u32 m0, s33, 17408
  s_add_u32 s31, s35, 1081344
  buffer_load_dwordx4 v27, s[12:15], s31 offen lds
  s_add_u32 m0, s33, 18432
  s_add_u32 s31, s35, 1114112
  buffer_load_dwordx4 v27, s[12:15], s31 offen lds
  s_add_u32 m0, s33, 19456
  s_add_u32 s31, s35, 1146880
  buffer_load_dwordx4 v27, s[12:15], s31 offen lds
  ds_read_b64_tr_b16 a[224:225], v29 offset:20480
  ds_read_b64_tr_b16 a[226:227], v29 offset:20992
  ds_read_b64_tr_b16 a[228:229], v84 offset:20480
  ds_read_b64_tr_b16 a[230:231], v84 offset:20992
  ds_read_b64_tr_b16 a[232:233], v29 offset:20512
  ds_read_b64_tr_b16 a[234:235], v29 offset:21024
  ds_read_b64_tr_b16 a[236:237], v84 offset:20512
  ds_read_b64_tr_b16 a[238:239], v84 offset:21024
  s_waitcnt lgkmcnt(0)
  s_waitcnt vmcnt(28)
  s_barrier
  s_add_u32 m0, s33, 20480
  s_add_u32 s31, s35, 1572864
  buffer_load_dwordx4 v27, s[12:15], s31 offen lds
  s_add_u32 m0, s33, 21504
  s_add_u32 s31, s35, 1605632
  buffer_load_dwordx4 v27, s[12:15], s31 offen lds
  s_add_u32 m0, s33, 22528
  s_add_u32 s31, s35, 1638400
  buffer_load_dwordx4 v27, s[12:15], s31 offen lds
  s_add_u32 m0, s33, 23552
  s_add_u32 s31, s35, 1671168
  buffer_load_dwordx4 v27, s[12:15], s31 offen lds
  ds_read_b64_tr_b16 a[240:241], v29 offset:24576
  ds_read_b64_tr_b16 a[242:243], v29 offset:25088
  ds_read_b64_tr_b16 a[244:245], v84 offset:24576
  ds_read_b64_tr_b16 a[246:247], v84 offset:25088
  ds_read_b64_tr_b16 a[248:249], v29 offset:24608
  ds_read_b64_tr_b16 a[250:251], v29 offset:25120
  ds_read_b64_tr_b16 a[252:253], v84 offset:24608
  ds_read_b64_tr_b16 a[254:255], v84 offset:25120
  s_waitcnt lgkmcnt(0)
  s_waitcnt vmcnt(28)
  s_barrier
  s_add_u32 m0, s33, 24576
  s_add_u32 s31, s35, 2097152
  buffer_load_dwordx4 v27, s[12:15], s31 offen lds
  s_add_u32 m0, s33, 25600
  s_add_u32 s31, s35, 2129920
  buffer_load_dwordx4 v27, s[12:15], s31 offen lds
  s_add_u32 m0, s33, 26624
  s_add_u32 s31, s35, 2162688
  buffer_load_dwordx4 v27, s[12:15], s31 offen lds
  s_add_u32 m0, s33, 27648
  s_add_u32 s31, s35, 2195456
  buffer_load_dwordx4 v27, s[12:15], s31 offen lds
  ds_read_b64_tr_b16 v[96:97], v29 offset:28672
  ds_read_b64_tr_b16 v[98:99], v29 offset:29184
  ds_read_b64_tr_b16 v[100:101], v84 offset:28672
  ds_read_b64_tr_b16 v[102:103], v84 offset:29184
  ds_read_b64_tr_b16 v[104:105], v29 offset:28704
  ds_read_b64_tr_b16 v[106:107], v29 offset:29216
  ds_read_b64_tr_b16 v[108:109], v84 offset:28704
  ds_read_b64_tr_b16 v[110:111], v84 offset:29216
  s_waitcnt lgkmcnt(0)
  s_waitcnt vmcnt(28)
  s_barrier
  s_add_u32 m0, s33, 28672
  s_add_u32 s31, s62, 128
  buffer_load_dwordx4 v28, s[16:19], s31 offen lds
  s_add_u32 m0, s33, 29696
  s_add_u32 s31, s62, 41088
  buffer_load_dwordx4 v28, s[16:19], s31 offen lds
  s_add_u32 m0, s33, 30720
  s_add_u32 s31, s62, 82048
  buffer_load_dwordx4 v28, s[16:19], s31 offen lds
  s_add_u32 m0, s33, 31744
  s_add_u32 s31, s62, 123008
  buffer_load_dwordx4 v28, s[16:19], s31 offen lds
  ds_read_b64_tr_b16 v[112:113], v29 offset:32768
  ds_read_b64_tr_b16 v[114:115], v29 offset:33280
  ds_read_b64_tr_b16 v[116:117], v84 offset:32768
  ds_read_b64_tr_b16 v[118:119], v84 offset:33280
  ds_read_b64_tr_b16 v[120:121], v29 offset:32800
  ds_read_b64_tr_b16 v[122:123], v29 offset:33312
  ds_read_b64_tr_b16 v[124:125], v84 offset:32800
  ds_read_b64_tr_b16 v[126:127], v84 offset:33312
  s_waitcnt lgkmcnt(0)
  s_waitcnt vmcnt(28)
  s_barrier
  s_add_u32 m0, s33, 32768
  s_add_u32 s31, s34, 0
  buffer_load_dwordx4 v27, s[12:15], s31 offen lds
  s_add_u32 m0, s33, 33792
  s_add_u32 s31, s34, 32768
  buffer_load_dwordx4 v27, s[12:15], s31 offen lds
  s_add_u32 m0, s33, 34816
  s_add_u32 s31, s34, 65536
  buffer_load_dwordx4 v27, s[12:15], s31 offen lds
  s_add_u32 m0, s33, 35840
  s_add_u32 s31, s34, 98304
  buffer_load_dwordx4 v27, s[12:15], s31 offen lds
  ds_read_b64_tr_b16 v[128:129], v29 offset:0
  ds_read_b64_tr_b16 v[130:131], v29 offset:512
  ds_read_b64_tr_b16 v[132:133], v84 offset:0
  ds_read_b64_tr_b16 v[134:135], v84 offset:512
  ds_read_b64_tr_b16 v[136:137], v29 offset:32
  ds_read_b64_tr_b16 v[138:139], v29 offset:544
  ds_read_b64_tr_b16 v[140:141], v84 offset:32
  ds_read_b64_tr_b16 v[142:143], v84 offset:544
  s_waitcnt lgkmcnt(0)
  s_waitcnt vmcnt(28)
  s_barrier
  s_add_u32 m0, s33, 0
  s_add_u32 s31, s34, 524288
  buffer_load_dwordx4 v27, s[12:15], s31 offen lds
  s_add_u32 m0, s33, 1024
  s_add_u32 s31, s34, 557056
  buffer_load_dwordx4 v27, s[12:15], s31 offen lds
  s_add_u32 m0, s33, 2048
  s_add_u32 s31, s34, 589824
  buffer_load_dwordx4 v27, s[12:15], s31 offen lds
  s_add_u32 m0, s33, 3072
  s_add_u32 s31, s34, 622592
  buffer_load_dwordx4 v27, s[12:15], s31 offen lds
  ds_read_b64_tr_b16 v[144:145], v29 offset:4096
  ds_read_b64_tr_b16 v[146:147], v29 offset:4608
  ds_read_b64_tr_b16 v[148:149], v84 offset:4096
  ds_read_b64_tr_b16 v[150:151], v84 offset:4608
  ds_read_b64_tr_b16 v[152:153], v29 offset:4128
  ds_read_b64_tr_b16 v[154:155], v29 offset:4640
  ds_read_b64_tr_b16 v[156:157], v84 offset:4128
  ds_read_b64_tr_b16 v[158:159], v84 offset:4640
  s_waitcnt lgkmcnt(0)
  s_waitcnt vmcnt(28)
  s_barrier
  s_add_u32 m0, s33, 4096
  s_add_u32 s31, s34, 1048576
  buffer_load_dwordx4 v27, s[12:15], s31 offen lds
  s_add_u32 m0, s33, 5120
  s_add_u32 s31, s34, 1081344
  buffer_load_dwordx4 v27, s[12:15], s31 offen lds
  s_add_u32 m0, s33, 6144
  s_add_u32 s31, s34, 1114112
  buffer_load_dwordx4 v27, s[12:15], s31 offen lds
  s_add_u32 m0, s33, 7168
  s_add_u32 s31, s34, 1146880
  buffer_load_dwordx4 v27, s[12:15], s31 offen lds
  ds_read_b64_tr_b16 v[160:161], v29 offset:8192
  ds_read_b64_tr_b16 v[162:163], v29 offset:8704
  ds_read_b64_tr_b16 v[164:165], v84 offset:8192
  ds_read_b64_tr_b16 v[166:167], v84 offset:8704
  ds_read_b64_tr_b16 v[168:169], v29 offset:8224
  ds_read_b64_tr_b16 v[170:171], v29 offset:8736
  ds_read_b64_tr_b16 v[172:173], v84 offset:8224
  ds_read_b64_tr_b16 v[174:175], v84 offset:8736
  s_waitcnt lgkmcnt(0)
  s_waitcnt vmcnt(28)
  s_barrier
  s_add_u32 m0, s33, 8192
  s_add_u32 s31, s34, 1572864
  buffer_load_dwordx4 v27, s[12:15], s31 offen lds
  s_add_u32 m0, s33, 9216
  s_add_u32 s31, s34, 1605632
  buffer_load_dwordx4 v27, s[12:15], s31 offen lds
  s_add_u32 m0, s33, 10240
  s_add_u32 s31, s34, 1638400
  buffer_load_dwordx4 v27, s[12:15], s31 offen lds
  s_add_u32 m0, s33, 11264
  s_add_u32 s31, s34, 1671168
  buffer_load_dwordx4 v27, s[12:15], s31 offen lds
  ds_read_b64_tr_b16 v[176:177], v29 offset:12288
  ds_read_b64_tr_b16 v[178:179], v29 offset:12800
  ds_read_b64_tr_b16 v[180:181], v84 offset:12288
  ds_read_b64_tr_b16 v[182:183], v84 offset:12800
  ds_read_b64_tr_b16 v[184:185], v29 offset:12320
  ds_read_b64_tr_b16 v[186:187], v29 offset:12832
  ds_read_b64_tr_b16 v[188:189], v84 offset:12320
  ds_read_b64_tr_b16 v[190:191], v84 offset:12832
  s_waitcnt lgkmcnt(0)
  s_waitcnt vmcnt(28)
  s_barrier
  s_add_u32 m0, s33, 12288
  s_add_u32 s31, s34, 2097152
  buffer_load_dwordx4 v27, s[12:15], s31 offen lds
  s_add_u32 m0, s33, 13312
  s_add_u32 s31, s34, 2129920
  buffer_load_dwordx4 v27, s[12:15], s31 offen lds
  s_add_u32 m0, s33, 14336
  s_add_u32 s31, s34, 2162688
  buffer_load_dwordx4 v27, s[12:15], s31 offen lds
  s_add_u32 m0, s33, 15360
  s_add_u32 s31, s34, 2195456
  buffer_load_dwordx4 v27, s[12:15], s31 offen lds
  ds_read_b64_tr_b16 v[192:193], v29 offset:16384
  ds_read_b64_tr_b16 v[194:195], v29 offset:16896
  ds_read_b64_tr_b16 v[196:197], v84 offset:16384
  ds_read_b64_tr_b16 v[198:199], v84 offset:16896
  ds_read_b64_tr_b16 v[200:201], v29 offset:16416
  ds_read_b64_tr_b16 v[202:203], v29 offset:16928
  ds_read_b64_tr_b16 v[204:205], v84 offset:16416
  ds_read_b64_tr_b16 v[206:207], v84 offset:16928
  s_waitcnt lgkmcnt(0)
  s_waitcnt vmcnt(28)
  s_barrier
  s_add_u32 m0, s33, 16384
  s_add_u32 s31, s62, 0
  buffer_load_dwordx4 v66, s[16:19], s31 offen lds
  s_add_u32 m0, s33, 17408
  s_add_u32 s31, s62, 20480
  buffer_load_dwordx4 v66, s[16:19], s31 offen lds
  s_add_u32 m0, s33, 18432
  s_add_u32 s31, s62, 40960
  buffer_load_dwordx4 v66, s[16:19], s31 offen lds
  s_add_u32 m0, s33, 19456
  s_add_u32 s31, s62, 61440
  buffer_load_dwordx4 v66, s[16:19], s31 offen lds
  ds_read_b64_tr_b16 v[208:209], v29 offset:20480
  ds_read_b64_tr_b16 v[210:211], v29 offset:20992
  ds_read_b64_tr_b16 v[212:213], v84 offset:20480
  ds_read_b64_tr_b16 v[214:215], v84 offset:20992
  ds_read_b64_tr_b16 v[216:217], v29 offset:20512
  ds_read_b64_tr_b16 v[218:219], v29 offset:21024
  ds_read_b64_tr_b16 v[220:221], v84 offset:20512
  ds_read_b64_tr_b16 v[222:223], v84 offset:21024
  s_waitcnt lgkmcnt(0)
  s_waitcnt vmcnt(28)
  s_barrier
  s_add_u32 m0, s33, 20480
  s_add_u32 s31, s62, 10240
  buffer_load_dwordx4 v66, s[16:19], s31 offen lds
  s_add_u32 m0, s33, 21504
  s_add_u32 s31, s62, 30720
  buffer_load_dwordx4 v66, s[16:19], s31 offen lds
  s_add_u32 m0, s33, 22528
  s_add_u32 s31, s62, 51200
  buffer_load_dwordx4 v66, s[16:19], s31 offen lds
  s_add_u32 m0, s33, 23552
  s_add_u32 s31, s62, 71680
  buffer_load_dwordx4 v66, s[16:19], s31 offen lds
  ds_read_b64_tr_b16 v[224:225], v29 offset:24576
  ds_read_b64_tr_b16 v[226:227], v29 offset:25088
  ds_read_b64_tr_b16 v[228:229], v84 offset:24576
  ds_read_b64_tr_b16 v[230:231], v84 offset:25088
  ds_read_b64_tr_b16 v[232:233], v29 offset:24608
  ds_read_b64_tr_b16 v[234:235], v29 offset:25120
  ds_read_b64_tr_b16 v[236:237], v84 offset:24608
  ds_read_b64_tr_b16 v[238:239], v84 offset:25120
  s_waitcnt lgkmcnt(0)
  s_waitcnt vmcnt(28)
  s_barrier
  s_add_u32 m0, s33, 24576
  s_add_u32 s31, s62, 81920
  buffer_load_dwordx4 v66, s[16:19], s31 offen lds
  s_add_u32 m0, s33, 25600
  s_add_u32 s31, s62, 102400
  buffer_load_dwordx4 v66, s[16:19], s31 offen lds
  s_add_u32 m0, s33, 26624
  s_add_u32 s31, s62, 122880
  buffer_load_dwordx4 v66, s[16:19], s31 offen lds
  s_add_u32 m0, s33, 27648
  s_add_u32 s31, s62, 143360
  buffer_load_dwordx4 v66, s[16:19], s31 offen lds
  ds_read_b64_tr_b16 v[240:241], v30 offset:28672
  ds_read_b64_tr_b16 v[242:243], v30 offset:28736
  ds_read_b64_tr_b16 v[244:245], v30 offset:28928
  ds_read_b64_tr_b16 v[246:247], v30 offset:28992
  ds_read_b64_tr_b16 v[248:249], v30 offset:30720
  ds_read_b64_tr_b16 v[250:251], v30 offset:30784
  ds_read_b64_tr_b16 v[252:253], v30 offset:30976
  ds_read_b64_tr_b16 v[254:255], v30 offset:31040
  s_waitcnt lgkmcnt(0)
  s_waitcnt vmcnt(28)
  s_barrier
  s_add_u32 m0, s33, 28672
  s_add_u32 s31, s62, 92160
  buffer_load_dwordx4 v66, s[16:19], s31 offen lds
  s_add_u32 m0, s33, 29696
  s_add_u32 s31, s62, 112640
  buffer_load_dwordx4 v66, s[16:19], s31 offen lds
  s_add_u32 m0, s33, 30720
  s_add_u32 s31, s62, 133120
  buffer_load_dwordx4 v66, s[16:19], s31 offen lds
  s_add_u32 m0, s33, 31744
  s_add_u32 s31, s62, 153600
  buffer_load_dwordx4 v66, s[16:19], s31 offen lds
  ds_read_b64_tr_b16 v[48:49], v29 offset:32768
  ds_read_b64_tr_b16 v[50:51], v29 offset:33280
  ds_read_b64_tr_b16 v[52:53], v84 offset:32768
  ds_read_b64_tr_b16 v[54:55], v84 offset:33280
  ds_read_b64_tr_b16 v[56:57], v29 offset:32800
  ds_read_b64_tr_b16 v[58:59], v29 offset:33312
  ds_read_b64_tr_b16 v[60:61], v84 offset:32800
  ds_read_b64_tr_b16 v[62:63], v84 offset:33312
  s_waitcnt lgkmcnt(0)
  s_waitcnt vmcnt(28)
  s_barrier
  ds_write_b128 v0, v[48:51] offset:32768
  ds_write_b128 v0, v[52:55] offset:33792
  ds_write_b128 v0, v[56:59] offset:34816
  ds_write_b128 v0, v[60:63] offset:35840
  s_waitcnt lgkmcnt(0)
  ds_read_b64_tr_b16 v[48:49], v29 offset:0
  ds_read_b64_tr_b16 v[50:51], v29 offset:512
  ds_read_b64_tr_b16 v[52:53], v84 offset:0
  ds_read_b64_tr_b16 v[54:55], v84 offset:512
  ds_read_b64_tr_b16 v[56:57], v29 offset:32
  ds_read_b64_tr_b16 v[58:59], v29 offset:544
  ds_read_b64_tr_b16 v[60:61], v84 offset:32
  ds_read_b64_tr_b16 v[62:63], v84 offset:544
  s_waitcnt lgkmcnt(0)
  s_waitcnt vmcnt(24)
  s_barrier
  ds_write_b128 v0, v[48:51] offset:0
  ds_write_b128 v0, v[52:55] offset:1024
  ds_write_b128 v0, v[56:59] offset:2048
  ds_write_b128 v0, v[60:63] offset:3072
  s_waitcnt lgkmcnt(0)
  ds_read_b64_tr_b16 v[48:49], v29 offset:4096
  ds_read_b64_tr_b16 v[50:51], v29 offset:4608
  ds_read_b64_tr_b16 v[52:53], v84 offset:4096
  ds_read_b64_tr_b16 v[54:55], v84 offset:4608
  ds_read_b64_tr_b16 v[56:57], v29 offset:4128
  ds_read_b64_tr_b16 v[58:59], v29 offset:4640
  ds_read_b64_tr_b16 v[60:61], v84 offset:4128
  ds_read_b64_tr_b16 v[62:63], v84 offset:4640
  s_waitcnt lgkmcnt(0)
  s_waitcnt vmcnt(20)
  s_barrier
  ds_write_b128 v0, v[48:51] offset:4096
  ds_write_b128 v0, v[52:55] offset:5120
  ds_write_b128 v0, v[56:59] offset:6144
  ds_write_b128 v0, v[60:63] offset:7168
  s_waitcnt lgkmcnt(0)
  ds_read_b64_tr_b16 v[48:49], v29 offset:8192
  ds_read_b64_tr_b16 v[50:51], v29 offset:8704
  ds_read_b64_tr_b16 v[52:53], v84 offset:8192
  ds_read_b64_tr_b16 v[54:55], v84 offset:8704
  ds_read_b64_tr_b16 v[56:57], v29 offset:8224
  ds_read_b64_tr_b16 v[58:59], v29 offset:8736
  ds_read_b64_tr_b16 v[60:61], v84 offset:8224
  ds_read_b64_tr_b16 v[62:63], v84 offset:8736
  s_waitcnt lgkmcnt(0)
  s_waitcnt vmcnt(16)
  s_barrier
  ds_write_b128 v0, v[48:51] offset:8192
  ds_write_b128 v0, v[52:55] offset:9216
  ds_write_b128 v0, v[56:59] offset:10240
  ds_write_b128 v0, v[60:63] offset:11264
  s_waitcnt lgkmcnt(0)
  ds_read_b64_tr_b16 v[48:49], v29 offset:12288
  ds_read_b64_tr_b16 v[50:51], v29 offset:12800
  ds_read_b64_tr_b16 v[52:53], v84 offset:12288
  ds_read_b64_tr_b16 v[54:55], v84 offset:12800
  ds_read_b64_tr_b16 v[56:57], v29 offset:12320
  ds_read_b64_tr_b16 v[58:59], v29 offset:12832
  ds_read_b64_tr_b16 v[60:61], v84 offset:12320
  ds_read_b64_tr_b16 v[62:63], v84 offset:12832
  s_waitcnt lgkmcnt(0)
  s_waitcnt vmcnt(12)
  s_barrier
  ds_write_b128 v0, v[48:51] offset:12288
  ds_write_b128 v0, v[52:55] offset:13312
  ds_write_b128 v0, v[56:59] offset:14336
  ds_write_b128 v0, v[60:63] offset:15360
  s_waitcnt lgkmcnt(0)
  ds_read_b64 v[68:69], v67 offset:16384
  ds_read_b64 v[70:71], v67 offset:16512
  ds_read_b64 v[72:73], v67 offset:17408
  ds_read_b64 v[74:75], v67 offset:17536
  ds_read_b64 v[76:77], v67 offset:16640
  ds_read_b64 v[78:79], v67 offset:16768
  ds_read_b64 v[80:81], v67 offset:17664
  ds_read_b64 v[82:83], v67 offset:17792
  s_mov_b32 s31, 0x05040100
  s_mov_b32 s32, 0x07060302
  s_waitcnt lgkmcnt(0)
  v_perm_b32 v48, v70, v68, s31
  v_perm_b32 v49, v74, v72, s31
  v_perm_b32 v50, v78, v76, s31
  v_perm_b32 v51, v82, v80, s31
  v_perm_b32 v52, v70, v68, s32
  v_perm_b32 v53, v74, v72, s32
  v_perm_b32 v54, v78, v76, s32
  v_perm_b32 v55, v82, v80, s32
  v_perm_b32 v56, v71, v69, s31
  v_perm_b32 v57, v75, v73, s31
  v_perm_b32 v58, v79, v77, s31
  v_perm_b32 v59, v83, v81, s31
  v_perm_b32 v60, v71, v69, s32
  v_perm_b32 v61, v75, v73, s32
  v_perm_b32 v62, v79, v77, s32
  v_perm_b32 v63, v83, v81, s32
  s_waitcnt lgkmcnt(0)
  ds_write_b128 v0, v[48:51] offset:16384
  ds_write_b128 v0, v[52:55] offset:17408
  ds_write_b128 v0, v[56:59] offset:18432
  ds_write_b128 v0, v[60:63] offset:19456
  s_waitcnt lgkmcnt(0)
  s_waitcnt vmcnt(8)
  ds_read_b64 v[68:69], v67 offset:20480
  ds_read_b64 v[70:71], v67 offset:20608
  ds_read_b64 v[72:73], v67 offset:21504
  ds_read_b64 v[74:75], v67 offset:21632
  ds_read_b64 v[76:77], v67 offset:20736
  ds_read_b64 v[78:79], v67 offset:20864
  ds_read_b64 v[80:81], v67 offset:21760
  ds_read_b64 v[82:83], v67 offset:21888
  s_mov_b32 s31, 0x05040100
  s_mov_b32 s32, 0x07060302
  s_waitcnt lgkmcnt(0)
  v_perm_b32 v48, v70, v68, s31
  v_perm_b32 v49, v74, v72, s31
  v_perm_b32 v50, v78, v76, s31
  v_perm_b32 v51, v82, v80, s31
  v_perm_b32 v52, v70, v68, s32
  v_perm_b32 v53, v74, v72, s32
  v_perm_b32 v54, v78, v76, s32
  v_perm_b32 v55, v82, v80, s32
  v_perm_b32 v56, v71, v69, s31
  v_perm_b32 v57, v75, v73, s31
  v_perm_b32 v58, v79, v77, s31
  v_perm_b32 v59, v83, v81, s31
  v_perm_b32 v60, v71, v69, s32
  v_perm_b32 v61, v75, v73, s32
  v_perm_b32 v62, v79, v77, s32
  v_perm_b32 v63, v83, v81, s32
  s_waitcnt lgkmcnt(0)
  ds_write_b128 v0, v[48:51] offset:20480
  ds_write_b128 v0, v[52:55] offset:21504
  ds_write_b128 v0, v[56:59] offset:22528
  ds_write_b128 v0, v[60:63] offset:23552
  s_waitcnt lgkmcnt(0)
  s_waitcnt vmcnt(4)
  ds_read_b64 v[68:69], v67 offset:24576
  ds_read_b64 v[70:71], v67 offset:24704
  ds_read_b64 v[72:73], v67 offset:25600
  ds_read_b64 v[74:75], v67 offset:25728
  ds_read_b64 v[76:77], v67 offset:24832
  ds_read_b64 v[78:79], v67 offset:24960
  ds_read_b64 v[80:81], v67 offset:25856
  ds_read_b64 v[82:83], v67 offset:25984
  s_mov_b32 s31, 0x05040100
  s_mov_b32 s32, 0x07060302
  s_waitcnt lgkmcnt(0)
  v_perm_b32 v48, v70, v68, s31
  v_perm_b32 v49, v74, v72, s31
  v_perm_b32 v50, v78, v76, s31
  v_perm_b32 v51, v82, v80, s31
  v_perm_b32 v52, v70, v68, s32
  v_perm_b32 v53, v74, v72, s32
  v_perm_b32 v54, v78, v76, s32
  v_perm_b32 v55, v82, v80, s32
  v_perm_b32 v56, v71, v69, s31
  v_perm_b32 v57, v75, v73, s31
  v_perm_b32 v58, v79, v77, s31
  v_perm_b32 v59, v83, v81, s31
  v_perm_b32 v60, v71, v69, s32
  v_perm_b32 v61, v75, v73, s32
  v_perm_b32 v62, v79, v77, s32
  v_perm_b32 v63, v83, v81, s32
  s_waitcnt lgkmcnt(0)
  ds_write_b128 v0, v[48:51] offset:24576
  ds_write_b128 v0, v[52:55] offset:25600
  ds_write_b128 v0, v[56:59] offset:26624
  ds_write_b128 v0, v[60:63] offset:27648
  s_waitcnt lgkmcnt(0)
  s_waitcnt vmcnt(0)
  ds_read_b64 v[68:69], v67 offset:28672
  ds_read_b64 v[70:71], v67 offset:28800
  ds_read_b64 v[72:73], v67 offset:29696
  ds_read_b64 v[74:75], v67 offset:29824
  ds_read_b64 v[76:77], v67 offset:28928
  ds_read_b64 v[78:79], v67 offset:29056
  ds_read_b64 v[80:81], v67 offset:29952
  ds_read_b64 v[82:83], v67 offset:30080
  s_mov_b32 s31, 0x05040100
  s_mov_b32 s32, 0x07060302
  s_waitcnt lgkmcnt(0)
  v_perm_b32 v48, v70, v68, s31
  v_perm_b32 v49, v74, v72, s31
  v_perm_b32 v50, v78, v76, s31
  v_perm_b32 v51, v82, v80, s31
  v_perm_b32 v52, v70, v68, s32
  v_perm_b32 v53, v74, v72, s32
  v_perm_b32 v54, v78, v76, s32
  v_perm_b32 v55, v82, v80, s32
  v_perm_b32 v56, v71, v69, s31
  v_perm_b32 v57, v75, v73, s31
  v_perm_b32 v58, v79, v77, s31
  v_perm_b32 v59, v83, v81, s31
  v_perm_b32 v60, v71, v69, s32
  v_perm_b32 v61, v75, v73, s32
  v_perm_b32 v62, v79, v77, s32
  v_perm_b32 v63, v83, v81, s32
  s_waitcnt lgkmcnt(0)
  ds_write_b128 v0, v[48:51] offset:28672
  ds_write_b128 v0, v[52:55] offset:29696
  ds_write_b128 v0, v[56:59] offset:30720
  ds_write_b128 v0, v[60:63] offset:31744
  s_waitcnt lgkmcnt(0)
wd_8:
  buffer_load_dword v42, off, s[20:23], 0 offset:132 sc1
  s_waitcnt vmcnt(0)
  v_readfirstlane_b32 s31, v42
  s_cmp_ge_u32 s31, 80
  s_cbranch_scc1 wd_9
  s_sleep 2
  s_sub_u32 s30, s30, 1
  s_cbranch_scc0 wd_8
  s_mov_b32 s30, 0
wd_9:
wd_10:
  buffer_load_dword v42, off, s[20:23], 0 offset:136 sc1
  s_waitcnt vmcnt(0)
  v_readfirstlane_b32 s31, v42
  s_cmp_ge_u32 s31, 1
  s_cbranch_scc1 wd_11
  s_sleep 2
  s_sub_u32 s30, s30, 1
  s_cbranch_scc0 wd_10
  s_mov_b32 s30, 0
wd_11:
  s_mov_b32 s12, s76
  s_mov_b32 s13, s77
  s_mov_b32 s14, 10240
  s_mov_b32 s15, 0x20000
  s_and_b32 s31, s31, 2
  s_lshl_b32 s31, s31, 12
  s_add_u32 s29, s29, s31
  s_add_u32 s40, s40, s31
  s_lshl_b32 s32, s3, 14
  s_add_u32 s31, s31, s32
  s_add_u32 s31, s31, 1949696
  s_cmp_ge_u32 s63, 32
  s_cselect_b32 s39, s39, s31
  s_cmp_ge_u32 s38, 40
  s_cbranch_scc1 L_12
  buffer_load_dword v43, v10, s[4:7], s41 offen
  s_mul_i32 s31, s3, 640
  s_lshl_b32 s32, s38, 4
  s_add_u32 s31, s31, s32
  buffer_load_dwordx2 v[42:43], v64, s[12:15], s31 offen
  s_waitcnt vmcnt(0)
  buffer_store_dwordx2 v[42:43], v10, s[4:7], s29 offen sc1
  buffer_store_dwordx2 v[42:43], v10, s[4:7], s41 offen
L_12:
wd_13:
  buffer_load_dword v44, off, s[20:23], 0 offset:128 sc1
  s_waitcnt vmcnt(0)
  v_readfirstlane_b32 s31, v44
  s_cmp_ge_u32 s31, 4
  s_cbranch_scc1 wd_14
  s_sleep 2
  s_sub_u32 s30, s30, 1
  s_cbranch_scc0 wd_13
  s_mov_b32 s30, 0
wd_14:
wf_15:
  buffer_load_dword v13, v12, s[4:7], s48 offen offset:0 sc1
  s_waitcnt vmcnt(0)
  v_cmp_ge_u32 vcc, 0, v13
  s_cbranch_vccz wf_16
  s_sleep 1
  s_sub_u32 s30, s30, 1
  s_cbranch_scc0 wf_15
  s_mov_b32 s30, 0
wf_16:
  s_mov_b32 s96, s30
  s_mov_b32 s34, 0x3f803f80
  s_mov_b32 s35, s34
  ds_read_b128 v[60:63], v0 offset:32768
  ds_read_b128 v[64:67], v0 offset:33792
  ds_read_b128 v[68:71], v0 offset:34816
  ds_read_b128 v[72:75], v0 offset:35840
  ds_read_b128 v[80:83], v0 offset:0
  ds_read_b128 v[84:87], v0 offset:1024
  ds_read_b128 v[88:91], v0 offset:2048
  ds_read_b128 v[92:95], v0 offset:3072
  s_cmp_lt_u32 s63, 32
  s_cbranch_scc1 L_rS
L_rF:
  s_cmp_lt_u32 s38, 40
  s_cbranch_scc1 L_rFR
  s_cmp_eq_u32 s28, 2
  s_cbranch_scc1 L_rF2
  v_mov_b32 v13, 0
  s_cmp_eq_u32 s28, 3
  s_cbranch_scc1 L_rF3
L_rFN:
  s_barrier
  s_sleep 3
  buffer_load_dwordx4 v[76:79], v4, s[4:7], s39 offen sc1
  buffer_load_dword v14, v5, s[4:7], s39 offen sc1
  s_waitcnt vmcnt(4)
  v_mov_b64 v[24:25], 0
  v_mov_b64 v[26:27], 0
  v_mov_b64 v[28:29], 0
  v_mov_b64 v[30:31], 0
  v_mov_b64 v[32:33], 0
  v_mov_b64 v[34:35], 0
  v_mov_b64 v[36:37], 0
  v_mov_b64 v[38:39], 0
  v_mov_b64 v[40:41], 0
  v_mov_b64 v[42:43], 0
  v_mov_b64 v[44:45], 0
  v_mov_b64 v[46:47], 0
  s_sleep 1
L_17:
  buffer_load_dwordx4 v[76:79], v4, s[4:7], s39 offen sc1
  buffer_load_dword v14, v5, s[4:7], s39 offen sc1
  s_mov_b64 exec, -1
  s_waitcnt vmcnt(2)
  v_max3_u32 v48, v76, v77, v14
  v_max3_u32 v48, v78, v79, v48
  ds_write_b128 v4, v[76:79]
  ds_write_b32 v5, v14
  v_cmp_eq_u32 vcc, -1, v48
  s_cbranch_vccz L_18
  s_mov_b64 exec, vcc
  s_sub_u32 s30, s30, 1
  s_cbranch_scc0 L_17
  s_mov_b32 s30, 0
  s_mov_b64 exec, -1
L_18:
  s_waitcnt lgkmcnt(0)
  s_barrier
  ds_read_b128 v[48:51], v1 offset:0
  ds_read_b128 v[52:55], v1 offset:1024
  ds_read_b128 v[56:59], v1 offset:2048
  s_add_u32 s31, s42, 16777216
  buffer_load_dwordx4 v[76:79], v4, s[4:7], s40 offen sc1
  buffer_load_dword v14, v5, s[4:7], s40 offen sc1
  s_waitcnt lgkmcnt(2)
  v_smfmac_f32_16x16x64_bf16 v[32:35], v[48:51], v[60:67], v15
  ds_read_b128 v[60:63], v0 offset:4096
  ds_read_b128 v[64:67], v0 offset:5120
  v_smfmac_f32_16x16x64_bf16 v[24:27], v[48:51], a[0:7], v15
  v_smfmac_f32_16x16x64_bf16 v[40:43], v[48:51], a[160:167], v15
  v_smfmac_f32_16x16x64_bf16 v[36:39], v[48:51], v[68:75], v15
  ds_read_b128 v[68:71], v0 offset:6144
  ds_read_b128 v[72:75], v0 offset:7168
  v_smfmac_f32_16x16x64_bf16 v[28:31], v[48:51], a[8:15], v15
  v_smfmac_f32_16x16x64_bf16 v[44:47], v[48:51], a[168:175], v15
  ds_read_b128 v[48:51], v1 offset:3072
  s_waitcnt lgkmcnt(6)
  v_smfmac_f32_16x16x64_bf16 v[32:35], v[52:55], v[80:87], v15
  ds_read_b128 v[80:83], v0 offset:8192
  ds_read_b128 v[84:87], v0 offset:9216
  v_smfmac_f32_16x16x64_bf16 v[24:27], v[52:55], a[16:23], v15
  v_smfmac_f32_16x16x64_bf16 v[40:43], v[52:55], a[176:183], v15
  v_smfmac_f32_16x16x64_bf16 v[36:39], v[52:55], v[88:95], v15
  ds_read_b128 v[88:91], v0 offset:10240
  ds_read_b128 v[92:95], v0 offset:11264
  v_smfmac_f32_16x16x64_bf16 v[28:31], v[52:55], a[24:31], v15
  v_smfmac_f32_16x16x64_bf16 v[44:47], v[52:55], a[184:191], v15
  ds_read_b128 v[52:55], v1 offset:4096
  s_waitcnt lgkmcnt(10)
  s_waitcnt lgkmcnt(8)
  v_smfmac_f32_16x16x64_bf16 v[32:35], v[56:59], v[60:67], v15
  ds_read_b128 v[60:63], v0 offset:12288
  ds_read_b128 v[64:67], v0 offset:13312
  v_smfmac_f32_16x16x64_bf16 v[24:27], v[56:59], a[32:39], v15
  s_waitcnt lgkmcnt(8)
  v_smfmac_f32_16x16x64_bf16 v[36:39], v[56:59], v[68:75], v15
  ds_read_b128 v[68:71], v0 offset:14336
  ds_read_b128 v[72:75], v0 offset:15360
  v_smfmac_f32_16x16x64_bf16 v[28:31], v[56:59], a[40:47], v15
  s_waitcnt lgkmcnt(9)
  s_waitcnt lgkmcnt(7)
  v_smfmac_f32_16x16x64_bf16 v[32:35], v[48:51], v[80:87], v15
  v_smfmac_f32_16x16x64_bf16 v[24:27], v[48:51], a[48:55], v15
  s_waitcnt lgkmcnt(5)
  v_smfmac_f32_16x16x64_bf16 v[36:39], v[48:51], v[88:95], v15
  buffer_load_dwordx4 v[80:83], v6, s[4:7], s31 offen offset:0
  v_smfmac_f32_16x16x64_bf16 v[28:31], v[48:51], a[56:63], v15
  buffer_load_dwordx4 v[88:91], v6, s[4:7], s42 offen offset:0
  s_waitcnt vmcnt(2)
L_19:
  ds_write_b128 v4, v[76:79] offset:5120
  ds_write_b32 v5, v14 offset:5120
  v_max3_u32 v14, v76, v77, v14
  v_max3_u32 v14, v78, v79, v14
  v_cmp_eq_u32 vcc, -1, v14
  s_cbranch_vccz L_20
  buffer_load_dwordx4 v[76:79], v4, s[4:7], s40 offen sc1
  buffer_load_dword v14, v5, s[4:7], s40 offen sc1
  s_waitcnt vmcnt(0)
  s_sub_u32 s30, s30, 1
  s_cbranch_scc0 L_19
  s_mov_b32 s30, 0
L_20:
  s_waitcnt lgkmcnt(2)
  v_smfmac_f32_16x16x64_bf16 v[32:35], v[52:55], v[60:67], v15
  buffer_load_dwordx4 v[92:95], v6, s[4:7], s42 offen offset:1024
  v_smfmac_f32_16x16x64_bf16 v[36:39], v[52:55], v[68:75], v15
  buffer_load_dwordx4 v[84:87], v6, s[4:7], s31 offen offset:1024
  s_waitcnt lgkmcnt(0)
  s_add_u32 s42, s42, 262144
  s_add_u32 s41, s41, 5120
  s_barrier
  ds_read_b128 v[60:63], v1 offset:5120
  ds_read_b128 v[64:67], v1 offset:6144
  ds_read_b128 v[68:71], v1 offset:7168
  ds_read_b128 v[72:75], v1 offset:8192
  ds_read_b128 v[76:79], v1 offset:9216
  v_smfmac_f32_16x16x64_bf16 v[24:27], v[52:55], a[64:71], v15
  buffer_store_dwordx2 v[2:3], v8, s[4:7], s43 offen sc1
  v_smfmac_f32_16x16x64_bf16 v[28:31], v[52:55], a[72:79], v15
  s_add_u32 s43, s43, 65536
  s_add_u32 s39, s39, 5120
  v_smfmac_f32_16x16x64_bf16 v[40:43], v[56:59], a[192:199], v15
  s_add_u32 s40, s40, 32768
  s_add_u32 s29, s29, 32768
  v_smfmac_f32_16x16x64_bf16 v[44:47], v[56:59], a[200:207], v15
  v_smfmac_f32_16x16x64_bf16 v[40:43], v[48:51], a[208:215], v15
  v_smfmac_f32_16x16x64_bf16 v[44:47], v[48:51], a[216:223], v15
  v_smfmac_f32_16x16x64_bf16 v[40:43], v[52:55], a[224:231], v15
  v_smfmac_f32_16x16x64_bf16 v[44:47], v[52:55], a[232:239], v15
  s_waitcnt lgkmcnt(4)
  v_smfmac_f32_16x16x64_bf16 v[24:27], v[60:63], a[80:87], v15
  v_smfmac_f32_16x16x64_bf16 v[28:31], v[60:63], a[88:95], v15
  s_waitcnt lgkmcnt(3)
  v_smfmac_f32_16x16x64_bf16 v[24:27], v[64:67], a[96:103], v15
  v_smfmac_f32_16x16x64_bf16 v[28:31], v[64:67], a[104:111], v15
  s_waitcnt lgkmcnt(2)
  v_smfmac_f32_16x16x64_bf16 v[24:27], v[68:71], a[112:119], v15
  v_smfmac_f32_16x16x64_bf16 v[28:31], v[68:71], a[120:127], v15
  s_waitcnt lgkmcnt(1)
  v_smfmac_f32_16x16x64_bf16 v[24:27], v[72:75], a[128:135], v15
  v_smfmac_f32_16x16x64_bf16 v[28:31], v[72:75], a[136:143], v15
  s_waitcnt lgkmcnt(0)
  v_smfmac_f32_16x16x64_bf16 v[24:27], v[76:79], a[144:151], v15
  v_smfmac_f32_16x16x64_bf16 v[28:31], v[76:79], a[152:159], v15
  v_smfmac_f32_16x16x64_bf16 v[32:35], v[60:63], v[160:167], v15
  v_smfmac_f32_16x16x64_bf16 v[36:39], v[60:63], v[168:175], v15
  v_add_f32 v24, v24, v25
  v_add_f32 v25, v26, v27
  v_smfmac_f32_16x16x64_bf16 v[32:35], v[64:67], v[176:183], v15
  v_add_f32 v26, v28, v29
  v_add_f32 v27, v30, v31
  v_smfmac_f32_16x16x64_bf16 v[36:39], v[64:67], v[184:191], v15
  v_pk_mul_f32 v[24:25], v[24:25], s[48:49] op_sel:[0,1] op_sel_hi:[1,1]
  v_pk_mul_f32 v[26:27], v[26:27], s[48:49] op_sel:[0,1] op_sel_hi:[1,1]
  v_smfmac_f32_16x16x64_bf16 v[32:35], v[68:71], v[192:199], v15
  v_cvt_pk_bf16_f32 v48, v24, v25
  v_cvt_pk_bf16_f32 v49, v26, v27
  v_smfmac_f32_16x16x64_bf16 v[36:39], v[68:71], v[200:207], v15
  v_mfma_f32_16x16x16_bf16 v[24:27], v[48:49], v[16:17], 0
  v_mfma_f32_16x16x16_bf16 v[28:31], v[48:49], v[18:19], 0
  v_smfmac_f32_16x16x64_bf16 v[32:35], v[72:75], v[208:215], v15
  v_smfmac_f32_16x16x64_bf16 v[36:39], v[72:75], v[216:223], v15
  v_cvt_pk_bf16_f32 v52, v24, v25
  v_cvt_pk_bf16_f32 v53, v26, v27
  v_smfmac_f32_16x16x64_bf16 v[32:35], v[76:79], v[224:231], v15
  v_cvt_pk_bf16_f32 v54, v28, v29
  v_cvt_pk_bf16_f32 v55, v30, v31
  v_smfmac_f32_16x16x64_bf16 v[36:39], v[76:79], v[232:239], v15
  s_waitcnt vmcnt(1)
  v_mfma_f32_16x16x32_bf16 v[24:27], v[88:91], v[52:55], 0
  v_mfma_f32_16x16x32_bf16 v[28:31], v[92:95], v[52:55], 0
  v_add_f32 v32, v32, v33
  v_add_f32 v33, v34, v35
  v_cvt_pk_bf16_f32 v50, v32, v33
  v_add_f32 v34, v36, v37
  v_add_f32 v35, v38, v39
  v_cvt_pk_bf16_f32 v51, v34, v35
  s_nop 1
  v_cndmask_b32 v24, v24, v28, s[52:53]
  v_cndmask_b32 v25, v25, v29, s[52:53]
  v_mfma_f32_16x16x16_bf16 v[32:35], v[50:51], v[16:17], 0
  v_cndmask_b32 v26, v26, v30, s[52:53]
  v_cndmask_b32 v27, v27, v31, s[52:53]
  ds_write_b128 v4, v[24:27]
  v_mfma_f32_16x16x16_bf16 v[36:39], v[50:51], v[18:19], 0
  v_mov_b64 v[2:3], v[50:51]
  v_smfmac_f32_16x16x64_bf16 v[40:43], v[60:63], a[240:247], v15
  s_nop 1
  v_cvt_pk_bf16_f32 v56, v32, v33
  v_cvt_pk_bf16_f32 v57, v34, v35
  s_nop 1
  v_cvt_pk_bf16_f32 v58, v36, v37
  v_cvt_pk_bf16_f32 v59, v38, v39
  v_smfmac_f32_16x16x64_bf16 v[44:47], v[60:63], a[248:255], v15
  v_mfma_f32_16x16x32_bf16 v[32:35], v[56:59], v[52:55], 0
  s_waitcnt lgkmcnt(0)
  s_barrier
  ds_read_b128 v[24:27], v6 offset:0
  ds_read_b128 v[28:31], v6 offset:1024
  ds_read_b128 v[88:91], v6 offset:2048
  ds_read_b128 v[92:95], v6 offset:3072
  v_smfmac_f32_16x16x64_bf16 v[40:43], v[64:67], v[96:103], v15
  s_nop 0
  v_cndmask_b32 v48, v32, v34, s[52:53]
  ds_write_b32 v5, v48
  v_smfmac_f32_16x16x64_bf16 v[44:47], v[64:67], v[104:111], v15
  v_mov_b32 v33, 0
  v_smfmac_f32_16x16x64_bf16 v[40:43], v[68:71], v[112:119], v15
  v_mov_b32 v34, 0
  v_smfmac_f32_16x16x64_bf16 v[44:47], v[68:71], v[120:127], v15
  v_smfmac_f32_16x16x64_bf16 v[40:43], v[72:75], v[128:135], v15
  s_waitcnt lgkmcnt(3)
  v_pk_add_f32 v[24:25], v[24:25], v[28:29]
  v_pk_add_f32 v[26:27], v[26:27], v[30:31]
  s_waitcnt lgkmcnt(0)
  s_barrier
  ds_read2st64_b32 v[48:49], v7 offset0:0 offset1:1
  ds_read2st64_b32 v[50:51], v7 offset0:2 offset1:3
  v_pk_add_f32 v[88:89], v[88:89], v[92:93]
  v_pk_add_f32 v[90:91], v[90:91], v[94:95]
  v_smfmac_f32_16x16x64_bf16 v[44:47], v[72:75], v[136:143], v15
  v_pk_add_f32 v[24:25], v[24:25], v[88:89]
  v_pk_add_f32 v[26:27], v[26:27], v[90:91]
  v_smfmac_f32_16x16x64_bf16 v[40:43], v[76:79], v[144:151], v15
  v_exp_f32 v28, v24
  v_exp_f32 v29, v25
  v_smfmac_f32_16x16x64_bf16 v[44:47], v[76:79], v[152:159], v15
  v_exp_f32 v30, v26
  v_exp_f32 v31, v27
  ds_read_b128 v[64:67], v0 offset:17408
  ds_read_b128 v[68:71], v0 offset:21504
  v_max3_f32 v57, |v24|, |v25|, |v26|
  v_cvt_pk_bf16_f32 v28, v28, v29
  v_cvt_pk_bf16_f32 v29, v30, v31
  ds_read_b128 v[72:75], v0 offset:24576
  ds_read_b128 v[76:79], v0 offset:28672
  v_max_f32 v57, |v27|, v57
  v_mov_b32_dpp v24, v28 quad_perm:[0,0,2,2] row_mask:0xf bank_mask:0xf
  v_mov_b32_dpp v25, v29 quad_perm:[0,0,2,2] row_mask:0xf bank_mask:0xf
  v_mov_b32_dpp v26, v28 quad_perm:[1,1,3,3] row_mask:0xf bank_mask:0xf
  v_mov_b32_dpp v27, v29 quad_perm:[1,1,3,3] row_mask:0xf bank_mask:0xf
  s_waitcnt lgkmcnt(4)
  v_pk_add_f32 v[48:49], v[48:49], v[50:51]
  v_mfma_f32_16x16x32_bf16 v[28:31], v[20:23], v[24:27], 0
  v_add_f32 v56, v48, v49
  v_mfma_f32_16x16x32_bf16 v[88:91], v[80:83], v[24:27], 0
  v_exp_f32 v36, v56
  v_mfma_f32_16x16x32_bf16 v[92:95], v[84:87], v[24:27], 0
  ds_read_b128 v[48:51], v0 offset:25600
  ds_read_b128 v[52:55], v0 offset:29696
  v_add_f32 v58, v40, v41
  v_add_f32 v59, v42, v43
  v_mov_b32_dpp v37, v36 quad_perm:[0,0,2,2] row_mask:0xf bank_mask:0xf
  v_mov_b32_dpp v38, v36 quad_perm:[1,1,3,3] row_mask:0xf bank_mask:0xf
  v_add_f32 v44, v44, v45
  v_add_f32 v45, v46, v47
  v_cvt_pk_bf16_f32 v32, v37, v38
  v_cvt_pk_bf16_f32 v35, v37, v38
  v_cvt_pk_bf16_f32 v58, v58, v59
  v_cvt_pk_bf16_f32 v59, v44, v45
  v_mfma_f32_16x16x16_bf16 v[28:31], v[20:21], v[32:33], v[28:31]
  ds_read_b128 v[80:83], v0 offset:16384
  ds_read_b128 v[84:87], v0 offset:20480
  v_max_f32 v57, |v56|, v57
  v_mfma_f32_16x16x16_bf16 v[88:91], v[58:59], v[32:33], v[88:91]
  v_cmp_nge_f32 vcc, s51, v57
  v_mfma_f32_16x16x16_bf16 v[92:95], v[58:59], v[34:35], v[92:95]
  s_cbranch_vccnz L_rMFN
L_rMbFN:
  s_nop 0
  v_rcp_f32 v28, v28
  v_cndmask_b32 v2, v2, v58, s[26:27]
  v_cndmask_b32 v3, v3, v59, s[26:27]
  s_cmp_eq_u32 s37, 63
  s_cbranch_scc1 L_rX
  s_nop 0
  v_cndmask_b32 v40, v88, v92, s[52:53]
  v_cndmask_b32 v41, v89, v93, s[52:53]
  v_cndmask_b32 v42, v90, v94, s[52:53]
  v_cndmask_b32 v43, v91, v95, s[52:53]
  v_pk_mul_f32 v[40:41], v[40:41], v[28:29] op_sel_hi:[1,0]
  v_pk_mul_f32 v[42:43], v[42:43], v[28:29] op_sel_hi:[1,0]
  v_cvt_pk_bf16_f32 v40, v40, v41
  v_cvt_pk_bf16_f32 v41, v42, v43
  ds_write_b64 v8, v[40:41]
  v_mov_b64 v[44:45], 0
  v_mov_b64 v[46:47], 0
  v_mov_b64 v[60:61], 0
  v_mov_b64 v[62:63], 0
  s_waitcnt lgkmcnt(0)
  s_barrier
  ds_read_b128 v[32:35], v6 offset:10240
  ds_read_b128 v[36:39], v6 offset:11264
  ds_read_b128 v[88:91], v0 offset:18432
  ds_read_b128 v[92:95], v0 offset:22528
  v_mov_b64 v[24:25], 0
  v_mov_b64 v[26:27], 0
  v_mov_b64 v[28:29], 0
  v_mov_b64 v[30:31], 0
  v_mov_b64 v[56:57], 0
  v_mov_b64 v[58:59], 0
  s_add_u32 s31, s44, 32768
  s_waitcnt lgkmcnt(3)
  v_smfmac_f32_16x16x64_bf16 v[44:47], v[32:35], v[80:87], v15
  ds_read_b128 v[80:83], v0 offset:26624
  ds_read_b128 v[84:87], v0 offset:30720
  s_waitcnt lgkmcnt(4)
  v_smfmac_f32_16x16x64_bf16 v[44:47], v[36:39], v[72:79], v15
  ds_read_b128 v[72:75], v0 offset:19456
  ds_read_b128 v[76:79], v0 offset:23552
  v_smfmac_f32_16x16x64_bf16 v[60:63], v[32:35], v[64:71], v15
  ds_read_b128 v[64:67], v0 offset:27648
  ds_read_b128 v[68:71], v0 offset:31744
  v_smfmac_f32_16x16x64_bf16 v[60:63], v[36:39], v[48:55], v15
  v_smfmac_f32_16x16x64_bf16 v[24:27], v[32:35], v[240:247], v15
  v_add_f32 v44, v44, v45
  v_add_f32 v45, v46, v47
  v_smfmac_f32_16x16x64_bf16 v[24:27], v[36:39], v[248:255], v15
  v_cvt_pk_bf16_f32 v40, v44, v45
  s_waitcnt lgkmcnt(6)
  v_smfmac_f32_16x16x64_bf16 v[28:31], v[32:35], v[88:95], v15
  s_waitcnt lgkmcnt(4)
  v_add_f32 v60, v60, v61
  v_add_f32 v61, v62, v63
  v_smfmac_f32_16x16x64_bf16 v[28:31], v[36:39], v[80:87], v15
  v_cvt_pk_bf16_f32 v41, v60, v61
  s_waitcnt lgkmcnt(2)
  v_smfmac_f32_16x16x64_bf16 v[56:59], v[32:35], v[72:79], v15
  s_waitcnt lgkmcnt(0)
  v_add_f32 v24, v24, v25
  v_add_f32 v25, v26, v27
  v_smfmac_f32_16x16x64_bf16 v[56:59], v[36:39], v[64:71], v15
  v_cvt_pk_bf16_f32 v24, v24, v25
  buffer_store_dword v24, v9, s[4:7], s31 offen
  v_add_f32 v28, v28, v29
  v_add_f32 v29, v30, v31
  v_cvt_pk_bf16_f32 v42, v28, v29
  s_nop 2
  v_add_f32 v56, v56, v57
  v_add_f32 v57, v58, v59
  v_cvt_pk_bf16_f32 v43, v56, v57
  buffer_store_dwordx4 v[40:43], v11, s[4:7], s44 offen
  ds_read_b128 v[60:63], v0 offset:32768
  ds_read_b128 v[64:67], v0 offset:33792
  ds_read_b128 v[68:71], v0 offset:34816
  ds_read_b128 v[72:75], v0 offset:35840
  ds_read_b128 v[80:83], v0 offset:0
  ds_read_b128 v[84:87], v0 offset:1024
  ds_read_b128 v[88:91], v0 offset:2048
  ds_read_b128 v[92:95], v0 offset:3072
  s_add_u32 s44, s44, s46
  s_add_u32 s37, s37, 1
  s_sub_u32 s46, 0, s46
  s_branch L_rFN
L_rMFN:
  s_add_u32 s31, s42, 16515072
  s_waitcnt lgkmcnt(0)
  s_nop 7
  s_nop 7
  buffer_load_dwordx4 v[80:83], v6, s[4:7], s31 offen offset:0
  buffer_load_dwordx4 v[84:87], v6, s[4:7], s31 offen offset:1024
  ds_read_b128 v[24:27], v6 offset:0
  ds_read_b128 v[28:31], v6 offset:1024
  ds_read_b128 v[88:91], v6 offset:2048
  ds_read_b128 v[92:95], v6 offset:3072
  s_waitcnt vmcnt(0) lgkmcnt(0)
  v_pk_add_f32 v[24:25], v[24:25], v[28:29]
  v_pk_add_f32 v[26:27], v[26:27], v[30:31]
  v_pk_add_f32 v[88:89], v[88:89], v[92:93]
  v_pk_add_f32 v[90:91], v[90:91], v[94:95]
  v_pk_add_f32 v[24:25], v[24:25], v[88:89]
  v_pk_add_f32 v[26:27], v[26:27], v[90:91]
  v_max3_f32 v57, v24, v25, v26
  v_max3_f32 v57, v27, v56, v57
  s_nop 1
  v_mov_b32_dpp v44, v57 quad_perm:[1,0,3,2] row_mask:0xf bank_mask:0xf
  v_max_f32 v57, v57, v44
  v_mov_b32 v44, v57
  s_nop 1
  v_permlane16_swap_b32 v44, v57
  v_max_f32 v57, v57, v44
  v_mov_b32 v44, v57
  s_nop 1
  v_permlane32_swap_b32 v44, v57
  v_max_f32 v57, v57, v44
  v_sub_f32 v24, v24, v57
  v_sub_f32 v25, v25, v57
  v_sub_f32 v26, v26, v57
  v_sub_f32 v27, v27, v57
  v_sub_f32 v56, v56, v57
  v_exp_f32 v28, v24
  v_exp_f32 v29, v25
  v_exp_f32 v30, v26
  v_exp_f32 v31, v27
  v_max3_f32 v57, |v24|, |v25|, |v26|
  v_cvt_pk_bf16_f32 v28, v28, v29
  v_cvt_pk_bf16_f32 v29, v30, v31
  v_max_f32 v57, |v27|, v57
  v_mov_b32_dpp v24, v28 quad_perm:[0,0,2,2] row_mask:0xf bank_mask:0xf
  v_mov_b32_dpp v25, v29 quad_perm:[0,0,2,2] row_mask:0xf bank_mask:0xf
  v_mov_b32_dpp v26, v28 quad_perm:[1,1,3,3] row_mask:0xf bank_mask:0xf
  v_mov_b32_dpp v27, v29 quad_perm:[1,1,3,3] row_mask:0xf bank_mask:0xf
  s_nop 1
  v_mfma_f32_16x16x32_bf16 v[28:31], v[20:23], v[24:27], 0
  v_mfma_f32_16x16x32_bf16 v[88:91], v[80:83], v[24:27], 0
  v_exp_f32 v36, v56
  v_mfma_f32_16x16x32_bf16 v[92:95], v[84:87], v[24:27], 0
  s_nop 0
  v_mov_b32_dpp v37, v36 quad_perm:[0,0,2,2] row_mask:0xf bank_mask:0xf
  v_mov_b32_dpp v38, v36 quad_perm:[1,1,3,3] row_mask:0xf bank_mask:0xf
  v_cvt_pk_bf16_f32 v32, v37, v38
  v_cvt_pk_bf16_f32 v35, v37, v38
  s_nop 0
  v_mfma_f32_16x16x16_bf16 v[28:31], v[20:21], v[32:33], v[28:31]
  v_mfma_f32_16x16x16_bf16 v[88:91], v[58:59], v[32:33], v[88:91]
  v_mfma_f32_16x16x16_bf16 v[92:95], v[58:59], v[34:35], v[92:95]
  ds_read_b128 v[80:83], v0 offset:16384
  ds_read_b128 v[84:87], v0 offset:20480
  s_nop 7
  s_nop 7
  s_branch L_rMbFN
L_rFR:
  s_barrier
  s_sleep 3
  buffer_load_dwordx4 v[76:79], v4, s[4:7], s39 offen sc1
  buffer_load_dword v14, v5, s[4:7], s39 offen sc1
  s_waitcnt vmcnt(4)
  v_mov_b64 v[24:25], 0
  v_mov_b64 v[26:27], 0
  v_mov_b64 v[28:29], 0
  v_mov_b64 v[30:31], 0
  v_mov_b64 v[32:33], 0
  v_mov_b64 v[34:35], 0
  v_mov_b64 v[36:37], 0
  v_mov_b64 v[38:39], 0
  v_mov_b64 v[40:41], 0
  v_mov_b64 v[42:43], 0
  v_mov_b64 v[44:45], 0
  v_mov_b64 v[46:47], 0
  s_sleep 1
L_24:
  buffer_load_dwordx4 v[76:79], v4, s[4:7], s39 offen sc1
  buffer_load_dword v14, v5, s[4:7], s39 offen sc1
  s_mov_b64 exec, -1
  s_waitcnt vmcnt(2)
  v_max3_u32 v48, v76, v77, v14
  v_max3_u32 v48, v78, v79, v48
  ds_write_b128 v4, v[76:79]
  ds_write_b32 v5, v14
  v_cmp_eq_u32 vcc, -1, v48
  s_cbranch_vccz L_25
  s_mov_b64 exec, vcc
  s_sub_u32 s30, s30, 1
  s_cbranch_scc0 L_24
  s_mov_b32 s30, 0
  s_mov_b64 exec, -1
L_25:
  s_waitcnt lgkmcnt(0)
  s_barrier
  ds_read_b128 v[48:51], v1 offset:0
  ds_read_b128 v[52:55], v1 offset:1024
  ds_read_b128 v[56:59], v1 offset:2048
  s_add_u32 s31, s42, 16777216
  buffer_load_dwordx4 v[76:79], v4, s[4:7], s40 offen sc1
  buffer_load_dword v14, v5, s[4:7], s40 offen sc1
  s_waitcnt lgkmcnt(2)
  v_smfmac_f32_16x16x64_bf16 v[32:35], v[48:51], v[60:67], v15
  ds_read_b128 v[60:63], v0 offset:4096
  ds_read_b128 v[64:67], v0 offset:5120
  v_smfmac_f32_16x16x64_bf16 v[24:27], v[48:51], a[0:7], v15
  v_smfmac_f32_16x16x64_bf16 v[40:43], v[48:51], a[160:167], v15
  v_smfmac_f32_16x16x64_bf16 v[36:39], v[48:51], v[68:75], v15
  ds_read_b128 v[68:71], v0 offset:6144
  ds_read_b128 v[72:75], v0 offset:7168
  v_smfmac_f32_16x16x64_bf16 v[28:31], v[48:51], a[8:15], v15
  v_smfmac_f32_16x16x64_bf16 v[44:47], v[48:51], a[168:175], v15
  ds_read_b128 v[48:51], v1 offset:3072
  s_waitcnt lgkmcnt(6)
  v_smfmac_f32_16x16x64_bf16 v[32:35], v[52:55], v[80:87], v15
  ds_read_b128 v[80:83], v0 offset:8192
  ds_read_b128 v[84:87], v0 offset:9216
  v_smfmac_f32_16x16x64_bf16 v[24:27], v[52:55], a[16:23], v15
  v_smfmac_f32_16x16x64_bf16 v[40:43], v[52:55], a[176:183], v15
  v_smfmac_f32_16x16x64_bf16 v[36:39], v[52:55], v[88:95], v15
  ds_read_b128 v[88:91], v0 offset:10240
  ds_read_b128 v[92:95], v0 offset:11264
  v_smfmac_f32_16x16x64_bf16 v[28:31], v[52:55], a[24:31], v15
  v_smfmac_f32_16x16x64_bf16 v[44:47], v[52:55], a[184:191], v15
  ds_read_b128 v[52:55], v1 offset:4096
  s_waitcnt lgkmcnt(10)
  s_waitcnt lgkmcnt(8)
  v_smfmac_f32_16x16x64_bf16 v[32:35], v[56:59], v[60:67], v15
  ds_read_b128 v[60:63], v0 offset:12288
  ds_read_b128 v[64:67], v0 offset:13312
  v_smfmac_f32_16x16x64_bf16 v[24:27], v[56:59], a[32:39], v15
  s_waitcnt lgkmcnt(8)
  v_smfmac_f32_16x16x64_bf16 v[36:39], v[56:59], v[68:75], v15
  ds_read_b128 v[68:71], v0 offset:14336
  ds_read_b128 v[72:75], v0 offset:15360
  v_smfmac_f32_16x16x64_bf16 v[28:31], v[56:59], a[40:47], v15
  s_waitcnt lgkmcnt(9)
  s_waitcnt lgkmcnt(7)
  v_smfmac_f32_16x16x64_bf16 v[32:35], v[48:51], v[80:87], v15
  v_smfmac_f32_16x16x64_bf16 v[24:27], v[48:51], a[48:55], v15
  s_waitcnt lgkmcnt(5)
  v_smfmac_f32_16x16x64_bf16 v[36:39], v[48:51], v[88:95], v15
  buffer_load_dwordx4 v[80:83], v6, s[4:7], s31 offen offset:0
  v_smfmac_f32_16x16x64_bf16 v[28:31], v[48:51], a[56:63], v15
  buffer_load_dwordx4 v[88:91], v6, s[4:7], s42 offen offset:0
  s_waitcnt vmcnt(2)
L_26:
  ds_write_b128 v4, v[76:79] offset:5120
  ds_write_b32 v5, v14 offset:5120
  v_max3_u32 v14, v76, v77, v14
  v_max3_u32 v14, v78, v79, v14
  v_cmp_eq_u32 vcc, -1, v14
  s_cbranch_vccz L_27
  buffer_load_dwordx4 v[76:79], v4, s[4:7], s40 offen sc1
  buffer_load_dword v14, v5, s[4:7], s40 offen sc1
  s_waitcnt vmcnt(0)
  s_sub_u32 s30, s30, 1
  s_cbranch_scc0 L_26
  s_mov_b32 s30, 0
L_27:
  s_waitcnt lgkmcnt(2)
  v_smfmac_f32_16x16x64_bf16 v[32:35], v[52:55], v[60:67], v15
  buffer_load_dwordx4 v[92:95], v6, s[4:7], s42 offen offset:1024
  v_smfmac_f32_16x16x64_bf16 v[36:39], v[52:55], v[68:75], v15
  buffer_load_dwordx4 v[84:87], v6, s[4:7], s31 offen offset:1024
  s_waitcnt lgkmcnt(0)
  s_add_u32 s42, s42, 262144
  s_add_u32 s41, s41, 5120
  s_barrier
  ds_read_b128 v[60:63], v1 offset:5120
  ds_read_b128 v[64:67], v1 offset:6144
  ds_read_b128 v[68:71], v1 offset:7168
  ds_read_b128 v[72:75], v1 offset:8192
  ds_read_b128 v[76:79], v1 offset:9216
  v_smfmac_f32_16x16x64_bf16 v[24:27], v[52:55], a[64:71], v15
  buffer_load_dword v14, v10, s[4:7], s41 offen
  v_smfmac_f32_16x16x64_bf16 v[28:31], v[52:55], a[72:79], v15
  buffer_store_dwordx2 v[2:3], v8, s[4:7], s43 offen sc1
  v_smfmac_f32_16x16x64_bf16 v[40:43], v[56:59], a[192:199], v15
  s_add_u32 s43, s43, 65536
  s_add_u32 s39, s39, 5120
  v_smfmac_f32_16x16x64_bf16 v[44:47], v[56:59], a[200:207], v15
  s_add_u32 s40, s40, 32768
  s_add_u32 s29, s29, 32768
  v_smfmac_f32_16x16x64_bf16 v[40:43], v[48:51], a[208:215], v15
  v_smfmac_f32_16x16x64_bf16 v[44:47], v[48:51], a[216:223], v15
  v_smfmac_f32_16x16x64_bf16 v[40:43], v[52:55], a[224:231], v15
  v_smfmac_f32_16x16x64_bf16 v[44:47], v[52:55], a[232:239], v15
  s_waitcnt lgkmcnt(4)
  v_smfmac_f32_16x16x64_bf16 v[24:27], v[60:63], a[80:87], v15
  s_add_u32 s31, s45, s46
  v_mov_b64 v[56:57], -1
  v_smfmac_f32_16x16x64_bf16 v[28:31], v[60:63], a[88:95], v15
  v_mov_b64 v[58:59], -1
  s_waitcnt lgkmcnt(3)
  v_smfmac_f32_16x16x64_bf16 v[24:27], v[64:67], a[96:103], v15
  v_smfmac_f32_16x16x64_bf16 v[28:31], v[64:67], a[104:111], v15
  buffer_store_dwordx4 v[56:59], v6, s[4:7], s31 offen offset:0
  s_waitcnt lgkmcnt(2)
  v_smfmac_f32_16x16x64_bf16 v[24:27], v[68:71], a[112:119], v15
  v_smfmac_f32_16x16x64_bf16 v[28:31], v[68:71], a[120:127], v15
  buffer_store_dwordx4 v[56:59], v6, s[4:7], s31 offen offset:1024
  s_waitcnt lgkmcnt(1)
  v_smfmac_f32_16x16x64_bf16 v[24:27], v[72:75], a[128:135], v15
  v_smfmac_f32_16x16x64_bf16 v[28:31], v[72:75], a[136:143], v15
  buffer_store_dwordx4 v[56:59], v6, s[4:7], s31 offen offset:2048
  s_waitcnt lgkmcnt(0)
  v_smfmac_f32_16x16x64_bf16 v[24:27], v[76:79], a[144:151], v15
  v_smfmac_f32_16x16x64_bf16 v[28:31], v[76:79], a[152:159], v15
  buffer_store_dwordx4 v[56:59], v6, s[4:7], s31 offen offset:3072
  v_smfmac_f32_16x16x64_bf16 v[32:35], v[60:63], v[160:167], v15
  v_smfmac_f32_16x16x64_bf16 v[36:39], v[60:63], v[168:175], v15
  v_add_f32 v24, v24, v25
  v_add_f32 v25, v26, v27
  v_smfmac_f32_16x16x64_bf16 v[32:35], v[64:67], v[176:183], v15
  v_add_f32 v26, v28, v29
  v_add_f32 v27, v30, v31
  v_smfmac_f32_16x16x64_bf16 v[36:39], v[64:67], v[184:191], v15
  v_pk_mul_f32 v[24:25], v[24:25], s[48:49] op_sel:[0,1] op_sel_hi:[1,1]
  v_pk_mul_f32 v[26:27], v[26:27], s[48:49] op_sel:[0,1] op_sel_hi:[1,1]
  v_smfmac_f32_16x16x64_bf16 v[32:35], v[68:71], v[192:199], v15
  v_cvt_pk_bf16_f32 v48, v24, v25
  v_cvt_pk_bf16_f32 v49, v26, v27
  v_smfmac_f32_16x16x64_bf16 v[36:39], v[68:71], v[200:207], v15
  v_mfma_f32_16x16x16_bf16 v[24:27], v[48:49], v[16:17], 0
  v_mfma_f32_16x16x16_bf16 v[28:31], v[48:49], v[18:19], 0
  v_smfmac_f32_16x16x64_bf16 v[32:35], v[72:75], v[208:215], v15
  v_smfmac_f32_16x16x64_bf16 v[36:39], v[72:75], v[216:223], v15
  v_cvt_pk_bf16_f32 v52, v24, v25
  v_cvt_pk_bf16_f32 v53, v26, v27
  v_smfmac_f32_16x16x64_bf16 v[32:35], v[76:79], v[224:231], v15
  v_cvt_pk_bf16_f32 v54, v28, v29
  v_cvt_pk_bf16_f32 v55, v30, v31
  v_smfmac_f32_16x16x64_bf16 v[36:39], v[76:79], v[232:239], v15
  s_waitcnt vmcnt(6)
  v_mfma_f32_16x16x32_bf16 v[24:27], v[88:91], v[52:55], 0
  v_mfma_f32_16x16x32_bf16 v[28:31], v[92:95], v[52:55], 0
  v_add_f32 v32, v32, v33
  v_add_f32 v33, v34, v35
  v_cvt_pk_bf16_f32 v50, v32, v33
  v_add_f32 v34, v36, v37
  v_add_f32 v35, v38, v39
  v_cvt_pk_bf16_f32 v51, v34, v35
  s_nop 1
  v_cndmask_b32 v24, v24, v28, s[52:53]
  v_cndmask_b32 v25, v25, v29, s[52:53]
  v_mfma_f32_16x16x16_bf16 v[32:35], v[50:51], v[16:17], 0
  v_cndmask_b32 v26, v26, v30, s[52:53]
  v_cndmask_b32 v27, v27, v31, s[52:53]
  ds_write_b128 v4, v[24:27]
  v_mfma_f32_16x16x16_bf16 v[36:39], v[50:51], v[18:19], 0
  v_mov_b64 v[2:3], v[50:51]
  v_smfmac_f32_16x16x64_bf16 v[40:43], v[60:63], a[240:247], v15
  s_nop 1
  v_cvt_pk_bf16_f32 v56, v32, v33
  v_cvt_pk_bf16_f32 v57, v34, v35
  s_nop 1
  v_cvt_pk_bf16_f32 v58, v36, v37
  v_cvt_pk_bf16_f32 v59, v38, v39
  v_smfmac_f32_16x16x64_bf16 v[44:47], v[60:63], a[248:255], v15
  v_mfma_f32_16x16x32_bf16 v[32:35], v[56:59], v[52:55], 0
  s_waitcnt lgkmcnt(0)
  s_barrier
  ds_read_b128 v[24:27], v6 offset:0
  ds_read_b128 v[28:31], v6 offset:1024
  ds_read_b128 v[88:91], v6 offset:2048
  ds_read_b128 v[92:95], v6 offset:3072
  v_smfmac_f32_16x16x64_bf16 v[40:43], v[64:67], v[96:103], v15
  s_nop 0
  v_cndmask_b32 v48, v32, v34, s[52:53]
  ds_write_b32 v5, v48
  v_smfmac_f32_16x16x64_bf16 v[44:47], v[64:67], v[104:111], v15
  v_mov_b32 v33, 0
  v_smfmac_f32_16x16x64_bf16 v[40:43], v[68:71], v[112:119], v15
  v_mov_b32 v34, 0
  v_smfmac_f32_16x16x64_bf16 v[44:47], v[68:71], v[120:127], v15
  v_smfmac_f32_16x16x64_bf16 v[40:43], v[72:75], v[128:135], v15
  s_waitcnt lgkmcnt(3)
  v_pk_add_f32 v[24:25], v[24:25], v[28:29]
  v_pk_add_f32 v[26:27], v[26:27], v[30:31]
  s_waitcnt lgkmcnt(0)
  s_barrier
  ds_read2st64_b32 v[48:49], v7 offset0:0 offset1:1
  ds_read2st64_b32 v[50:51], v7 offset0:2 offset1:3
  v_pk_add_f32 v[88:89], v[88:89], v[92:93]
  v_pk_add_f32 v[90:91], v[90:91], v[94:95]
  v_smfmac_f32_16x16x64_bf16 v[44:47], v[72:75], v[136:143], v15
  v_pk_add_f32 v[24:25], v[24:25], v[88:89]
  v_pk_add_f32 v[26:27], v[26:27], v[90:91]
  v_smfmac_f32_16x16x64_bf16 v[40:43], v[76:79], v[144:151], v15
  v_exp_f32 v28, v24
  v_exp_f32 v29, v25
  v_smfmac_f32_16x16x64_bf16 v[44:47], v[76:79], v[152:159], v15
  v_exp_f32 v30, v26
  v_exp_f32 v31, v27
  ds_read_b128 v[64:67], v0 offset:17408
  ds_read_b128 v[68:71], v0 offset:21504
  v_max3_f32 v57, |v24|, |v25|, |v26|
  v_cvt_pk_bf16_f32 v28, v28, v29
  v_cvt_pk_bf16_f32 v29, v30, v31
  ds_read_b128 v[72:75], v0 offset:24576
  ds_read_b128 v[76:79], v0 offset:28672
  v_max_f32 v57, |v27|, v57
  v_mov_b32_dpp v24, v28 quad_perm:[0,0,2,2] row_mask:0xf bank_mask:0xf
  v_mov_b32_dpp v25, v29 quad_perm:[0,0,2,2] row_mask:0xf bank_mask:0xf
  v_mov_b32_dpp v26, v28 quad_perm:[1,1,3,3] row_mask:0xf bank_mask:0xf
  v_mov_b32_dpp v27, v29 quad_perm:[1,1,3,3] row_mask:0xf bank_mask:0xf
  s_waitcnt lgkmcnt(4)
  v_pk_add_f32 v[48:49], v[48:49], v[50:51]
  v_mfma_f32_16x16x32_bf16 v[28:31], v[20:23], v[24:27], 0
  v_add_f32 v56, v48, v49
  v_mfma_f32_16x16x32_bf16 v[88:91], v[80:83], v[24:27], 0
  v_exp_f32 v36, v56
  v_mfma_f32_16x16x32_bf16 v[92:95], v[84:87], v[24:27], 0
  ds_read_b128 v[48:51], v0 offset:25600
  ds_read_b128 v[52:55], v0 offset:29696
  v_add_f32 v58, v40, v41
  v_add_f32 v59, v42, v43
  v_mov_b32_dpp v37, v36 quad_perm:[0,0,2,2] row_mask:0xf bank_mask:0xf
  v_mov_b32_dpp v38, v36 quad_perm:[1,1,3,3] row_mask:0xf bank_mask:0xf
  v_add_f32 v44, v44, v45
  v_add_f32 v45, v46, v47
  v_cvt_pk_bf16_f32 v32, v37, v38
  v_cvt_pk_bf16_f32 v35, v37, v38
  v_cvt_pk_bf16_f32 v58, v58, v59
  v_cvt_pk_bf16_f32 v59, v44, v45
  v_mfma_f32_16x16x16_bf16 v[28:31], v[20:21], v[32:33], v[28:31]
  ds_read_b128 v[80:83], v0 offset:16384
  ds_read_b128 v[84:87], v0 offset:20480
  v_max_f32 v57, |v56|, v57
  v_mfma_f32_16x16x16_bf16 v[88:91], v[58:59], v[32:33], v[88:91]
  v_cmp_nge_f32 vcc, s51, v57
  v_mfma_f32_16x16x16_bf16 v[92:95], v[58:59], v[34:35], v[92:95]
  s_cbranch_vccnz L_rMFR
L_rMbFR:
  s_nop 0
  v_rcp_f32 v28, v28
  v_cndmask_b32 v2, v2, v58, s[26:27]
  v_cndmask_b32 v3, v3, v59, s[26:27]
  s_cmp_eq_u32 s37, 63
  s_cbranch_scc1 L_rX
  s_nop 0
  v_cndmask_b32 v40, v88, v92, s[52:53]
  v_cndmask_b32 v41, v89, v93, s[52:53]
  v_cndmask_b32 v42, v90, v94, s[52:53]
  v_cndmask_b32 v43, v91, v95, s[52:53]
  v_pk_mul_f32 v[40:41], v[40:41], v[28:29] op_sel_hi:[1,0]
  v_pk_mul_f32 v[42:43], v[42:43], v[28:29] op_sel_hi:[1,0]
  v_cvt_pk_bf16_f32 v40, v40, v41
  v_cvt_pk_bf16_f32 v41, v42, v43
  ds_write_b64 v8, v[40:41]
  v_mov_b64 v[44:45], 0
  v_mov_b64 v[46:47], 0
  v_mov_b64 v[60:61], 0
  v_mov_b64 v[62:63], 0
  s_waitcnt lgkmcnt(0)
  s_barrier
  ds_read_b128 v[32:35], v6 offset:10240
  ds_read_b128 v[36:39], v6 offset:11264
  ds_read_b128 v[88:91], v0 offset:18432
  ds_read_b128 v[92:95], v0 offset:22528
  v_mov_b64 v[24:25], 0
  v_mov_b64 v[26:27], 0
  v_mov_b64 v[28:29], 0
  v_mov_b64 v[30:31], 0
  v_mov_b64 v[56:57], 0
  v_mov_b64 v[58:59], 0
  s_add_u32 s31, s44, 32768
  s_waitcnt lgkmcnt(3)
  v_smfmac_f32_16x16x64_bf16 v[44:47], v[32:35], v[80:87], v15
  ds_read_b128 v[80:83], v0 offset:26624
  ds_read_b128 v[84:87], v0 offset:30720
  s_waitcnt lgkmcnt(4)
  v_smfmac_f32_16x16x64_bf16 v[44:47], v[36:39], v[72:79], v15
  ds_read_b128 v[72:75], v0 offset:19456
  ds_read_b128 v[76:79], v0 offset:23552
  v_smfmac_f32_16x16x64_bf16 v[60:63], v[32:35], v[64:71], v15
  ds_read_b128 v[64:67], v0 offset:27648
  ds_read_b128 v[68:71], v0 offset:31744
  v_smfmac_f32_16x16x64_bf16 v[60:63], v[36:39], v[48:55], v15
  v_smfmac_f32_16x16x64_bf16 v[24:27], v[32:35], v[240:247], v15
  v_add_f32 v44, v44, v45
  v_add_f32 v45, v46, v47
  v_smfmac_f32_16x16x64_bf16 v[24:27], v[36:39], v[248:255], v15
  v_cvt_pk_bf16_f32 v40, v44, v45
  s_waitcnt lgkmcnt(6)
  v_smfmac_f32_16x16x64_bf16 v[28:31], v[32:35], v[88:95], v15
  s_waitcnt lgkmcnt(4)
  v_add_f32 v60, v60, v61
  v_add_f32 v61, v62, v63
  v_smfmac_f32_16x16x64_bf16 v[28:31], v[36:39], v[80:87], v15
  v_cvt_pk_bf16_f32 v41, v60, v61
  s_waitcnt lgkmcnt(2)
  v_smfmac_f32_16x16x64_bf16 v[56:59], v[32:35], v[72:79], v15
  s_waitcnt lgkmcnt(0)
  v_add_f32 v24, v24, v25
  v_add_f32 v25, v26, v27
  v_smfmac_f32_16x16x64_bf16 v[56:59], v[36:39], v[64:71], v15
  v_cvt_pk_bf16_f32 v24, v24, v25
  buffer_store_dword v24, v9, s[4:7], s31 offen
  v_add_f32 v28, v28, v29
  v_add_f32 v29, v30, v31
  v_cvt_pk_bf16_f32 v42, v28, v29
  s_nop 2
  v_add_f32 v56, v56, v57
  v_add_f32 v57, v58, v59
  v_cvt_pk_bf16_f32 v43, v56, v57
  buffer_store_dwordx4 v[40:43], v11, s[4:7], s44 offen
  ds_read_b128 v[60:63], v0 offset:32768
  ds_read_b128 v[64:67], v0 offset:33792
  ds_read_b128 v[68:71], v0 offset:34816
  ds_read_b128 v[72:75], v0 offset:35840
  ds_read_b128 v[80:83], v0 offset:0
  ds_read_b128 v[84:87], v0 offset:1024
  ds_read_b128 v[88:91], v0 offset:2048
  ds_read_b128 v[92:95], v0 offset:3072
  s_add_u32 s44, s44, s46
  s_add_u32 s37, s37, 1
  s_sleep 4
  buffer_load_dwordx4 v[24:27], v6, s[4:7], s45 offen offset:0 sc1
  buffer_load_dwordx4 v[28:31], v6, s[4:7], s45 offen offset:1024 sc1
  buffer_load_dwordx4 v[32:35], v6, s[4:7], s45 offen offset:2048 sc1
  buffer_load_dwordx4 v[36:39], v6, s[4:7], s45 offen offset:3072 sc1
  v_mov_b32 v79, 0x3f80
  v_cndmask_b32 v79, v79, 1.0, s[100:101]
  v_cndmask_b32 v76, 0, v79, s[54:55]
  v_cndmask_b32 v77, 0, v79, s[56:57]
  v_cndmask_b32 v78, 0, v79, s[58:59]
  v_cndmask_b32 v79, 0, v79, s[60:61]
  s_sleep 2
L_28:
  buffer_load_dwordx4 v[24:27], v6, s[4:7], s45 offen offset:0 sc1
  buffer_load_dwordx4 v[28:31], v6, s[4:7], s45 offen offset:1024 sc1
  buffer_load_dwordx4 v[32:35], v6, s[4:7], s45 offen offset:2048 sc1
  buffer_load_dwordx4 v[36:39], v6, s[4:7], s45 offen offset:3072 sc1
  s_mov_b64 exec, -1
  s_waitcnt vmcnt(7)
  v_max3_u32 v14, v24, v25, 0
  v_max3_u32 v14, v26, v27, v14
  v_mfma_f32_16x16x32_bf16 v[56:59], v[76:79], v[24:27], 0
  s_waitcnt vmcnt(6)
  v_max3_u32 v14, v28, v29, v14
  v_max3_u32 v14, v30, v31, v14
  v_mfma_f32_16x16x32_bf16 v[56:59], v[76:79], v[28:31], v[56:59]
  s_waitcnt vmcnt(5)
  v_max3_u32 v14, v32, v33, v14
  v_max3_u32 v14, v34, v35, v14
  v_mfma_f32_16x16x32_bf16 v[56:59], v[76:79], v[32:35], v[56:59]
  s_waitcnt vmcnt(4)
  v_max3_u32 v14, v36, v37, v14
  v_max3_u32 v14, v38, v39, v14
  v_mfma_f32_16x16x32_bf16 v[56:59], v[76:79], v[36:39], v[56:59]
  v_cmp_eq_u32 vcc, -1, v14
  s_nop 5
  s_cbranch_vccz L_29
  s_mov_b64 exec, vcc
  s_sub_u32 s30, s30, 1
  s_cbranch_scc0 L_28
  s_mov_b32 s30, 0
  s_mov_b64 exec, -1
L_29:
  v_add_f32_dpp v56, v56, v56 row_ror:8 row_mask:0xf bank_mask:0xf
  v_add_f32_dpp v57, v57, v57 row_ror:8 row_mask:0xf bank_mask:0xf
  v_add_f32_dpp v58, v58, v58 row_ror:8 row_mask:0xf bank_mask:0xf
  v_add_f32_dpp v59, v59, v59 row_ror:8 row_mask:0xf bank_mask:0xf
  v_cvt_pk_bf16_f32 v56, v56, v57
  v_cvt_pk_bf16_f32 v57, v58, v59
  buffer_store_dwordx2 v[56:57], v10, s[4:7], s29 offen sc1
  buffer_store_dwordx2 v[56:57], v10, s[4:7], s41 offen
  s_add_u32 s45, s45, s46
  s_sub_u32 s46, 0, s46
  s_branch L_rFR
L_rMFR:
  s_add_u32 s31, s42, 16515072
  s_waitcnt lgkmcnt(0)
  s_nop 7
  s_nop 7
  buffer_load_dwordx4 v[80:83], v6, s[4:7], s31 offen offset:0
  buffer_load_dwordx4 v[84:87], v6, s[4:7], s31 offen offset:1024
  ds_read_b128 v[24:27], v6 offset:0
  ds_read_b128 v[28:31], v6 offset:1024
  ds_read_b128 v[88:91], v6 offset:2048
  ds_read_b128 v[92:95], v6 offset:3072
  s_waitcnt vmcnt(0) lgkmcnt(0)
  v_pk_add_f32 v[24:25], v[24:25], v[28:29]
  v_pk_add_f32 v[26:27], v[26:27], v[30:31]
  v_pk_add_f32 v[88:89], v[88:89], v[92:93]
  v_pk_add_f32 v[90:91], v[90:91], v[94:95]
  v_pk_add_f32 v[24:25], v[24:25], v[88:89]
  v_pk_add_f32 v[26:27], v[26:27], v[90:91]
  v_max3_f32 v57, v24, v25, v26
  v_max3_f32 v57, v27, v56, v57
  s_nop 1
  v_mov_b32_dpp v44, v57 quad_perm:[1,0,3,2] row_mask:0xf bank_mask:0xf
  v_max_f32 v57, v57, v44
  v_mov_b32 v44, v57
  s_nop 1
  v_permlane16_swap_b32 v44, v57
  v_max_f32 v57, v57, v44
  v_mov_b32 v44, v57
  s_nop 1
  v_permlane32_swap_b32 v44, v57
  v_max_f32 v57, v57, v44
  v_sub_f32 v24, v24, v57
  v_sub_f32 v25, v25, v57
  v_sub_f32 v26, v26, v57
  v_sub_f32 v27, v27, v57
  v_sub_f32 v56, v56, v57
  v_exp_f32 v28, v24
  v_exp_f32 v29, v25
  v_exp_f32 v30, v26
  v_exp_f32 v31, v27
  v_max3_f32 v57, |v24|, |v25|, |v26|
  v_cvt_pk_bf16_f32 v28, v28, v29
  v_cvt_pk_bf16_f32 v29, v30, v31
  v_max_f32 v57, |v27|, v57
  v_mov_b32_dpp v24, v28 quad_perm:[0,0,2,2] row_mask:0xf bank_mask:0xf
  v_mov_b32_dpp v25, v29 quad_perm:[0,0,2,2] row_mask:0xf bank_mask:0xf
  v_mov_b32_dpp v26, v28 quad_perm:[1,1,3,3] row_mask:0xf bank_mask:0xf
  v_mov_b32_dpp v27, v29 quad_perm:[1,1,3,3] row_mask:0xf bank_mask:0xf
  s_nop 1
  v_mfma_f32_16x16x32_bf16 v[28:31], v[20:23], v[24:27], 0
  v_mfma_f32_16x16x32_bf16 v[88:91], v[80:83], v[24:27], 0
  v_exp_f32 v36, v56
  v_mfma_f32_16x16x32_bf16 v[92:95], v[84:87], v[24:27], 0
  s_nop 0
  v_mov_b32_dpp v37, v36 quad_perm:[0,0,2,2] row_mask:0xf bank_mask:0xf
  v_mov_b32_dpp v38, v36 quad_perm:[1,1,3,3] row_mask:0xf bank_mask:0xf
  v_cvt_pk_bf16_f32 v32, v37, v38
  v_cvt_pk_bf16_f32 v35, v37, v38
  s_nop 0
  v_mfma_f32_16x16x16_bf16 v[28:31], v[20:21], v[32:33], v[28:31]
  v_mfma_f32_16x16x16_bf16 v[88:91], v[58:59], v[32:33], v[88:91]
  v_mfma_f32_16x16x16_bf16 v[92:95], v[58:59], v[34:35], v[92:95]
  ds_read_b128 v[80:83], v0 offset:16384
  ds_read_b128 v[84:87], v0 offset:20480
  s_nop 7
  s_nop 7
  s_branch L_rMbFR
L_rF2:
  s_barrier
  s_sleep 3
  buffer_load_dwordx4 v[76:79], v4, s[4:7], s39 offen sc1
  buffer_load_dword v14, v5, s[4:7], s39 offen sc1
  s_waitcnt vmcnt(4)
  v_mov_b64 v[24:25], 0
  v_mov_b64 v[26:27], 0
  v_mov_b64 v[28:29], 0
  v_mov_b64 v[30:31], 0
  v_mov_b64 v[32:33], 0
  v_mov_b64 v[34:35], 0
  v_mov_b64 v[36:37], 0
  v_mov_b64 v[38:39], 0
  v_mov_b64 v[40:41], 0
  v_mov_b64 v[42:43], 0
  v_mov_b64 v[44:45], 0
  v_mov_b64 v[46:47], 0
  s_sleep 1
L_31:
  buffer_load_dwordx4 v[76:79], v4, s[4:7], s39 offen sc1
  buffer_load_dword v14, v5, s[4:7], s39 offen sc1
  s_mov_b64 exec, -1
  s_waitcnt vmcnt(2)
  v_max3_u32 v48, v76, v77, v14
  v_max3_u32 v48, v78, v79, v48
  ds_write_b128 v4, v[76:79]
  ds_write_b32 v5, v14
  v_cmp_eq_u32 vcc, -1, v48
  s_cbranch_vccz L_32
  s_mov_b64 exec, vcc
  s_sub_u32 s30, s30, 1
  s_cbranch_scc0 L_31
  s_mov_b32 s30, 0
  s_mov_b64 exec, -1
L_32:
  s_waitcnt lgkmcnt(0)
  s_barrier
  ds_read_b128 v[48:51], v1 offset:0
  ds_read_b128 v[52:55], v1 offset:1024
  ds_read_b128 v[56:59], v1 offset:2048
  s_add_u32 s31, s42, 16777216
  s_add_u32 s32, s37, 1
  s_min_u32 s32, s32, 63
  buffer_load_dwordx4 v[76:79], v4, s[4:7], s40 offen sc1
  buffer_load_dword v14, v5, s[4:7], s40 offen sc1
  s_waitcnt lgkmcnt(2)
  v_smfmac_f32_16x16x64_bf16 v[32:35], v[48:51], v[60:67], v15
  ds_read_b128 v[60:63], v0 offset:4096
  ds_read_b128 v[64:67], v0 offset:5120
  v_smfmac_f32_16x16x64_bf16 v[24:27], v[48:51], a[0:7], v15
  v_smfmac_f32_16x16x64_bf16 v[40:43], v[48:51], a[160:167], v15
  v_smfmac_f32_16x16x64_bf16 v[36:39], v[48:51], v[68:75], v15
  ds_read_b128 v[68:71], v0 offset:6144
  ds_read_b128 v[72:75], v0 offset:7168
  v_smfmac_f32_16x16x64_bf16 v[28:31], v[48:51], a[8:15], v15
  v_smfmac_f32_16x16x64_bf16 v[44:47], v[48:51], a[168:175], v15
  ds_read_b128 v[48:51], v1 offset:3072
  s_waitcnt lgkmcnt(6)
  v_smfmac_f32_16x16x64_bf16 v[32:35], v[52:55], v[80:87], v15
  ds_read_b128 v[80:83], v0 offset:8192
  ds_read_b128 v[84:87], v0 offset:9216
  v_smfmac_f32_16x16x64_bf16 v[24:27], v[52:55], a[16:23], v15
  v_smfmac_f32_16x16x64_bf16 v[40:43], v[52:55], a[176:183], v15
  v_smfmac_f32_16x16x64_bf16 v[36:39], v[52:55], v[88:95], v15
  ds_read_b128 v[88:91], v0 offset:10240
  ds_read_b128 v[92:95], v0 offset:11264
  v_smfmac_f32_16x16x64_bf16 v[28:31], v[52:55], a[24:31], v15
  v_smfmac_f32_16x16x64_bf16 v[44:47], v[52:55], a[184:191], v15
  ds_read_b128 v[52:55], v1 offset:4096
  s_waitcnt lgkmcnt(10)
  s_waitcnt lgkmcnt(8)
  v_smfmac_f32_16x16x64_bf16 v[32:35], v[56:59], v[60:67], v15
  ds_read_b128 v[60:63], v0 offset:12288
  ds_read_b128 v[64:67], v0 offset:13312
  v_smfmac_f32_16x16x64_bf16 v[24:27], v[56:59], a[32:39], v15
  s_waitcnt lgkmcnt(8)
  v_smfmac_f32_16x16x64_bf16 v[36:39], v[56:59], v[68:75], v15
  ds_read_b128 v[68:71], v0 offset:14336
  ds_read_b128 v[72:75], v0 offset:15360
  v_smfmac_f32_16x16x64_bf16 v[28:31], v[56:59], a[40:47], v15
  s_waitcnt lgkmcnt(9)
  s_waitcnt lgkmcnt(7)
  v_smfmac_f32_16x16x64_bf16 v[32:35], v[48:51], v[80:87], v15
  v_smfmac_f32_16x16x64_bf16 v[24:27], v[48:51], a[48:55], v15
  s_waitcnt lgkmcnt(5)
  v_smfmac_f32_16x16x64_bf16 v[36:39], v[48:51], v[88:95], v15
  buffer_load_dwordx4 v[80:83], v6, s[4:7], s31 offen offset:0
  v_smfmac_f32_16x16x64_bf16 v[28:31], v[48:51], a[56:63], v15
  buffer_load_dwordx4 v[88:91], v6, s[4:7], s42 offen offset:0
  s_waitcnt vmcnt(2)
L_33:
  ds_write_b128 v4, v[76:79] offset:5120
  ds_write_b32 v5, v14 offset:5120
  v_max3_u32 v14, v76, v77, v14
  v_max3_u32 v14, v78, v79, v14
  v_cmp_eq_u32 vcc, -1, v14
  s_cbranch_vccz L_34
  buffer_load_dwordx4 v[76:79], v4, s[4:7], s40 offen sc1
  buffer_load_dword v14, v5, s[4:7], s40 offen sc1
  s_waitcnt vmcnt(0)
  s_sub_u32 s30, s30, 1
  s_cbranch_scc0 L_33
  s_mov_b32 s30, 0
L_34:
  s_waitcnt lgkmcnt(2)
  v_smfmac_f32_16x16x64_bf16 v[32:35], v[52:55], v[60:67], v15
  buffer_load_dwordx4 v[92:95], v6, s[4:7], s42 offen offset:1024
  v_smfmac_f32_16x16x64_bf16 v[36:39], v[52:55], v[68:75], v15
  buffer_load_dwordx4 v[84:87], v6, s[4:7], s31 offen offset:1024
  s_waitcnt lgkmcnt(0)
  s_add_u32 s42, s42, 262144
  s_add_u32 s41, s41, 5120
  s_add_u32 s31, s31, 262144
  v_cmp_ge_u32 vcc, s32, v13
  s_barrier
  ds_read_b128 v[60:63], v1 offset:5120
  ds_read_b128 v[64:67], v1 offset:6144
  ds_read_b128 v[68:71], v1 offset:7168
  ds_read_b128 v[72:75], v1 offset:8192
  ds_read_b128 v[76:79], v1 offset:9216
  v_smfmac_f32_16x16x64_bf16 v[24:27], v[52:55], a[64:71], v15
  s_cbranch_vccnz L_rPF2
L_rPbF2:
  buffer_load_dword v14, v10, s[4:7], s42 offen
  v_smfmac_f32_16x16x64_bf16 v[28:31], v[52:55], a[72:79], v15
  buffer_load_dword v14, v10, s[4:7], s31 offen
  v_smfmac_f32_16x16x64_bf16 v[40:43], v[56:59], a[192:199], v15
  buffer_store_dwordx2 v[2:3], v8, s[4:7], s43 offen sc1
  v_smfmac_f32_16x16x64_bf16 v[44:47], v[56:59], a[200:207], v15
  buffer_load_dword v13, v12, s[4:7], s48 offen sc1
  v_smfmac_f32_16x16x64_bf16 v[40:43], v[48:51], a[208:215], v15
  s_add_u32 s43, s43, 65536
  s_add_u32 s39, s39, 5120
  v_smfmac_f32_16x16x64_bf16 v[44:47], v[48:51], a[216:223], v15
  s_add_u32 s40, s40, 32768
  s_add_u32 s29, s29, 32768
  v_smfmac_f32_16x16x64_bf16 v[40:43], v[52:55], a[224:231], v15
  v_smfmac_f32_16x16x64_bf16 v[44:47], v[52:55], a[232:239], v15
  s_waitcnt lgkmcnt(4)
  v_smfmac_f32_16x16x64_bf16 v[24:27], v[60:63], a[80:87], v15
  v_smfmac_f32_16x16x64_bf16 v[28:31], v[60:63], a[88:95], v15
  s_waitcnt lgkmcnt(3)
  v_smfmac_f32_16x16x64_bf16 v[24:27], v[64:67], a[96:103], v15
  v_smfmac_f32_16x16x64_bf16 v[28:31], v[64:67], a[104:111], v15
  s_waitcnt lgkmcnt(2)
  v_smfmac_f32_16x16x64_bf16 v[24:27], v[68:71], a[112:119], v15
  v_smfmac_f32_16x16x64_bf16 v[28:31], v[68:71], a[120:127], v15
  s_waitcnt lgkmcnt(1)
  v_smfmac_f32_16x16x64_bf16 v[24:27], v[72:75], a[128:135], v15
  v_smfmac_f32_16x16x64_bf16 v[28:31], v[72:75], a[136:143], v15
  s_waitcnt lgkmcnt(0)
  v_smfmac_f32_16x16x64_bf16 v[24:27], v[76:79], a[144:151], v15
  v_smfmac_f32_16x16x64_bf16 v[28:31], v[76:79], a[152:159], v15
  v_smfmac_f32_16x16x64_bf16 v[32:35], v[60:63], v[160:167], v15
  v_smfmac_f32_16x16x64_bf16 v[36:39], v[60:63], v[168:175], v15
  v_add_f32 v24, v24, v25
  v_add_f32 v25, v26, v27
  v_smfmac_f32_16x16x64_bf16 v[32:35], v[64:67], v[176:183], v15
  v_add_f32 v26, v28, v29
  v_add_f32 v27, v30, v31
  v_smfmac_f32_16x16x64_bf16 v[36:39], v[64:67], v[184:191], v15
  v_pk_mul_f32 v[24:25], v[24:25], s[48:49] op_sel:[0,1] op_sel_hi:[1,1]
  v_pk_mul_f32 v[26:27], v[26:27], s[48:49] op_sel:[0,1] op_sel_hi:[1,1]
  v_smfmac_f32_16x16x64_bf16 v[32:35], v[68:71], v[192:199], v15
  v_cvt_pk_bf16_f32 v48, v24, v25
  v_cvt_pk_bf16_f32 v49, v26, v27
  v_smfmac_f32_16x16x64_bf16 v[36:39], v[68:71], v[200:207], v15
  v_mfma_f32_16x16x16_bf16 v[24:27], v[48:49], v[16:17], 0
  v_mfma_f32_16x16x16_bf16 v[28:31], v[48:49], v[18:19], 0
  v_smfmac_f32_16x16x64_bf16 v[32:35], v[72:75], v[208:215], v15
  v_smfmac_f32_16x16x64_bf16 v[36:39], v[72:75], v[216:223], v15
  v_cvt_pk_bf16_f32 v52, v24, v25
  v_cvt_pk_bf16_f32 v53, v26, v27
  v_smfmac_f32_16x16x64_bf16 v[32:35], v[76:79], v[224:231], v15
  v_cvt_pk_bf16_f32 v54, v28, v29
  v_cvt_pk_bf16_f32 v55, v30, v31
  v_smfmac_f32_16x16x64_bf16 v[36:39], v[76:79], v[232:239], v15
  s_waitcnt vmcnt(4)
  v_mfma_f32_16x16x32_bf16 v[24:27], v[88:91], v[52:55], 0
  v_mfma_f32_16x16x32_bf16 v[28:31], v[92:95], v[52:55], 0
  v_add_f32 v32, v32, v33
  v_add_f32 v33, v34, v35
  v_cvt_pk_bf16_f32 v50, v32, v33
  v_add_f32 v34, v36, v37
  v_add_f32 v35, v38, v39
  v_cvt_pk_bf16_f32 v51, v34, v35
  s_nop 1
  v_cndmask_b32 v24, v24, v28, s[52:53]
  v_cndmask_b32 v25, v25, v29, s[52:53]
  v_mfma_f32_16x16x16_bf16 v[32:35], v[50:51], v[16:17], 0
  v_cndmask_b32 v26, v26, v30, s[52:53]
  v_cndmask_b32 v27, v27, v31, s[52:53]
  ds_write_b128 v4, v[24:27]
  v_mfma_f32_16x16x16_bf16 v[36:39], v[50:51], v[18:19], 0
  v_mov_b64 v[2:3], v[50:51]
  v_smfmac_f32_16x16x64_bf16 v[40:43], v[60:63], a[240:247], v15
  s_nop 1
  v_cvt_pk_bf16_f32 v56, v32, v33
  v_cvt_pk_bf16_f32 v57, v34, v35
  s_nop 1
  v_cvt_pk_bf16_f32 v58, v36, v37
  v_cvt_pk_bf16_f32 v59, v38, v39
  v_smfmac_f32_16x16x64_bf16 v[44:47], v[60:63], a[248:255], v15
  v_mfma_f32_16x16x32_bf16 v[32:35], v[56:59], v[52:55], 0
  s_waitcnt lgkmcnt(0)
  s_barrier
  ds_read_b128 v[24:27], v6 offset:0
  ds_read_b128 v[28:31], v6 offset:1024
  ds_read_b128 v[88:91], v6 offset:2048
  ds_read_b128 v[92:95], v6 offset:3072
  v_smfmac_f32_16x16x64_bf16 v[40:43], v[64:67], v[96:103], v15
  s_nop 0
  v_cndmask_b32 v48, v32, v34, s[52:53]
  ds_write_b32 v5, v48
  v_smfmac_f32_16x16x64_bf16 v[44:47], v[64:67], v[104:111], v15
  v_mov_b32 v33, 0
  v_smfmac_f32_16x16x64_bf16 v[40:43], v[68:71], v[112:119], v15
  v_mov_b32 v34, 0
  v_smfmac_f32_16x16x64_bf16 v[44:47], v[68:71], v[120:127], v15
  v_smfmac_f32_16x16x64_bf16 v[40:43], v[72:75], v[128:135], v15
  s_waitcnt lgkmcnt(3)
  v_pk_add_f32 v[24:25], v[24:25], v[28:29]
  v_pk_add_f32 v[26:27], v[26:27], v[30:31]
  s_waitcnt lgkmcnt(0)
  s_barrier
  ds_read2st64_b32 v[48:49], v7 offset0:0 offset1:1
  ds_read2st64_b32 v[50:51], v7 offset0:2 offset1:3
  v_pk_add_f32 v[88:89], v[88:89], v[92:93]
  v_pk_add_f32 v[90:91], v[90:91], v[94:95]
  v_smfmac_f32_16x16x64_bf16 v[44:47], v[72:75], v[136:143], v15
  v_pk_add_f32 v[24:25], v[24:25], v[88:89]
  v_pk_add_f32 v[26:27], v[26:27], v[90:91]
  v_smfmac_f32_16x16x64_bf16 v[40:43], v[76:79], v[144:151], v15
  v_exp_f32 v28, v24
  v_exp_f32 v29, v25
  v_smfmac_f32_16x16x64_bf16 v[44:47], v[76:79], v[152:159], v15
  v_exp_f32 v30, v26
  v_exp_f32 v31, v27
  ds_read_b128 v[64:67], v0 offset:17408
  ds_read_b128 v[68:71], v0 offset:21504
  v_max3_f32 v57, |v24|, |v25|, |v26|
  v_cvt_pk_bf16_f32 v28, v28, v29
  v_cvt_pk_bf16_f32 v29, v30, v31
  ds_read_b128 v[72:75], v0 offset:24576
  ds_read_b128 v[76:79], v0 offset:28672
  v_max_f32 v57, |v27|, v57
  v_mov_b32_dpp v24, v28 quad_perm:[0,0,2,2] row_mask:0xf bank_mask:0xf
  v_mov_b32_dpp v25, v29 quad_perm:[0,0,2,2] row_mask:0xf bank_mask:0xf
  v_mov_b32_dpp v26, v28 quad_perm:[1,1,3,3] row_mask:0xf bank_mask:0xf
  v_mov_b32_dpp v27, v29 quad_perm:[1,1,3,3] row_mask:0xf bank_mask:0xf
  s_waitcnt lgkmcnt(4)
  v_pk_add_f32 v[48:49], v[48:49], v[50:51]
  v_mfma_f32_16x16x32_bf16 v[28:31], v[20:23], v[24:27], 0
  v_add_f32 v56, v48, v49
  v_mfma_f32_16x16x32_bf16 v[88:91], v[80:83], v[24:27], 0
  v_exp_f32 v36, v56
  v_mfma_f32_16x16x32_bf16 v[92:95], v[84:87], v[24:27], 0
  ds_read_b128 v[48:51], v0 offset:25600
  ds_read_b128 v[52:55], v0 offset:29696
  v_add_f32 v58, v40, v41
  v_add_f32 v59, v42, v43
  v_mov_b32_dpp v37, v36 quad_perm:[0,0,2,2] row_mask:0xf bank_mask:0xf
  v_mov_b32_dpp v38, v36 quad_perm:[1,1,3,3] row_mask:0xf bank_mask:0xf
  v_add_f32 v44, v44, v45
  v_add_f32 v45, v46, v47
  v_cvt_pk_bf16_f32 v32, v37, v38
  v_cvt_pk_bf16_f32 v35, v37, v38
  v_cvt_pk_bf16_f32 v58, v58, v59
  v_cvt_pk_bf16_f32 v59, v44, v45
  v_mfma_f32_16x16x16_bf16 v[28:31], v[20:21], v[32:33], v[28:31]
  ds_read_b128 v[80:83], v0 offset:16384
  ds_read_b128 v[84:87], v0 offset:20480
  v_max_f32 v57, |v56|, v57
  v_mfma_f32_16x16x16_bf16 v[88:91], v[58:59], v[32:33], v[88:91]
  v_cmp_nge_f32 vcc, s51, v57
  v_mfma_f32_16x16x16_bf16 v[92:95], v[58:59], v[34:35], v[92:95]
  s_cbranch_vccnz L_rMF2
L_rMbF2:
  s_nop 0
  v_rcp_f32 v28, v28
  v_cndmask_b32 v2, v2, v58, s[26:27]
  v_cndmask_b32 v3, v3, v59, s[26:27]
  s_cmp_eq_u32 s37, 63
  s_cbranch_scc1 L_rX
  s_nop 0
  v_cndmask_b32 v40, v88, v92, s[52:53]
  v_cndmask_b32 v41, v89, v93, s[52:53]
  v_cndmask_b32 v42, v90, v94, s[52:53]
  v_cndmask_b32 v43, v91, v95, s[52:53]
  v_pk_mul_f32 v[40:41], v[40:41], v[28:29] op_sel_hi:[1,0]
  v_pk_mul_f32 v[42:43], v[42:43], v[28:29] op_sel_hi:[1,0]
  v_cvt_pk_bf16_f32 v40, v40, v41
  v_cvt_pk_bf16_f32 v41, v42, v43
  ds_write_b64 v8, v[40:41]
  v_mov_b64 v[44:45], 0
  v_mov_b64 v[46:47], 0
  v_mov_b64 v[60:61], 0
  v_mov_b64 v[62:63], 0
  s_waitcnt lgkmcnt(0)
  s_barrier
  ds_read_b128 v[32:35], v6 offset:10240
  ds_read_b128 v[36:39], v6 offset:11264
  ds_read_b128 v[88:91], v0 offset:18432
  ds_read_b128 v[92:95], v0 offset:22528
  v_mov_b64 v[24:25], 0
  v_mov_b64 v[26:27], 0
  v_mov_b64 v[28:29], 0
  v_mov_b64 v[30:31], 0
  v_mov_b64 v[56:57], 0
  v_mov_b64 v[58:59], 0
  s_add_u32 s31, s44, 32768
  s_waitcnt lgkmcnt(3)
  v_smfmac_f32_16x16x64_bf16 v[44:47], v[32:35], v[80:87], v15
  ds_read_b128 v[80:83], v0 offset:26624
  ds_read_b128 v[84:87], v0 offset:30720
  s_waitcnt lgkmcnt(4)
  v_smfmac_f32_16x16x64_bf16 v[44:47], v[36:39], v[72:79], v15
  ds_read_b128 v[72:75], v0 offset:19456
  ds_read_b128 v[76:79], v0 offset:23552
  v_smfmac_f32_16x16x64_bf16 v[60:63], v[32:35], v[64:71], v15
  ds_read_b128 v[64:67], v0 offset:27648
  ds_read_b128 v[68:71], v0 offset:31744
  v_smfmac_f32_16x16x64_bf16 v[60:63], v[36:39], v[48:55], v15
  v_smfmac_f32_16x16x64_bf16 v[24:27], v[32:35], v[240:247], v15
  v_add_f32 v44, v44, v45
  v_add_f32 v45, v46, v47
  v_smfmac_f32_16x16x64_bf16 v[24:27], v[36:39], v[248:255], v15
  v_cvt_pk_bf16_f32 v40, v44, v45
  s_waitcnt lgkmcnt(6)
  v_smfmac_f32_16x16x64_bf16 v[28:31], v[32:35], v[88:95], v15
  s_waitcnt lgkmcnt(4)
  v_add_f32 v60, v60, v61
  v_add_f32 v61, v62, v63
  v_smfmac_f32_16x16x64_bf16 v[28:31], v[36:39], v[80:87], v15
  v_cvt_pk_bf16_f32 v41, v60, v61
  s_waitcnt lgkmcnt(2)
  v_smfmac_f32_16x16x64_bf16 v[56:59], v[32:35], v[72:79], v15
  s_waitcnt lgkmcnt(0)
  v_add_f32 v24, v24, v25
  v_add_f32 v25, v26, v27
  v_smfmac_f32_16x16x64_bf16 v[56:59], v[36:39], v[64:71], v15
  v_cvt_pk_bf16_f32 v24, v24, v25
  buffer_store_dword v24, v9, s[4:7], s31 offen
  v_add_f32 v28, v28, v29
  v_add_f32 v29, v30, v31
  v_cvt_pk_bf16_f32 v42, v28, v29
  s_nop 2
  v_add_f32 v56, v56, v57
  v_add_f32 v57, v58, v59
  v_cvt_pk_bf16_f32 v43, v56, v57
  buffer_store_dwordx4 v[40:43], v11, s[4:7], s44 offen
  ds_read_b128 v[60:63], v0 offset:32768
  ds_read_b128 v[64:67], v0 offset:33792
  ds_read_b128 v[68:71], v0 offset:34816
  ds_read_b128 v[72:75], v0 offset:35840
  ds_read_b128 v[80:83], v0 offset:0
  ds_read_b128 v[84:87], v0 offset:1024
  ds_read_b128 v[88:91], v0 offset:2048
  ds_read_b128 v[92:95], v0 offset:3072
  s_add_u32 s44, s44, s46
  s_add_u32 s37, s37, 1
  s_sub_u32 s46, 0, s46
  s_branch L_rF2
L_rPF2:
wf_38:
  buffer_load_dword v13, v12, s[4:7], s48 offen offset:0 sc1
  s_waitcnt vmcnt(0)
  v_cmp_ge_u32 vcc, s32, v13
  s_cbranch_vccz wf_39
  s_sleep 1
  s_sub_u32 s30, s30, 1
  s_cbranch_scc0 wf_38
  s_mov_b32 s30, 0
wf_39:
  s_branch L_rPbF2
L_rMF2:
  s_add_u32 s31, s42, 16515072
  s_waitcnt lgkmcnt(0)
  s_nop 7
  s_nop 7
  buffer_load_dwordx4 v[80:83], v6, s[4:7], s31 offen offset:0
  buffer_load_dwordx4 v[84:87], v6, s[4:7], s31 offen offset:1024
  ds_read_b128 v[24:27], v6 offset:0
  ds_read_b128 v[28:31], v6 offset:1024
  ds_read_b128 v[88:91], v6 offset:2048
  ds_read_b128 v[92:95], v6 offset:3072
  s_waitcnt vmcnt(0) lgkmcnt(0)
  v_pk_add_f32 v[24:25], v[24:25], v[28:29]
  v_pk_add_f32 v[26:27], v[26:27], v[30:31]
  v_pk_add_f32 v[88:89], v[88:89], v[92:93]
  v_pk_add_f32 v[90:91], v[90:91], v[94:95]
  v_pk_add_f32 v[24:25], v[24:25], v[88:89]
  v_pk_add_f32 v[26:27], v[26:27], v[90:91]
  v_max3_f32 v57, v24, v25, v26
  v_max3_f32 v57, v27, v56, v57
  s_nop 1
  v_mov_b32_dpp v44, v57 quad_perm:[1,0,3,2] row_mask:0xf bank_mask:0xf
  v_max_f32 v57, v57, v44
  v_mov_b32 v44, v57
  s_nop 1
  v_permlane16_swap_b32 v44, v57
  v_max_f32 v57, v57, v44
  v_mov_b32 v44, v57
  s_nop 1
  v_permlane32_swap_b32 v44, v57
  v_max_f32 v57, v57, v44
  v_sub_f32 v24, v24, v57
  v_sub_f32 v25, v25, v57
  v_sub_f32 v26, v26, v57
  v_sub_f32 v27, v27, v57
  v_sub_f32 v56, v56, v57
  v_exp_f32 v28, v24
  v_exp_f32 v29, v25
  v_exp_f32 v30, v26
  v_exp_f32 v31, v27
  v_max3_f32 v57, |v24|, |v25|, |v26|
  v_cvt_pk_bf16_f32 v28, v28, v29
  v_cvt_pk_bf16_f32 v29, v30, v31
  v_max_f32 v57, |v27|, v57
  v_mov_b32_dpp v24, v28 quad_perm:[0,0,2,2] row_mask:0xf bank_mask:0xf
  v_mov_b32_dpp v25, v29 quad_perm:[0,0,2,2] row_mask:0xf bank_mask:0xf
  v_mov_b32_dpp v26, v28 quad_perm:[1,1,3,3] row_mask:0xf bank_mask:0xf
  v_mov_b32_dpp v27, v29 quad_perm:[1,1,3,3] row_mask:0xf bank_mask:0xf
  s_nop 1
  v_mfma_f32_16x16x32_bf16 v[28:31], v[20:23], v[24:27], 0
  v_mfma_f32_16x16x32_bf16 v[88:91], v[80:83], v[24:27], 0
  v_exp_f32 v36, v56
  v_mfma_f32_16x16x32_bf16 v[92:95], v[84:87], v[24:27], 0
  s_nop 0
  v_mov_b32_dpp v37, v36 quad_perm:[0,0,2,2] row_mask:0xf bank_mask:0xf
  v_mov_b32_dpp v38, v36 quad_perm:[1,1,3,3] row_mask:0xf bank_mask:0xf
  v_cvt_pk_bf16_f32 v32, v37, v38
  v_cvt_pk_bf16_f32 v35, v37, v38
  s_nop 0
  v_mfma_f32_16x16x16_bf16 v[28:31], v[20:21], v[32:33], v[28:31]
  v_mfma_f32_16x16x16_bf16 v[88:91], v[58:59], v[32:33], v[88:91]
  v_mfma_f32_16x16x16_bf16 v[92:95], v[58:59], v[34:35], v[92:95]
  ds_read_b128 v[80:83], v0 offset:16384
  ds_read_b128 v[84:87], v0 offset:20480
  s_nop 7
  s_nop 7
  s_branch L_rMbF2
L_rF3:
  s_barrier
  s_sleep 3
  buffer_load_dwordx4 v[76:79], v4, s[4:7], s39 offen sc1
  buffer_load_dword v14, v5, s[4:7], s39 offen sc1
  s_waitcnt vmcnt(4)
  v_mov_b64 v[24:25], 0
  v_mov_b64 v[26:27], 0
  v_mov_b64 v[28:29], 0
  v_mov_b64 v[30:31], 0
  v_mov_b64 v[32:33], 0
  v_mov_b64 v[34:35], 0
  v_mov_b64 v[36:37], 0
  v_mov_b64 v[38:39], 0
  v_mov_b64 v[40:41], 0
  v_mov_b64 v[42:43], 0
  v_mov_b64 v[44:45], 0
  v_mov_b64 v[46:47], 0
  s_sleep 1
L_40:
  buffer_load_dwordx4 v[76:79], v4, s[4:7], s39 offen sc1
  buffer_load_dword v14, v5, s[4:7], s39 offen sc1
  s_mov_b64 exec, -1
  s_waitcnt vmcnt(2)
  v_max3_u32 v48, v76, v77, v14
  v_max3_u32 v48, v78, v79, v48
  ds_write_b128 v4, v[76:79]
  ds_write_b32 v5, v14
  v_cmp_eq_u32 vcc, -1, v48
  s_cbranch_vccz L_41
  s_mov_b64 exec, vcc
  s_sub_u32 s30, s30, 1
  s_cbranch_scc0 L_40
  s_mov_b32 s30, 0
  s_mov_b64 exec, -1
L_41:
  s_waitcnt lgkmcnt(0)
  s_barrier
  ds_read_b128 v[48:51], v1 offset:0
  ds_read_b128 v[52:55], v1 offset:1024
  ds_read_b128 v[56:59], v1 offset:2048
  s_add_u32 s31, s42, 16777216
  buffer_load_dwordx4 v[76:79], v4, s[4:7], s40 offen sc1
  buffer_load_dword v14, v5, s[4:7], s40 offen sc1
  s_waitcnt lgkmcnt(2)
  v_smfmac_f32_16x16x64_bf16 v[32:35], v[48:51], v[60:67], v15
  ds_read_b128 v[60:63], v0 offset:4096
  ds_read_b128 v[64:67], v0 offset:5120
  v_smfmac_f32_16x16x64_bf16 v[24:27], v[48:51], a[0:7], v15
  v_smfmac_f32_16x16x64_bf16 v[40:43], v[48:51], a[160:167], v15
  v_smfmac_f32_16x16x64_bf16 v[36:39], v[48:51], v[68:75], v15
  ds_read_b128 v[68:71], v0 offset:6144
  ds_read_b128 v[72:75], v0 offset:7168
  v_smfmac_f32_16x16x64_bf16 v[28:31], v[48:51], a[8:15], v15
  v_smfmac_f32_16x16x64_bf16 v[44:47], v[48:51], a[168:175], v15
  ds_read_b128 v[48:51], v1 offset:3072
  s_waitcnt lgkmcnt(6)
  v_smfmac_f32_16x16x64_bf16 v[32:35], v[52:55], v[80:87], v15
  ds_read_b128 v[80:83], v0 offset:8192
  ds_read_b128 v[84:87], v0 offset:9216
  v_smfmac_f32_16x16x64_bf16 v[24:27], v[52:55], a[16:23], v15
  v_smfmac_f32_16x16x64_bf16 v[40:43], v[52:55], a[176:183], v15
  v_smfmac_f32_16x16x64_bf16 v[36:39], v[52:55], v[88:95], v15
  ds_read_b128 v[88:91], v0 offset:10240
  ds_read_b128 v[92:95], v0 offset:11264
  v_smfmac_f32_16x16x64_bf16 v[28:31], v[52:55], a[24:31], v15
  v_smfmac_f32_16x16x64_bf16 v[44:47], v[52:55], a[184:191], v15
  ds_read_b128 v[52:55], v1 offset:4096
  s_waitcnt lgkmcnt(10)
  s_waitcnt lgkmcnt(8)
  v_smfmac_f32_16x16x64_bf16 v[32:35], v[56:59], v[60:67], v15
  ds_read_b128 v[60:63], v0 offset:12288
  ds_read_b128 v[64:67], v0 offset:13312
  v_smfmac_f32_16x16x64_bf16 v[24:27], v[56:59], a[32:39], v15
  s_waitcnt lgkmcnt(8)
  v_smfmac_f32_16x16x64_bf16 v[36:39], v[56:59], v[68:75], v15
  ds_read_b128 v[68:71], v0 offset:14336
  ds_read_b128 v[72:75], v0 offset:15360
  v_smfmac_f32_16x16x64_bf16 v[28:31], v[56:59], a[40:47], v15
  s_waitcnt lgkmcnt(9)
  s_waitcnt lgkmcnt(7)
  v_smfmac_f32_16x16x64_bf16 v[32:35], v[48:51], v[80:87], v15
  v_smfmac_f32_16x16x64_bf16 v[24:27], v[48:51], a[48:55], v15
  s_waitcnt lgkmcnt(5)
  v_smfmac_f32_16x16x64_bf16 v[36:39], v[48:51], v[88:95], v15
  buffer_load_dwordx4 v[80:83], v6, s[4:7], s31 offen offset:0
  v_smfmac_f32_16x16x64_bf16 v[28:31], v[48:51], a[56:63], v15
  buffer_load_dwordx4 v[88:91], v6, s[4:7], s42 offen offset:0
  s_waitcnt vmcnt(2)
L_42:
  ds_write_b128 v4, v[76:79] offset:5120
  ds_write_b32 v5, v14 offset:5120
  v_max3_u32 v14, v76, v77, v14
  v_max3_u32 v14, v78, v79, v14
  v_cmp_eq_u32 vcc, -1, v14
  s_cbranch_vccz L_43
  buffer_load_dwordx4 v[76:79], v4, s[4:7], s40 offen sc1
  buffer_load_dword v14, v5, s[4:7], s40 offen sc1
  s_waitcnt vmcnt(0)
  s_sub_u32 s30, s30, 1
  s_cbranch_scc0 L_42
  s_mov_b32 s30, 0
L_43:
  s_waitcnt lgkmcnt(2)
  v_smfmac_f32_16x16x64_bf16 v[32:35], v[52:55], v[60:67], v15
  buffer_load_dwordx4 v[92:95], v6, s[4:7], s42 offen offset:1024
  v_smfmac_f32_16x16x64_bf16 v[36:39], v[52:55], v[68:75], v15
  buffer_load_dwordx4 v[84:87], v6, s[4:7], s31 offen offset:1024
  s_waitcnt lgkmcnt(0)
  s_add_u32 s42, s42, 262144
  s_add_u32 s41, s41, 5120
  s_barrier
  ds_read_b128 v[60:63], v1 offset:5120
  ds_read_b128 v[64:67], v1 offset:6144
  ds_read_b128 v[68:71], v1 offset:7168
  ds_read_b128 v[72:75], v1 offset:8192
  ds_read_b128 v[76:79], v1 offset:9216
  v_smfmac_f32_16x16x64_bf16 v[24:27], v[52:55], a[64:71], v15
  buffer_store_dwordx2 v[2:3], v8, s[4:7], s43 offen sc1
  v_smfmac_f32_16x16x64_bf16 v[28:31], v[52:55], a[72:79], v15
  buffer_store_dword v13, v10, s[4:7], s47 offen sc1
  v_smfmac_f32_16x16x64_bf16 v[40:43], v[56:59], a[192:199], v15
  v_mov_b32 v13, s37
  v_smfmac_f32_16x16x64_bf16 v[44:47], v[56:59], a[200:207], v15
  s_add_u32 s43, s43, 65536
  s_add_u32 s39, s39, 5120
  v_smfmac_f32_16x16x64_bf16 v[40:43], v[48:51], a[208:215], v15
  s_add_u32 s40, s40, 32768
  s_add_u32 s29, s29, 32768
  v_smfmac_f32_16x16x64_bf16 v[44:47], v[48:51], a[216:223], v15
  v_smfmac_f32_16x16x64_bf16 v[40:43], v[52:55], a[224:231], v15
  v_smfmac_f32_16x16x64_bf16 v[44:47], v[52:55], a[232:239], v15
  s_waitcnt lgkmcnt(4)
  v_smfmac_f32_16x16x64_bf16 v[24:27], v[60:63], a[80:87], v15
  v_smfmac_f32_16x16x64_bf16 v[28:31], v[60:63], a[88:95], v15
  s_waitcnt lgkmcnt(3)
  v_smfmac_f32_16x16x64_bf16 v[24:27], v[64:67], a[96:103], v15
  v_smfmac_f32_16x16x64_bf16 v[28:31], v[64:67], a[104:111], v15
  s_waitcnt lgkmcnt(2)
  v_smfmac_f32_16x16x64_bf16 v[24:27], v[68:71], a[112:119], v15
  v_smfmac_f32_16x16x64_bf16 v[28:31], v[68:71], a[120:127], v15
  s_waitcnt lgkmcnt(1)
  v_smfmac_f32_16x16x64_bf16 v[24:27], v[72:75], a[128:135], v15
  v_smfmac_f32_16x16x64_bf16 v[28:31], v[72:75], a[136:143], v15
  s_waitcnt lgkmcnt(0)
  v_smfmac_f32_16x16x64_bf16 v[24:27], v[76:79], a[144:151], v15
  v_smfmac_f32_16x16x64_bf16 v[28:31], v[76:79], a[152:159], v15
  v_smfmac_f32_16x16x64_bf16 v[32:35], v[60:63], v[160:167], v15
  v_smfmac_f32_16x16x64_bf16 v[36:39], v[60:63], v[168:175], v15
  v_add_f32 v24, v24, v25
  v_add_f32 v25, v26, v27
  v_smfmac_f32_16x16x64_bf16 v[32:35], v[64:67], v[176:183], v15
  v_add_f32 v26, v28, v29
  v_add_f32 v27, v30, v31
  v_smfmac_f32_16x16x64_bf16 v[36:39], v[64:67], v[184:191], v15
  v_pk_mul_f32 v[24:25], v[24:25], s[48:49] op_sel:[0,1] op_sel_hi:[1,1]
  v_pk_mul_f32 v[26:27], v[26:27], s[48:49] op_sel:[0,1] op_sel_hi:[1,1]
  v_smfmac_f32_16x16x64_bf16 v[32:35], v[68:71], v[192:199], v15
  v_cvt_pk_bf16_f32 v48, v24, v25
  v_cvt_pk_bf16_f32 v49, v26, v27
  v_smfmac_f32_16x16x64_bf16 v[36:39], v[68:71], v[200:207], v15
  v_mfma_f32_16x16x16_bf16 v[24:27], v[48:49], v[16:17], 0
  v_mfma_f32_16x16x16_bf16 v[28:31], v[48:49], v[18:19], 0
  v_smfmac_f32_16x16x64_bf16 v[32:35], v[72:75], v[208:215], v15
  v_smfmac_f32_16x16x64_bf16 v[36:39], v[72:75], v[216:223], v15
  v_cvt_pk_bf16_f32 v52, v24, v25
  v_cvt_pk_bf16_f32 v53, v26, v27
  v_smfmac_f32_16x16x64_bf16 v[32:35], v[76:79], v[224:231], v15
  v_cvt_pk_bf16_f32 v54, v28, v29
  v_cvt_pk_bf16_f32 v55, v30, v31
  v_smfmac_f32_16x16x64_bf16 v[36:39], v[76:79], v[232:239], v15
  s_waitcnt vmcnt(2)
  v_mfma_f32_16x16x32_bf16 v[24:27], v[88:91], v[52:55], 0
  v_mfma_f32_16x16x32_bf16 v[28:31], v[92:95], v[52:55], 0
  v_add_f32 v32, v32, v33
  v_add_f32 v33, v34, v35
  v_cvt_pk_bf16_f32 v50, v32, v33
  v_add_f32 v34, v36, v37
  v_add_f32 v35, v38, v39
  v_cvt_pk_bf16_f32 v51, v34, v35
  s_nop 1
  v_cndmask_b32 v24, v24, v28, s[52:53]
  v_cndmask_b32 v25, v25, v29, s[52:53]
  v_mfma_f32_16x16x16_bf16 v[32:35], v[50:51], v[16:17], 0
  v_cndmask_b32 v26, v26, v30, s[52:53]
  v_cndmask_b32 v27, v27, v31, s[52:53]
  ds_write_b128 v4, v[24:27]
  v_mfma_f32_16x16x16_bf16 v[36:39], v[50:51], v[18:19], 0
  v_mov_b64 v[2:3], v[50:51]
  v_smfmac_f32_16x16x64_bf16 v[40:43], v[60:63], a[240:247], v15
  s_nop 1
  v_cvt_pk_bf16_f32 v56, v32, v33
  v_cvt_pk_bf16_f32 v57, v34, v35
  s_nop 1
  v_cvt_pk_bf16_f32 v58, v36, v37
  v_cvt_pk_bf16_f32 v59, v38, v39
  v_smfmac_f32_16x16x64_bf16 v[44:47], v[60:63], a[248:255], v15
  v_mfma_f32_16x16x32_bf16 v[32:35], v[56:59], v[52:55], 0
  s_waitcnt lgkmcnt(0)
  s_barrier
  ds_read_b128 v[24:27], v6 offset:0
  ds_read_b128 v[28:31], v6 offset:1024
  ds_read_b128 v[88:91], v6 offset:2048
  ds_read_b128 v[92:95], v6 offset:3072
  v_smfmac_f32_16x16x64_bf16 v[40:43], v[64:67], v[96:103], v15
  s_nop 0
  v_cndmask_b32 v48, v32, v34, s[52:53]
  ds_write_b32 v5, v48
  v_smfmac_f32_16x16x64_bf16 v[44:47], v[64:67], v[104:111], v15
  v_mov_b32 v33, 0
  v_smfmac_f32_16x16x64_bf16 v[40:43], v[68:71], v[112:119], v15
  v_mov_b32 v34, 0
  v_smfmac_f32_16x16x64_bf16 v[44:47], v[68:71], v[120:127], v15
  v_smfmac_f32_16x16x64_bf16 v[40:43], v[72:75], v[128:135], v15
  s_waitcnt lgkmcnt(3)
  v_pk_add_f32 v[24:25], v[24:25], v[28:29]
  v_pk_add_f32 v[26:27], v[26:27], v[30:31]
  s_waitcnt lgkmcnt(0)
  s_barrier
  ds_read2st64_b32 v[48:49], v7 offset0:0 offset1:1
  ds_read2st64_b32 v[50:51], v7 offset0:2 offset1:3
  v_pk_add_f32 v[88:89], v[88:89], v[92:93]
  v_pk_add_f32 v[90:91], v[90:91], v[94:95]
  v_smfmac_f32_16x16x64_bf16 v[44:47], v[72:75], v[136:143], v15
  v_pk_add_f32 v[24:25], v[24:25], v[88:89]
  v_pk_add_f32 v[26:27], v[26:27], v[90:91]
  v_smfmac_f32_16x16x64_bf16 v[40:43], v[76:79], v[144:151], v15
  v_exp_f32 v28, v24
  v_exp_f32 v29, v25
  v_smfmac_f32_16x16x64_bf16 v[44:47], v[76:79], v[152:159], v15
  v_exp_f32 v30, v26
  v_exp_f32 v31, v27
  ds_read_b128 v[64:67], v0 offset:17408
  ds_read_b128 v[68:71], v0 offset:21504
  v_max3_f32 v57, |v24|, |v25|, |v26|
  v_cvt_pk_bf16_f32 v28, v28, v29
  v_cvt_pk_bf16_f32 v29, v30, v31
  ds_read_b128 v[72:75], v0 offset:24576
  ds_read_b128 v[76:79], v0 offset:28672
  v_max_f32 v57, |v27|, v57
  v_mov_b32_dpp v24, v28 quad_perm:[0,0,2,2] row_mask:0xf bank_mask:0xf
  v_mov_b32_dpp v25, v29 quad_perm:[0,0,2,2] row_mask:0xf bank_mask:0xf
  v_mov_b32_dpp v26, v28 quad_perm:[1,1,3,3] row_mask:0xf bank_mask:0xf
  v_mov_b32_dpp v27, v29 quad_perm:[1,1,3,3] row_mask:0xf bank_mask:0xf
  s_waitcnt lgkmcnt(4)
  v_pk_add_f32 v[48:49], v[48:49], v[50:51]
  v_mfma_f32_16x16x32_bf16 v[28:31], v[20:23], v[24:27], 0
  v_add_f32 v56, v48, v49
  v_mfma_f32_16x16x32_bf16 v[88:91], v[80:83], v[24:27], 0
  v_exp_f32 v36, v56
  v_mfma_f32_16x16x32_bf16 v[92:95], v[84:87], v[24:27], 0
  ds_read_b128 v[48:51], v0 offset:25600
  ds_read_b128 v[52:55], v0 offset:29696
  v_add_f32 v58, v40, v41
  v_add_f32 v59, v42, v43
  v_mov_b32_dpp v37, v36 quad_perm:[0,0,2,2] row_mask:0xf bank_mask:0xf
  v_mov_b32_dpp v38, v36 quad_perm:[1,1,3,3] row_mask:0xf bank_mask:0xf
  v_add_f32 v44, v44, v45
  v_add_f32 v45, v46, v47
  v_cvt_pk_bf16_f32 v32, v37, v38
  v_cvt_pk_bf16_f32 v35, v37, v38
  v_cvt_pk_bf16_f32 v58, v58, v59
  v_cvt_pk_bf16_f32 v59, v44, v45
  v_mfma_f32_16x16x16_bf16 v[28:31], v[20:21], v[32:33], v[28:31]
  ds_read_b128 v[80:83], v0 offset:16384
  ds_read_b128 v[84:87], v0 offset:20480
  v_max_f32 v57, |v56|, v57
  v_mfma_f32_16x16x16_bf16 v[88:91], v[58:59], v[32:33], v[88:91]
  v_cmp_nge_f32 vcc, s51, v57
  v_mfma_f32_16x16x16_bf16 v[92:95], v[58:59], v[34:35], v[92:95]
  s_cbranch_vccnz L_rMF3
L_rMbF3:
  s_nop 0
  v_rcp_f32 v28, v28
  v_cndmask_b32 v2, v2, v58, s[26:27]
  v_cndmask_b32 v3, v3, v59, s[26:27]
  s_cmp_eq_u32 s37, 63
  s_cbranch_scc1 L_rX
  s_nop 0
  v_cndmask_b32 v40, v88, v92, s[52:53]
  v_cndmask_b32 v41, v89, v93, s[52:53]
  v_cndmask_b32 v42, v90, v94, s[52:53]
  v_cndmask_b32 v43, v91, v95, s[52:53]
  v_pk_mul_f32 v[40:41], v[40:41], v[28:29] op_sel_hi:[1,0]
  v_pk_mul_f32 v[42:43], v[42:43], v[28:29] op_sel_hi:[1,0]
  v_cvt_pk_bf16_f32 v40, v40, v41
  v_cvt_pk_bf16_f32 v41, v42, v43
  ds_write_b64 v8, v[40:41]
  v_mov_b64 v[44:45], 0
  v_mov_b64 v[46:47], 0
  v_mov_b64 v[60:61], 0
  v_mov_b64 v[62:63], 0
  s_waitcnt lgkmcnt(0)
  s_barrier
  ds_read_b128 v[32:35], v6 offset:10240
  ds_read_b128 v[36:39], v6 offset:11264
  ds_read_b128 v[88:91], v0 offset:18432
  ds_read_b128 v[92:95], v0 offset:22528
  v_mov_b64 v[24:25], 0
  v_mov_b64 v[26:27], 0
  v_mov_b64 v[28:29], 0
  v_mov_b64 v[30:31], 0
  v_mov_b64 v[56:57], 0
  v_mov_b64 v[58:59], 0
  s_add_u32 s31, s44, 32768
  s_waitcnt lgkmcnt(3)
  v_smfmac_f32_16x16x64_bf16 v[44:47], v[32:35], v[80:87], v15
  ds_read_b128 v[80:83], v0 offset:26624
  ds_read_b128 v[84:87], v0 offset:30720
  s_waitcnt lgkmcnt(4)
  v_smfmac_f32_16x16x64_bf16 v[44:47], v[36:39], v[72:79], v15
  ds_read_b128 v[72:75], v0 offset:19456
  ds_read_b128 v[76:79], v0 offset:23552
  v_smfmac_f32_16x16x64_bf16 v[60:63], v[32:35], v[64:71], v15
  ds_read_b128 v[64:67], v0 offset:27648
  ds_read_b128 v[68:71], v0 offset:31744
  v_smfmac_f32_16x16x64_bf16 v[60:63], v[36:39], v[48:55], v15
  v_smfmac_f32_16x16x64_bf16 v[24:27], v[32:35], v[240:247], v15
  v_add_f32 v44, v44, v45
  v_add_f32 v45, v46, v47
  v_smfmac_f32_16x16x64_bf16 v[24:27], v[36:39], v[248:255], v15
  v_cvt_pk_bf16_f32 v40, v44, v45
  s_waitcnt lgkmcnt(6)
  v_smfmac_f32_16x16x64_bf16 v[28:31], v[32:35], v[88:95], v15
  s_waitcnt lgkmcnt(4)
  v_add_f32 v60, v60, v61
  v_add_f32 v61, v62, v63
  v_smfmac_f32_16x16x64_bf16 v[28:31], v[36:39], v[80:87], v15
  v_cvt_pk_bf16_f32 v41, v60, v61
  s_waitcnt lgkmcnt(2)
  v_smfmac_f32_16x16x64_bf16 v[56:59], v[32:35], v[72:79], v15
  s_waitcnt lgkmcnt(0)
  v_add_f32 v24, v24, v25
  v_add_f32 v25, v26, v27
  v_smfmac_f32_16x16x64_bf16 v[56:59], v[36:39], v[64:71], v15
  v_cvt_pk_bf16_f32 v24, v24, v25
  buffer_store_dword v24, v9, s[4:7], s31 offen
  v_add_f32 v28, v28, v29
  v_add_f32 v29, v30, v31
  v_cvt_pk_bf16_f32 v42, v28, v29
  s_nop 2
  v_add_f32 v56, v56, v57
  v_add_f32 v57, v58, v59
  v_cvt_pk_bf16_f32 v43, v56, v57
  buffer_store_dwordx4 v[40:43], v11, s[4:7], s44 offen
  ds_read_b128 v[60:63], v0 offset:32768
  ds_read_b128 v[64:67], v0 offset:33792
  ds_read_b128 v[68:71], v0 offset:34816
  ds_read_b128 v[72:75], v0 offset:35840
  ds_read_b128 v[80:83], v0 offset:0
  ds_read_b128 v[84:87], v0 offset:1024
  ds_read_b128 v[88:91], v0 offset:2048
  ds_read_b128 v[92:95], v0 offset:3072
  s_add_u32 s44, s44, s46
  s_add_u32 s37, s37, 1
  s_sub_u32 s46, 0, s46
  s_branch L_rF3
L_rMF3:
  s_add_u32 s31, s42, 16515072
  s_waitcnt lgkmcnt(0)
  s_nop 7
  s_nop 7
  buffer_load_dwordx4 v[80:83], v6, s[4:7], s31 offen offset:0
  buffer_load_dwordx4 v[84:87], v6, s[4:7], s31 offen offset:1024
  ds_read_b128 v[24:27], v6 offset:0
  ds_read_b128 v[28:31], v6 offset:1024
  ds_read_b128 v[88:91], v6 offset:2048
  ds_read_b128 v[92:95], v6 offset:3072
  s_waitcnt vmcnt(0) lgkmcnt(0)
  v_pk_add_f32 v[24:25], v[24:25], v[28:29]
  v_pk_add_f32 v[26:27], v[26:27], v[30:31]
  v_pk_add_f32 v[88:89], v[88:89], v[92:93]
  v_pk_add_f32 v[90:91], v[90:91], v[94:95]
  v_pk_add_f32 v[24:25], v[24:25], v[88:89]
  v_pk_add_f32 v[26:27], v[26:27], v[90:91]
  v_max3_f32 v57, v24, v25, v26
  v_max3_f32 v57, v27, v56, v57
  s_nop 1
  v_mov_b32_dpp v44, v57 quad_perm:[1,0,3,2] row_mask:0xf bank_mask:0xf
  v_max_f32 v57, v57, v44
  v_mov_b32 v44, v57
  s_nop 1
  v_permlane16_swap_b32 v44, v57
  v_max_f32 v57, v57, v44
  v_mov_b32 v44, v57
  s_nop 1
  v_permlane32_swap_b32 v44, v57
  v_max_f32 v57, v57, v44
  v_sub_f32 v24, v24, v57
  v_sub_f32 v25, v25, v57
  v_sub_f32 v26, v26, v57
  v_sub_f32 v27, v27, v57
  v_sub_f32 v56, v56, v57
  v_exp_f32 v28, v24
  v_exp_f32 v29, v25
  v_exp_f32 v30, v26
  v_exp_f32 v31, v27
  v_max3_f32 v57, |v24|, |v25|, |v26|
  v_cvt_pk_bf16_f32 v28, v28, v29
  v_cvt_pk_bf16_f32 v29, v30, v31
  v_max_f32 v57, |v27|, v57
  v_mov_b32_dpp v24, v28 quad_perm:[0,0,2,2] row_mask:0xf bank_mask:0xf
  v_mov_b32_dpp v25, v29 quad_perm:[0,0,2,2] row_mask:0xf bank_mask:0xf
  v_mov_b32_dpp v26, v28 quad_perm:[1,1,3,3] row_mask:0xf bank_mask:0xf
  v_mov_b32_dpp v27, v29 quad_perm:[1,1,3,3] row_mask:0xf bank_mask:0xf
  s_nop 1
  v_mfma_f32_16x16x32_bf16 v[28:31], v[20:23], v[24:27], 0
  v_mfma_f32_16x16x32_bf16 v[88:91], v[80:83], v[24:27], 0
  v_exp_f32 v36, v56
  v_mfma_f32_16x16x32_bf16 v[92:95], v[84:87], v[24:27], 0
  s_nop 0
  v_mov_b32_dpp v37, v36 quad_perm:[0,0,2,2] row_mask:0xf bank_mask:0xf
  v_mov_b32_dpp v38, v36 quad_perm:[1,1,3,3] row_mask:0xf bank_mask:0xf
  v_cvt_pk_bf16_f32 v32, v37, v38
  v_cvt_pk_bf16_f32 v35, v37, v38
  s_nop 0
  v_mfma_f32_16x16x16_bf16 v[28:31], v[20:21], v[32:33], v[28:31]
  v_mfma_f32_16x16x16_bf16 v[88:91], v[58:59], v[32:33], v[88:91]
  v_mfma_f32_16x16x16_bf16 v[92:95], v[58:59], v[34:35], v[92:95]
  ds_read_b128 v[80:83], v0 offset:16384
  ds_read_b128 v[84:87], v0 offset:20480
  s_nop 7
  s_nop 7
  s_branch L_rMbF3
L_rS:
  s_cmp_lt_u32 s38, 40
  s_cbranch_scc1 L_rSR
  s_cmp_eq_u32 s28, 2
  s_cbranch_scc1 L_rS2
  v_mov_b32 v13, 0
  s_cmp_eq_u32 s28, 3
  s_cbranch_scc1 L_rS3
L_rSN:
  s_barrier
  s_sleep 3
  buffer_load_dwordx4 v[76:79], v4, s[4:7], s39 offen sc1
  buffer_load_dword v14, v5, s[4:7], s39 offen sc1
  s_waitcnt vmcnt(3)
  v_mov_b64 v[24:25], 0
  v_mov_b64 v[26:27], 0
  v_mov_b64 v[28:29], 0
  v_mov_b64 v[30:31], 0
  v_mov_b64 v[32:33], 0
  v_mov_b64 v[34:35], 0
  v_mov_b64 v[36:37], 0
  v_mov_b64 v[38:39], 0
  v_mov_b64 v[40:41], 0
  v_mov_b64 v[42:43], 0
  v_mov_b64 v[44:45], 0
  v_mov_b64 v[46:47], 0
  s_waitcnt vmcnt(0)
L_47:
  ds_write_b128 v4, v[76:79] offset:0
  ds_write_b32 v5, v14 offset:0
  v_max3_u32 v48, v76, v77, v14
  v_max3_u32 v48, v78, v79, v48
  v_cmp_eq_u32 vcc, -1, v48
  s_cbranch_vccz L_48
  buffer_load_dwordx4 v[76:79], v4, s[4:7], s39 offen sc1
  buffer_load_dword v14, v5, s[4:7], s39 offen sc1
  s_waitcnt vmcnt(0)
  s_sub_u32 s30, s30, 1
  s_cbranch_scc0 L_47
  s_mov_b32 s30, 0
L_48:
  s_waitcnt lgkmcnt(0)
  s_barrier
  ds_read_b128 v[48:51], v1 offset:0
  ds_read_b128 v[52:55], v1 offset:1024
  ds_read_b128 v[56:59], v1 offset:2048
  s_add_u32 s31, s42, 16777216
  buffer_load_dwordx4 v[76:79], v4, s[4:7], s40 offen sc1
  buffer_load_dword v14, v5, s[4:7], s40 offen sc1
  s_waitcnt lgkmcnt(2)
  v_smfmac_f32_16x16x64_bf16 v[32:35], v[48:51], v[60:67], v15
  ds_read_b128 v[60:63], v0 offset:4096
  ds_read_b128 v[64:67], v0 offset:5120
  v_smfmac_f32_16x16x64_bf16 v[24:27], v[48:51], a[0:7], v15
  v_smfmac_f32_16x16x64_bf16 v[40:43], v[48:51], a[160:167], v15
  v_smfmac_f32_16x16x64_bf16 v[36:39], v[48:51], v[68:75], v15
  ds_read_b128 v[68:71], v0 offset:6144
  ds_read_b128 v[72:75], v0 offset:7168
  v_smfmac_f32_16x16x64_bf16 v[28:31], v[48:51], a[8:15], v15
  v_smfmac_f32_16x16x64_bf16 v[44:47], v[48:51], a[168:175], v15
  ds_read_b128 v[48:51], v1 offset:3072
  s_waitcnt lgkmcnt(6)
  v_smfmac_f32_16x16x64_bf16 v[32:35], v[52:55], v[80:87], v15
  ds_read_b128 v[80:83], v0 offset:8192
  ds_read_b128 v[84:87], v0 offset:9216
  v_smfmac_f32_16x16x64_bf16 v[24:27], v[52:55], a[16:23], v15
  v_smfmac_f32_16x16x64_bf16 v[40:43], v[52:55], a[176:183], v15
  v_smfmac_f32_16x16x64_bf16 v[36:39], v[52:55], v[88:95], v15
  ds_read_b128 v[88:91], v0 offset:10240
  ds_read_b128 v[92:95], v0 offset:11264
  v_smfmac_f32_16x16x64_bf16 v[28:31], v[52:55], a[24:31], v15
  v_smfmac_f32_16x16x64_bf16 v[44:47], v[52:55], a[184:191], v15
  ds_read_b128 v[52:55], v1 offset:4096
  s_waitcnt lgkmcnt(10)
  s_waitcnt lgkmcnt(8)
  v_smfmac_f32_16x16x64_bf16 v[32:35], v[56:59], v[60:67], v15
  ds_read_b128 v[60:63], v0 offset:12288
  ds_read_b128 v[64:67], v0 offset:13312
  v_smfmac_f32_16x16x64_bf16 v[24:27], v[56:59], a[32:39], v15
  s_waitcnt lgkmcnt(8)
  v_smfmac_f32_16x16x64_bf16 v[36:39], v[56:59], v[68:75], v15
  ds_read_b128 v[68:71], v0 offset:14336
  ds_read_b128 v[72:75], v0 offset:15360
  v_smfmac_f32_16x16x64_bf16 v[28:31], v[56:59], a[40:47], v15
  s_waitcnt lgkmcnt(9)
  s_waitcnt lgkmcnt(7)
  v_smfmac_f32_16x16x64_bf16 v[32:35], v[48:51], v[80:87], v15
  v_smfmac_f32_16x16x64_bf16 v[24:27], v[48:51], a[48:55], v15
  s_waitcnt lgkmcnt(5)
  v_smfmac_f32_16x16x64_bf16 v[36:39], v[48:51], v[88:95], v15
  buffer_load_dwordx4 v[80:83], v6, s[4:7], s31 offen offset:0
  v_smfmac_f32_16x16x64_bf16 v[28:31], v[48:51], a[56:63], v15
  buffer_load_dwordx4 v[88:91], v6, s[4:7], s42 offen offset:0
  s_waitcnt vmcnt(2)
L_49:
  ds_write_b128 v4, v[76:79] offset:5120
  ds_write_b32 v5, v14 offset:5120
  v_max3_u32 v14, v76, v77, v14
  v_max3_u32 v14, v78, v79, v14
  v_cmp_eq_u32 vcc, -1, v14
  s_cbranch_vccz L_50
  buffer_load_dwordx4 v[76:79], v4, s[4:7], s40 offen sc1
  buffer_load_dword v14, v5, s[4:7], s40 offen sc1
  s_waitcnt vmcnt(0)
  s_sub_u32 s30, s30, 1
  s_cbranch_scc0 L_49
  s_mov_b32 s30, 0
L_50:
  s_waitcnt lgkmcnt(2)
  v_smfmac_f32_16x16x64_bf16 v[32:35], v[52:55], v[60:67], v15
  buffer_load_dwordx4 v[92:95], v6, s[4:7], s42 offen offset:1024
  v_smfmac_f32_16x16x64_bf16 v[36:39], v[52:55], v[68:75], v15
  buffer_load_dwordx4 v[84:87], v6, s[4:7], s31 offen offset:1024
  s_waitcnt lgkmcnt(0)
  s_add_u32 s42, s42, 262144
  s_add_u32 s41, s41, 5120
  s_barrier
  ds_read_b128 v[60:63], v1 offset:5120
  ds_read_b128 v[64:67], v1 offset:6144
  ds_read_b128 v[68:71], v1 offset:7168
  ds_read_b128 v[72:75], v1 offset:8192
  ds_read_b128 v[76:79], v1 offset:9216
  v_smfmac_f32_16x16x64_bf16 v[24:27], v[52:55], a[64:71], v15
  buffer_store_dwordx2 v[2:3], v8, s[4:7], s43 offen sc1
  v_smfmac_f32_16x16x64_bf16 v[28:31], v[52:55], a[72:79], v15
  s_add_u32 s43, s43, 65536
  s_add_u32 s39, s39, 32768
  v_smfmac_f32_16x16x64_bf16 v[40:43], v[56:59], a[192:199], v15
  s_add_u32 s40, s40, 32768
  s_add_u32 s29, s29, 32768
  v_smfmac_f32_16x16x64_bf16 v[44:47], v[56:59], a[200:207], v15
  v_smfmac_f32_16x16x64_bf16 v[40:43], v[48:51], a[208:215], v15
  v_smfmac_f32_16x16x64_bf16 v[44:47], v[48:51], a[216:223], v15
  v_smfmac_f32_16x16x64_bf16 v[40:43], v[52:55], a[224:231], v15
  v_smfmac_f32_16x16x64_bf16 v[44:47], v[52:55], a[232:239], v15
  s_waitcnt lgkmcnt(4)
  v_smfmac_f32_16x16x64_bf16 v[24:27], v[60:63], a[80:87], v15
  v_smfmac_f32_16x16x64_bf16 v[28:31], v[60:63], a[88:95], v15
  s_waitcnt lgkmcnt(3)
  v_smfmac_f32_16x16x64_bf16 v[24:27], v[64:67], a[96:103], v15
  v_smfmac_f32_16x16x64_bf16 v[28:31], v[64:67], a[104:111], v15
  s_waitcnt lgkmcnt(2)
  v_smfmac_f32_16x16x64_bf16 v[24:27], v[68:71], a[112:119], v15
  v_smfmac_f32_16x16x64_bf16 v[28:31], v[68:71], a[120:127], v15
  s_waitcnt lgkmcnt(1)
  v_smfmac_f32_16x16x64_bf16 v[24:27], v[72:75], a[128:135], v15
  v_smfmac_f32_16x16x64_bf16 v[28:31], v[72:75], a[136:143], v15
  s_waitcnt lgkmcnt(0)
  v_smfmac_f32_16x16x64_bf16 v[24:27], v[76:79], a[144:151], v15
  v_smfmac_f32_16x16x64_bf16 v[28:31], v[76:79], a[152:159], v15
  v_smfmac_f32_16x16x64_bf16 v[32:35], v[60:63], v[160:167], v15
  v_smfmac_f32_16x16x64_bf16 v[36:39], v[60:63], v[168:175], v15
  v_add_f32 v24, v24, v25
  v_add_f32 v25, v26, v27
  v_smfmac_f32_16x16x64_bf16 v[32:35], v[64:67], v[176:183], v15
  v_add_f32 v26, v28, v29
  v_add_f32 v27, v30, v31
  v_smfmac_f32_16x16x64_bf16 v[36:39], v[64:67], v[184:191], v15
  v_pk_mul_f32 v[24:25], v[24:25], s[48:49] op_sel:[0,1] op_sel_hi:[1,1]
  v_pk_mul_f32 v[26:27], v[26:27], s[48:49] op_sel:[0,1] op_sel_hi:[1,1]
  v_smfmac_f32_16x16x64_bf16 v[32:35], v[68:71], v[192:199], v15
  v_cvt_pk_bf16_f32 v48, v24, v25
  v_cvt_pk_bf16_f32 v49, v26, v27
  v_smfmac_f32_16x16x64_bf16 v[36:39], v[68:71], v[200:207], v15
  v_mfma_f32_16x16x16_bf16 v[24:27], v[48:49], v[16:17], 0
  v_mfma_f32_16x16x16_bf16 v[28:31], v[48:49], v[18:19], 0
  v_smfmac_f32_16x16x64_bf16 v[32:35], v[72:75], v[208:215], v15
  v_smfmac_f32_16x16x64_bf16 v[36:39], v[72:75], v[216:223], v15
  v_cvt_pk_bf16_f32 v52, v24, v25
  v_cvt_pk_bf16_f32 v53, v26, v27
  v_smfmac_f32_16x16x64_bf16 v[32:35], v[76:79], v[224:231], v15
  v_cvt_pk_bf16_f32 v54, v28, v29
  v_cvt_pk_bf16_f32 v55, v30, v31
  v_smfmac_f32_16x16x64_bf16 v[36:39], v[76:79], v[232:239], v15
  s_waitcnt vmcnt(1)
  v_mfma_f32_16x16x32_bf16 v[24:27], v[88:91], v[52:55], 0
  v_mfma_f32_16x16x32_bf16 v[28:31], v[92:95], v[52:55], 0
  v_add_f32 v32, v32, v33
  v_add_f32 v33, v34, v35
  v_cvt_pk_bf16_f32 v50, v32, v33
  v_add_f32 v34, v36, v37
  v_add_f32 v35, v38, v39
  v_cvt_pk_bf16_f32 v51, v34, v35
  s_nop 1
  v_cndmask_b32 v24, v24, v28, s[52:53]
  v_cndmask_b32 v25, v25, v29, s[52:53]
  v_mfma_f32_16x16x16_bf16 v[32:35], v[50:51], v[16:17], 0
  v_cndmask_b32 v26, v26, v30, s[52:53]
  v_cndmask_b32 v27, v27, v31, s[52:53]
  ds_write_b128 v4, v[24:27]
  v_mfma_f32_16x16x16_bf16 v[36:39], v[50:51], v[18:19], 0
  v_mov_b64 v[2:3], v[50:51]
  v_smfmac_f32_16x16x64_bf16 v[40:43], v[60:63], a[240:247], v15
  s_nop 1
  v_cvt_pk_bf16_f32 v56, v32, v33
  v_cvt_pk_bf16_f32 v57, v34, v35
  s_nop 1
  v_cvt_pk_bf16_f32 v58, v36, v37
  v_cvt_pk_bf16_f32 v59, v38, v39
  v_smfmac_f32_16x16x64_bf16 v[44:47], v[60:63], a[248:255], v15
  v_mfma_f32_16x16x32_bf16 v[32:35], v[56:59], v[52:55], 0
  s_waitcnt lgkmcnt(0)
  s_barrier
  ds_read_b128 v[24:27], v6 offset:0
  ds_read_b128 v[28:31], v6 offset:1024
  ds_read_b128 v[88:91], v6 offset:2048
  ds_read_b128 v[92:95], v6 offset:3072
  v_smfmac_f32_16x16x64_bf16 v[40:43], v[64:67], v[96:103], v15
  s_nop 0
  v_cndmask_b32 v48, v32, v34, s[52:53]
  ds_write_b32 v5, v48
  v_smfmac_f32_16x16x64_bf16 v[44:47], v[64:67], v[104:111], v15
  v_mov_b32 v33, 0
  v_smfmac_f32_16x16x64_bf16 v[40:43], v[68:71], v[112:119], v15
  v_mov_b32 v34, 0
  v_smfmac_f32_16x16x64_bf16 v[44:47], v[68:71], v[120:127], v15
  v_smfmac_f32_16x16x64_bf16 v[40:43], v[72:75], v[128:135], v15
  s_waitcnt lgkmcnt(3)
  v_pk_add_f32 v[24:25], v[24:25], v[28:29]
  v_pk_add_f32 v[26:27], v[26:27], v[30:31]
  s_waitcnt lgkmcnt(0)
  s_barrier
  ds_read2st64_b32 v[48:49], v7 offset0:0 offset1:1
  ds_read2st64_b32 v[50:51], v7 offset0:2 offset1:3
  v_pk_add_f32 v[88:89], v[88:89], v[92:93]
  v_pk_add_f32 v[90:91], v[90:91], v[94:95]
  v_smfmac_f32_16x16x64_bf16 v[44:47], v[72:75], v[136:143], v15
  v_pk_add_f32 v[24:25], v[24:25], v[88:89]
  v_pk_add_f32 v[26:27], v[26:27], v[90:91]
  v_smfmac_f32_16x16x64_bf16 v[40:43], v[76:79], v[144:151], v15
  v_exp_f32 v28, v24
  v_exp_f32 v29, v25
  v_smfmac_f32_16x16x64_bf16 v[44:47], v[76:79], v[152:159], v15
  v_exp_f32 v30, v26
  v_exp_f32 v31, v27
  ds_read_b128 v[64:67], v0 offset:17408
  ds_read_b128 v[68:71], v0 offset:21504
  v_max3_f32 v57, |v24|, |v25|, |v26|
  v_cvt_pk_bf16_f32 v28, v28, v29
  v_cvt_pk_bf16_f32 v29, v30, v31
  ds_read_b128 v[72:75], v0 offset:24576
  ds_read_b128 v[76:79], v0 offset:28672
  v_max_f32 v57, |v27|, v57
  v_mov_b32_dpp v24, v28 quad_perm:[0,0,2,2] row_mask:0xf bank_mask:0xf
  v_mov_b32_dpp v25, v29 quad_perm:[0,0,2,2] row_mask:0xf bank_mask:0xf
  v_mov_b32_dpp v26, v28 quad_perm:[1,1,3,3] row_mask:0xf bank_mask:0xf
  v_mov_b32_dpp v27, v29 quad_perm:[1,1,3,3] row_mask:0xf bank_mask:0xf
  s_waitcnt lgkmcnt(4)
  v_pk_add_f32 v[48:49], v[48:49], v[50:51]
  v_mfma_f32_16x16x32_bf16 v[28:31], v[20:23], v[24:27], 0
  v_add_f32 v56, v48, v49
  v_mfma_f32_16x16x32_bf16 v[88:91], v[80:83], v[24:27], 0
  v_exp_f32 v36, v56
  v_mfma_f32_16x16x32_bf16 v[92:95], v[84:87], v[24:27], 0
  ds_read_b128 v[48:51], v0 offset:25600
  ds_read_b128 v[52:55], v0 offset:29696
  v_add_f32 v58, v40, v41
  v_add_f32 v59, v42, v43
  v_mov_b32_dpp v37, v36 quad_perm:[0,0,2,2] row_mask:0xf bank_mask:0xf
  v_mov_b32_dpp v38, v36 quad_perm:[1,1,3,3] row_mask:0xf bank_mask:0xf
  v_add_f32 v44, v44, v45
  v_add_f32 v45, v46, v47
  v_cvt_pk_bf16_f32 v32, v37, v38
  v_cvt_pk_bf16_f32 v35, v37, v38
  v_cvt_pk_bf16_f32 v58, v58, v59
  v_cvt_pk_bf16_f32 v59, v44, v45
  v_mfma_f32_16x16x16_bf16 v[28:31], v[20:21], v[32:33], v[28:31]
  ds_read_b128 v[80:83], v0 offset:16384
  ds_read_b128 v[84:87], v0 offset:20480
  v_max_f32 v57, |v56|, v57
  v_mfma_f32_16x16x16_bf16 v[88:91], v[58:59], v[32:33], v[88:91]
  v_cmp_nge_f32 vcc, s51, v57
  v_mfma_f32_16x16x16_bf16 v[92:95], v[58:59], v[34:35], v[92:95]
  s_cbranch_vccnz L_rMSN
L_rMbSN:
  s_nop 0
  v_rcp_f32 v28, v28
  v_cndmask_b32 v2, v2, v58, s[26:27]
  v_cndmask_b32 v3, v3, v59, s[26:27]
  s_cmp_eq_u32 s37, 63
  s_cbranch_scc1 L_rX
  s_nop 0
  v_cndmask_b32 v40, v88, v92, s[52:53]
  v_cndmask_b32 v41, v89, v93, s[52:53]
  v_cndmask_b32 v42, v90, v94, s[52:53]
  v_cndmask_b32 v43, v91, v95, s[52:53]
  v_pk_mul_f32 v[40:41], v[40:41], v[28:29] op_sel_hi:[1,0]
  v_pk_mul_f32 v[42:43], v[42:43], v[28:29] op_sel_hi:[1,0]
  v_cvt_pk_bf16_f32 v40, v40, v41
  v_cvt_pk_bf16_f32 v41, v42, v43
  ds_write_b64 v8, v[40:41]
  v_mov_b64 v[44:45], 0
  v_mov_b64 v[46:47], 0
  v_mov_b64 v[60:61], 0
  v_mov_b64 v[62:63], 0
  s_waitcnt lgkmcnt(0)
  s_barrier
  ds_read_b128 v[32:35], v6 offset:10240
  ds_read_b128 v[36:39], v6 offset:11264
  ds_read_b128 v[88:91], v0 offset:18432
  ds_read_b128 v[92:95], v0 offset:22528
  v_mov_b64 v[24:25], 0
  v_mov_b64 v[26:27], 0
  v_mov_b64 v[28:29], 0
  v_mov_b64 v[30:31], 0
  v_mov_b64 v[56:57], 0
  v_mov_b64 v[58:59], 0
  s_add_u32 s31, s44, 32768
  s_waitcnt lgkmcnt(3)
  v_smfmac_f32_16x16x64_bf16 v[44:47], v[32:35], v[80:87], v15
  ds_read_b128 v[80:83], v0 offset:26624
  ds_read_b128 v[84:87], v0 offset:30720
  s_waitcnt lgkmcnt(4)
  v_smfmac_f32_16x16x64_bf16 v[44:47], v[36:39], v[72:79], v15
  ds_read_b128 v[72:75], v0 offset:19456
  ds_read_b128 v[76:79], v0 offset:23552
  v_smfmac_f32_16x16x64_bf16 v[60:63], v[32:35], v[64:71], v15
  ds_read_b128 v[64:67], v0 offset:27648
  ds_read_b128 v[68:71], v0 offset:31744
  v_smfmac_f32_16x16x64_bf16 v[60:63], v[36:39], v[48:55], v15
  v_smfmac_f32_16x16x64_bf16 v[24:27], v[32:35], v[240:247], v15
  v_add_f32 v44, v44, v45
  v_add_f32 v45, v46, v47
  v_smfmac_f32_16x16x64_bf16 v[24:27], v[36:39], v[248:255], v15
  v_cvt_pk_bf16_f32 v40, v44, v45
  s_waitcnt lgkmcnt(6)
  v_smfmac_f32_16x16x64_bf16 v[28:31], v[32:35], v[88:95], v15
  s_waitcnt lgkmcnt(4)
  v_add_f32 v60, v60, v61
  v_add_f32 v61, v62, v63
  v_smfmac_f32_16x16x64_bf16 v[28:31], v[36:39], v[80:87], v15
  v_cvt_pk_bf16_f32 v41, v60, v61
  s_waitcnt lgkmcnt(2)
  v_smfmac_f32_16x16x64_bf16 v[56:59], v[32:35], v[72:79], v15
  s_waitcnt lgkmcnt(0)
  v_add_f32 v24, v24, v25
  v_add_f32 v25, v26, v27
  v_smfmac_f32_16x16x64_bf16 v[56:59], v[36:39], v[64:71], v15
  v_cvt_pk_bf16_f32 v24, v24, v25
  buffer_store_dword v24, v9, s[4:7], s31 offen sc1
  v_add_f32 v28, v28, v29
  v_add_f32 v29, v30, v31
  v_cvt_pk_bf16_f32 v42, v28, v29
  s_nop 2
  v_add_f32 v56, v56, v57
  v_add_f32 v57, v58, v59
  v_cvt_pk_bf16_f32 v43, v56, v57
  buffer_store_dwordx4 v[40:43], v11, s[4:7], s44 offen sc1
  ds_read_b128 v[60:63], v0 offset:32768
  ds_read_b128 v[64:67], v0 offset:33792
  ds_read_b128 v[68:71], v0 offset:34816
  ds_read_b128 v[72:75], v0 offset:35840
  ds_read_b128 v[80:83], v0 offset:0
  ds_read_b128 v[84:87], v0 offset:1024
  ds_read_b128 v[88:91], v0 offset:2048
  ds_read_b128 v[92:95], v0 offset:3072
  s_add_u32 s44, s44, s46
  s_add_u32 s37, s37, 1
  s_sub_u32 s46, 0, s46
  s_branch L_rSN
L_rMSN:
  s_add_u32 s31, s42, 16515072
  s_waitcnt lgkmcnt(0)
  s_nop 7
  s_nop 7
  buffer_load_dwordx4 v[80:83], v6, s[4:7], s31 offen offset:0
  buffer_load_dwordx4 v[84:87], v6, s[4:7], s31 offen offset:1024
  ds_read_b128 v[24:27], v6 offset:0
  ds_read_b128 v[28:31], v6 offset:1024
  ds_read_b128 v[88:91], v6 offset:2048
  ds_read_b128 v[92:95], v6 offset:3072
  s_waitcnt vmcnt(0) lgkmcnt(0)
  v_pk_add_f32 v[24:25], v[24:25], v[28:29]
  v_pk_add_f32 v[26:27], v[26:27], v[30:31]
  v_pk_add_f32 v[88:89], v[88:89], v[92:93]
  v_pk_add_f32 v[90:91], v[90:91], v[94:95]
  v_pk_add_f32 v[24:25], v[24:25], v[88:89]
  v_pk_add_f32 v[26:27], v[26:27], v[90:91]
  v_max3_f32 v57, v24, v25, v26
  v_max3_f32 v57, v27, v56, v57
  s_nop 1
  v_mov_b32_dpp v44, v57 quad_perm:[1,0,3,2] row_mask:0xf bank_mask:0xf
  v_max_f32 v57, v57, v44
  v_mov_b32 v44, v57
  s_nop 1
  v_permlane16_swap_b32 v44, v57
  v_max_f32 v57, v57, v44
  v_mov_b32 v44, v57
  s_nop 1
  v_permlane32_swap_b32 v44, v57
  v_max_f32 v57, v57, v44
  v_sub_f32 v24, v24, v57
  v_sub_f32 v25, v25, v57
  v_sub_f32 v26, v26, v57
  v_sub_f32 v27, v27, v57
  v_sub_f32 v56, v56, v57
  v_exp_f32 v28, v24
  v_exp_f32 v29, v25
  v_exp_f32 v30, v26
  v_exp_f32 v31, v27
  v_max3_f32 v57, |v24|, |v25|, |v26|
  v_cvt_pk_bf16_f32 v28, v28, v29
  v_cvt_pk_bf16_f32 v29, v30, v31
  v_max_f32 v57, |v27|, v57
  v_mov_b32_dpp v24, v28 quad_perm:[0,0,2,2] row_mask:0xf bank_mask:0xf
  v_mov_b32_dpp v25, v29 quad_perm:[0,0,2,2] row_mask:0xf bank_mask:0xf
  v_mov_b32_dpp v26, v28 quad_perm:[1,1,3,3] row_mask:0xf bank_mask:0xf
  v_mov_b32_dpp v27, v29 quad_perm:[1,1,3,3] row_mask:0xf bank_mask:0xf
  s_nop 1
  v_mfma_f32_16x16x32_bf16 v[28:31], v[20:23], v[24:27], 0
  v_mfma_f32_16x16x32_bf16 v[88:91], v[80:83], v[24:27], 0
  v_exp_f32 v36, v56
  v_mfma_f32_16x16x32_bf16 v[92:95], v[84:87], v[24:27], 0
  s_nop 0
  v_mov_b32_dpp v37, v36 quad_perm:[0,0,2,2] row_mask:0xf bank_mask:0xf
  v_mov_b32_dpp v38, v36 quad_perm:[1,1,3,3] row_mask:0xf bank_mask:0xf
  v_cvt_pk_bf16_f32 v32, v37, v38
  v_cvt_pk_bf16_f32 v35, v37, v38
  s_nop 0
  v_mfma_f32_16x16x16_bf16 v[28:31], v[20:21], v[32:33], v[28:31]
  v_mfma_f32_16x16x16_bf16 v[88:91], v[58:59], v[32:33], v[88:91]
  v_mfma_f32_16x16x16_bf16 v[92:95], v[58:59], v[34:35], v[92:95]
  ds_read_b128 v[80:83], v0 offset:16384
  ds_read_b128 v[84:87], v0 offset:20480
  s_nop 7
  s_nop 7
  s_branch L_rMbSN
L_rSR:
  s_barrier
  s_sleep 3
  buffer_load_dwordx4 v[76:79], v4, s[4:7], s39 offen sc1
  buffer_load_dword v14, v5, s[4:7], s39 offen sc1
  s_waitcnt vmcnt(3)
  v_mov_b64 v[24:25], 0
  v_mov_b64 v[26:27], 0
  v_mov_b64 v[28:29], 0
  v_mov_b64 v[30:31], 0
  v_mov_b64 v[32:33], 0
  v_mov_b64 v[34:35], 0
  v_mov_b64 v[36:37], 0
  v_mov_b64 v[38:39], 0
  v_mov_b64 v[40:41], 0
  v_mov_b64 v[42:43], 0
  v_mov_b64 v[44:45], 0
  v_mov_b64 v[46:47], 0
  s_waitcnt vmcnt(0)
L_54:
  ds_write_b128 v4, v[76:79] offset:0
  ds_write_b32 v5, v14 offset:0
  v_max3_u32 v48, v76, v77, v14
  v_max3_u32 v48, v78, v79, v48
  v_cmp_eq_u32 vcc, -1, v48
  s_cbranch_vccz L_55
  buffer_load_dwordx4 v[76:79], v4, s[4:7], s39 offen sc1
  buffer_load_dword v14, v5, s[4:7], s39 offen sc1
  s_waitcnt vmcnt(0)
  s_sub_u32 s30, s30, 1
  s_cbranch_scc0 L_54
  s_mov_b32 s30, 0
L_55:
  s_waitcnt lgkmcnt(0)
  s_barrier
  ds_read_b128 v[48:51], v1 offset:0
  ds_read_b128 v[52:55], v1 offset:1024
  ds_read_b128 v[56:59], v1 offset:2048
  s_add_u32 s31, s42, 16777216
  buffer_load_dwordx4 v[76:79], v4, s[4:7], s40 offen sc1
  buffer_load_dword v14, v5, s[4:7], s40 offen sc1
  s_waitcnt lgkmcnt(2)
  v_smfmac_f32_16x16x64_bf16 v[32:35], v[48:51], v[60:67], v15
  ds_read_b128 v[60:63], v0 offset:4096
  ds_read_b128 v[64:67], v0 offset:5120
  v_smfmac_f32_16x16x64_bf16 v[24:27], v[48:51], a[0:7], v15
  v_smfmac_f32_16x16x64_bf16 v[40:43], v[48:51], a[160:167], v15
  v_smfmac_f32_16x16x64_bf16 v[36:39], v[48:51], v[68:75], v15
  ds_read_b128 v[68:71], v0 offset:6144
  ds_read_b128 v[72:75], v0 offset:7168
  v_smfmac_f32_16x16x64_bf16 v[28:31], v[48:51], a[8:15], v15
  v_smfmac_f32_16x16x64_bf16 v[44:47], v[48:51], a[168:175], v15
  ds_read_b128 v[48:51], v1 offset:3072
  s_waitcnt lgkmcnt(6)
  v_smfmac_f32_16x16x64_bf16 v[32:35], v[52:55], v[80:87], v15
  ds_read_b128 v[80:83], v0 offset:8192
  ds_read_b128 v[84:87], v0 offset:9216
  v_smfmac_f32_16x16x64_bf16 v[24:27], v[52:55], a[16:23], v15
  v_smfmac_f32_16x16x64_bf16 v[40:43], v[52:55], a[176:183], v15
  v_smfmac_f32_16x16x64_bf16 v[36:39], v[52:55], v[88:95], v15
  ds_read_b128 v[88:91], v0 offset:10240
  ds_read_b128 v[92:95], v0 offset:11264
  v_smfmac_f32_16x16x64_bf16 v[28:31], v[52:55], a[24:31], v15
  v_smfmac_f32_16x16x64_bf16 v[44:47], v[52:55], a[184:191], v15
  ds_read_b128 v[52:55], v1 offset:4096
  s_waitcnt lgkmcnt(10)
  s_waitcnt lgkmcnt(8)
  v_smfmac_f32_16x16x64_bf16 v[32:35], v[56:59], v[60:67], v15
  ds_read_b128 v[60:63], v0 offset:12288
  ds_read_b128 v[64:67], v0 offset:13312
  v_smfmac_f32_16x16x64_bf16 v[24:27], v[56:59], a[32:39], v15
  s_waitcnt lgkmcnt(8)
  v_smfmac_f32_16x16x64_bf16 v[36:39], v[56:59], v[68:75], v15
  ds_read_b128 v[68:71], v0 offset:14336
  ds_read_b128 v[72:75], v0 offset:15360
  v_smfmac_f32_16x16x64_bf16 v[28:31], v[56:59], a[40:47], v15
  s_waitcnt lgkmcnt(9)
  s_waitcnt lgkmcnt(7)
  v_smfmac_f32_16x16x64_bf16 v[32:35], v[48:51], v[80:87], v15
  v_smfmac_f32_16x16x64_bf16 v[24:27], v[48:51], a[48:55], v15
  s_waitcnt lgkmcnt(5)
  v_smfmac_f32_16x16x64_bf16 v[36:39], v[48:51], v[88:95], v15
  buffer_load_dwordx4 v[80:83], v6, s[4:7], s31 offen offset:0
  v_smfmac_f32_16x16x64_bf16 v[28:31], v[48:51], a[56:63], v15
  buffer_load_dwordx4 v[88:91], v6, s[4:7], s42 offen offset:0
  s_waitcnt vmcnt(2)
L_56:
  ds_write_b128 v4, v[76:79] offset:5120
  ds_write_b32 v5, v14 offset:5120
  v_max3_u32 v14, v76, v77, v14
  v_max3_u32 v14, v78, v79, v14
  v_cmp_eq_u32 vcc, -1, v14
  s_cbranch_vccz L_57
  buffer_load_dwordx4 v[76:79], v4, s[4:7], s40 offen sc1
  buffer_load_dword v14, v5, s[4:7], s40 offen sc1
  s_waitcnt vmcnt(0)
  s_sub_u32 s30, s30, 1
  s_cbranch_scc0 L_56
  s_mov_b32 s30, 0
L_57:
  s_waitcnt lgkmcnt(2)
  v_smfmac_f32_16x16x64_bf16 v[32:35], v[52:55], v[60:67], v15
  buffer_load_dwordx4 v[92:95], v6, s[4:7], s42 offen offset:1024
  v_smfmac_f32_16x16x64_bf16 v[36:39], v[52:55], v[68:75], v15
  buffer_load_dwordx4 v[84:87], v6, s[4:7], s31 offen offset:1024
  s_waitcnt lgkmcnt(0)
  s_add_u32 s42, s42, 262144
  s_add_u32 s41, s41, 5120
  s_barrier
  ds_read_b128 v[60:63], v1 offset:5120
  ds_read_b128 v[64:67], v1 offset:6144
  ds_read_b128 v[68:71], v1 offset:7168
  ds_read_b128 v[72:75], v1 offset:8192
  ds_read_b128 v[76:79], v1 offset:9216
  v_smfmac_f32_16x16x64_bf16 v[24:27], v[52:55], a[64:71], v15
  buffer_load_dword v14, v10, s[4:7], s41 offen
  v_smfmac_f32_16x16x64_bf16 v[28:31], v[52:55], a[72:79], v15
  buffer_store_dwordx2 v[2:3], v8, s[4:7], s43 offen sc1
  v_smfmac_f32_16x16x64_bf16 v[40:43], v[56:59], a[192:199], v15
  s_add_u32 s43, s43, 65536
  s_add_u32 s39, s39, 32768
  v_smfmac_f32_16x16x64_bf16 v[44:47], v[56:59], a[200:207], v15
  s_add_u32 s40, s40, 32768
  s_add_u32 s29, s29, 32768
  v_smfmac_f32_16x16x64_bf16 v[40:43], v[48:51], a[208:215], v15
  v_smfmac_f32_16x16x64_bf16 v[44:47], v[48:51], a[216:223], v15
  v_smfmac_f32_16x16x64_bf16 v[40:43], v[52:55], a[224:231], v15
  v_smfmac_f32_16x16x64_bf16 v[44:47], v[52:55], a[232:239], v15
  s_waitcnt lgkmcnt(4)
  v_smfmac_f32_16x16x64_bf16 v[24:27], v[60:63], a[80:87], v15
  s_add_u32 s31, s45, s46
  v_mov_b64 v[56:57], -1
  v_smfmac_f32_16x16x64_bf16 v[28:31], v[60:63], a[88:95], v15
  v_mov_b64 v[58:59], -1
  s_waitcnt lgkmcnt(3)
  v_smfmac_f32_16x16x64_bf16 v[24:27], v[64:67], a[96:103], v15
  v_smfmac_f32_16x16x64_bf16 v[28:31], v[64:67], a[104:111], v15
  buffer_store_dwordx4 v[56:59], v6, s[4:7], s31 offen offset:0 sc1
  s_waitcnt lgkmcnt(2)
  v_smfmac_f32_16x16x64_bf16 v[24:27], v[68:71], a[112:119], v15
  v_smfmac_f32_16x16x64_bf16 v[28:31], v[68:71], a[120:127], v15
  buffer_store_dwordx4 v[56:59], v6, s[4:7], s31 offen offset:1024 sc1
  s_waitcnt lgkmcnt(1)
  v_smfmac_f32_16x16x64_bf16 v[24:27], v[72:75], a[128:135], v15
  v_smfmac_f32_16x16x64_bf16 v[28:31], v[72:75], a[136:143], v15
  buffer_store_dwordx4 v[56:59], v6, s[4:7], s31 offen offset:2048 sc1
  s_waitcnt lgkmcnt(0)
  v_smfmac_f32_16x16x64_bf16 v[24:27], v[76:79], a[144:151], v15
  v_smfmac_f32_16x16x64_bf16 v[28:31], v[76:79], a[152:159], v15
  buffer_store_dwordx4 v[56:59], v6, s[4:7], s31 offen offset:3072 sc1
  v_smfmac_f32_16x16x64_bf16 v[32:35], v[60:63], v[160:167], v15
  v_smfmac_f32_16x16x64_bf16 v[36:39], v[60:63], v[168:175], v15
  v_add_f32 v24, v24, v25
  v_add_f32 v25, v26, v27
  v_smfmac_f32_16x16x64_bf16 v[32:35], v[64:67], v[176:183], v15
  v_add_f32 v26, v28, v29
  v_add_f32 v27, v30, v31
  v_smfmac_f32_16x16x64_bf16 v[36:39], v[64:67], v[184:191], v15
  v_pk_mul_f32 v[24:25], v[24:25], s[48:49] op_sel:[0,1] op_sel_hi:[1,1]
  v_pk_mul_f32 v[26:27], v[26:27], s[48:49] op_sel:[0,1] op_sel_hi:[1,1]
  v_smfmac_f32_16x16x64_bf16 v[32:35], v[68:71], v[192:199], v15
  v_cvt_pk_bf16_f32 v48, v24, v25
  v_cvt_pk_bf16_f32 v49, v26, v27
  v_smfmac_f32_16x16x64_bf16 v[36:39], v[68:71], v[200:207], v15
  v_mfma_f32_16x16x16_bf16 v[24:27], v[48:49], v[16:17], 0
  v_mfma_f32_16x16x16_bf16 v[28:31], v[48:49], v[18:19], 0
  v_smfmac_f32_16x16x64_bf16 v[32:35], v[72:75], v[208:215], v15
  v_smfmac_f32_16x16x64_bf16 v[36:39], v[72:75], v[216:223], v15
  v_cvt_pk_bf16_f32 v52, v24, v25
  v_cvt_pk_bf16_f32 v53, v26, v27
  v_smfmac_f32_16x16x64_bf16 v[32:35], v[76:79], v[224:231], v15
  v_cvt_pk_bf16_f32 v54, v28, v29
  v_cvt_pk_bf16_f32 v55, v30, v31
  v_smfmac_f32_16x16x64_bf16 v[36:39], v[76:79], v[232:239], v15
  s_waitcnt vmcnt(6)
  v_mfma_f32_16x16x32_bf16 v[24:27], v[88:91], v[52:55], 0
  v_mfma_f32_16x16x32_bf16 v[28:31], v[92:95], v[52:55], 0
  v_add_f32 v32, v32, v33
  v_add_f32 v33, v34, v35
  v_cvt_pk_bf16_f32 v50, v32, v33
  v_add_f32 v34, v36, v37
  v_add_f32 v35, v38, v39
  v_cvt_pk_bf16_f32 v51, v34, v35
  s_nop 1
  v_cndmask_b32 v24, v24, v28, s[52:53]
  v_cndmask_b32 v25, v25, v29, s[52:53]
  v_mfma_f32_16x16x16_bf16 v[32:35], v[50:51], v[16:17], 0
  v_cndmask_b32 v26, v26, v30, s[52:53]
  v_cndmask_b32 v27, v27, v31, s[52:53]
  ds_write_b128 v4, v[24:27]
  v_mfma_f32_16x16x16_bf16 v[36:39], v[50:51], v[18:19], 0
  v_mov_b64 v[2:3], v[50:51]
  v_smfmac_f32_16x16x64_bf16 v[40:43], v[60:63], a[240:247], v15
  s_nop 1
  v_cvt_pk_bf16_f32 v56, v32, v33
  v_cvt_pk_bf16_f32 v57, v34, v35
  s_nop 1
  v_cvt_pk_bf16_f32 v58, v36, v37
  v_cvt_pk_bf16_f32 v59, v38, v39
  v_smfmac_f32_16x16x64_bf16 v[44:47], v[60:63], a[248:255], v15
  v_mfma_f32_16x16x32_bf16 v[32:35], v[56:59], v[52:55], 0
  s_waitcnt lgkmcnt(0)
  s_barrier
  ds_read_b128 v[24:27], v6 offset:0
  ds_read_b128 v[28:31], v6 offset:1024
  ds_read_b128 v[88:91], v6 offset:2048
  ds_read_b128 v[92:95], v6 offset:3072
  v_smfmac_f32_16x16x64_bf16 v[40:43], v[64:67], v[96:103], v15
  s_nop 0
  v_cndmask_b32 v48, v32, v34, s[52:53]
  ds_write_b32 v5, v48
  v_smfmac_f32_16x16x64_bf16 v[44:47], v[64:67], v[104:111], v15
  v_mov_b32 v33, 0
  v_smfmac_f32_16x16x64_bf16 v[40:43], v[68:71], v[112:119], v15
  v_mov_b32 v34, 0
  v_smfmac_f32_16x16x64_bf16 v[44:47], v[68:71], v[120:127], v15
  v_smfmac_f32_16x16x64_bf16 v[40:43], v[72:75], v[128:135], v15
  s_waitcnt lgkmcnt(3)
  v_pk_add_f32 v[24:25], v[24:25], v[28:29]
  v_pk_add_f32 v[26:27], v[26:27], v[30:31]
  s_waitcnt lgkmcnt(0)
  s_barrier
  ds_read2st64_b32 v[48:49], v7 offset0:0 offset1:1
  ds_read2st64_b32 v[50:51], v7 offset0:2 offset1:3
  v_pk_add_f32 v[88:89], v[88:89], v[92:93]
  v_pk_add_f32 v[90:91], v[90:91], v[94:95]
  v_smfmac_f32_16x16x64_bf16 v[44:47], v[72:75], v[136:143], v15
  v_pk_add_f32 v[24:25], v[24:25], v[88:89]
  v_pk_add_f32 v[26:27], v[26:27], v[90:91]
  v_smfmac_f32_16x16x64_bf16 v[40:43], v[76:79], v[144:151], v15
  v_exp_f32 v28, v24
  v_exp_f32 v29, v25
  v_smfmac_f32_16x16x64_bf16 v[44:47], v[76:79], v[152:159], v15
  v_exp_f32 v30, v26
  v_exp_f32 v31, v27
  ds_read_b128 v[64:67], v0 offset:17408
  ds_read_b128 v[68:71], v0 offset:21504
  v_max3_f32 v57, |v24|, |v25|, |v26|
  v_cvt_pk_bf16_f32 v28, v28, v29
  v_cvt_pk_bf16_f32 v29, v30, v31
  ds_read_b128 v[72:75], v0 offset:24576
  ds_read_b128 v[76:79], v0 offset:28672
  v_max_f32 v57, |v27|, v57
  v_mov_b32_dpp v24, v28 quad_perm:[0,0,2,2] row_mask:0xf bank_mask:0xf
  v_mov_b32_dpp v25, v29 quad_perm:[0,0,2,2] row_mask:0xf bank_mask:0xf
  v_mov_b32_dpp v26, v28 quad_perm:[1,1,3,3] row_mask:0xf bank_mask:0xf
  v_mov_b32_dpp v27, v29 quad_perm:[1,1,3,3] row_mask:0xf bank_mask:0xf
  s_waitcnt lgkmcnt(4)
  v_pk_add_f32 v[48:49], v[48:49], v[50:51]
  v_mfma_f32_16x16x32_bf16 v[28:31], v[20:23], v[24:27], 0
  v_add_f32 v56, v48, v49
  v_mfma_f32_16x16x32_bf16 v[88:91], v[80:83], v[24:27], 0
  v_exp_f32 v36, v56
  v_mfma_f32_16x16x32_bf16 v[92:95], v[84:87], v[24:27], 0
  ds_read_b128 v[48:51], v0 offset:25600
  ds_read_b128 v[52:55], v0 offset:29696
  v_add_f32 v58, v40, v41
  v_add_f32 v59, v42, v43
  v_mov_b32_dpp v37, v36 quad_perm:[0,0,2,2] row_mask:0xf bank_mask:0xf
  v_mov_b32_dpp v38, v36 quad_perm:[1,1,3,3] row_mask:0xf bank_mask:0xf
  v_add_f32 v44, v44, v45
  v_add_f32 v45, v46, v47
  v_cvt_pk_bf16_f32 v32, v37, v38
  v_cvt_pk_bf16_f32 v35, v37, v38
  v_cvt_pk_bf16_f32 v58, v58, v59
  v_cvt_pk_bf16_f32 v59, v44, v45
  v_mfma_f32_16x16x16_bf16 v[28:31], v[20:21], v[32:33], v[28:31]
  ds_read_b128 v[80:83], v0 offset:16384
  ds_read_b128 v[84:87], v0 offset:20480
  v_max_f32 v57, |v56|, v57
  v_mfma_f32_16x16x16_bf16 v[88:91], v[58:59], v[32:33], v[88:91]
  v_cmp_nge_f32 vcc, s51, v57
  v_mfma_f32_16x16x16_bf16 v[92:95], v[58:59], v[34:35], v[92:95]
  s_cbranch_vccnz L_rMSR
L_rMbSR:
  s_nop 0
  v_rcp_f32 v28, v28
  v_cndmask_b32 v2, v2, v58, s[26:27]
  v_cndmask_b32 v3, v3, v59, s[26:27]
  s_cmp_eq_u32 s37, 63
  s_cbranch_scc1 L_rX
  s_nop 0
  v_cndmask_b32 v40, v88, v92, s[52:53]
  v_cndmask_b32 v41, v89, v93, s[52:53]
  v_cndmask_b32 v42, v90, v94, s[52:53]
  v_cndmask_b32 v43, v91, v95, s[52:53]
  v_pk_mul_f32 v[40:41], v[40:41], v[28:29] op_sel_hi:[1,0]
  v_pk_mul_f32 v[42:43], v[42:43], v[28:29] op_sel_hi:[1,0]
  v_cvt_pk_bf16_f32 v40, v40, v41
  v_cvt_pk_bf16_f32 v41, v42, v43
  ds_write_b64 v8, v[40:41]
  v_mov_b64 v[44:45], 0
  v_mov_b64 v[46:47], 0
  v_mov_b64 v[60:61], 0
  v_mov_b64 v[62:63], 0
  s_waitcnt lgkmcnt(0)
  s_barrier
  ds_read_b128 v[32:35], v6 offset:10240
  ds_read_b128 v[36:39], v6 offset:11264
  ds_read_b128 v[88:91], v0 offset:18432
  ds_read_b128 v[92:95], v0 offset:22528
  v_mov_b64 v[24:25], 0
  v_mov_b64 v[26:27], 0
  v_mov_b64 v[28:29], 0
  v_mov_b64 v[30:31], 0
  v_mov_b64 v[56:57], 0
  v_mov_b64 v[58:59], 0
  s_add_u32 s31, s44, 32768
  s_waitcnt lgkmcnt(3)
  v_smfmac_f32_16x16x64_bf16 v[44:47], v[32:35], v[80:87], v15
  ds_read_b128 v[80:83], v0 offset:26624
  ds_read_b128 v[84:87], v0 offset:30720
  s_waitcnt lgkmcnt(4)
  v_smfmac_f32_16x16x64_bf16 v[44:47], v[36:39], v[72:79], v15
  ds_read_b128 v[72:75], v0 offset:19456
  ds_read_b128 v[76:79], v0 offset:23552
  v_smfmac_f32_16x16x64_bf16 v[60:63], v[32:35], v[64:71], v15
  ds_read_b128 v[64:67], v0 offset:27648
  ds_read_b128 v[68:71], v0 offset:31744
  v_smfmac_f32_16x16x64_bf16 v[60:63], v[36:39], v[48:55], v15
  v_smfmac_f32_16x16x64_bf16 v[24:27], v[32:35], v[240:247], v15
  v_add_f32 v44, v44, v45
  v_add_f32 v45, v46, v47
  v_smfmac_f32_16x16x64_bf16 v[24:27], v[36:39], v[248:255], v15
  v_cvt_pk_bf16_f32 v40, v44, v45
  s_waitcnt lgkmcnt(6)
  v_smfmac_f32_16x16x64_bf16 v[28:31], v[32:35], v[88:95], v15
  s_waitcnt lgkmcnt(4)
  v_add_f32 v60, v60, v61
  v_add_f32 v61, v62, v63
  v_smfmac_f32_16x16x64_bf16 v[28:31], v[36:39], v[80:87], v15
  v_cvt_pk_bf16_f32 v41, v60, v61
  s_waitcnt lgkmcnt(2)
  v_smfmac_f32_16x16x64_bf16 v[56:59], v[32:35], v[72:79], v15
  s_waitcnt lgkmcnt(0)
  v_add_f32 v24, v24, v25
  v_add_f32 v25, v26, v27
  v_smfmac_f32_16x16x64_bf16 v[56:59], v[36:39], v[64:71], v15
  v_cvt_pk_bf16_f32 v24, v24, v25
  buffer_store_dword v24, v9, s[4:7], s31 offen sc1
  v_add_f32 v28, v28, v29
  v_add_f32 v29, v30, v31
  v_cvt_pk_bf16_f32 v42, v28, v29
  s_nop 2
  v_add_f32 v56, v56, v57
  v_add_f32 v57, v58, v59
  v_cvt_pk_bf16_f32 v43, v56, v57
  buffer_store_dwordx4 v[40:43], v11, s[4:7], s44 offen sc1
  ds_read_b128 v[60:63], v0 offset:32768
  ds_read_b128 v[64:67], v0 offset:33792
  ds_read_b128 v[68:71], v0 offset:34816
  ds_read_b128 v[72:75], v0 offset:35840
  ds_read_b128 v[80:83], v0 offset:0
  ds_read_b128 v[84:87], v0 offset:1024
  ds_read_b128 v[88:91], v0 offset:2048
  ds_read_b128 v[92:95], v0 offset:3072
  s_add_u32 s44, s44, s46
  s_add_u32 s37, s37, 1
  s_sleep 4
  buffer_load_dwordx4 v[24:27], v6, s[4:7], s45 offen offset:0 sc1
  buffer_load_dwordx4 v[28:31], v6, s[4:7], s45 offen offset:1024 sc1
  buffer_load_dwordx4 v[32:35], v6, s[4:7], s45 offen offset:2048 sc1
  buffer_load_dwordx4 v[36:39], v6, s[4:7], s45 offen offset:3072 sc1
  v_mov_b32 v79, 0x3f80
  v_cndmask_b32 v79, v79, 1.0, s[100:101]
  v_cndmask_b32 v76, 0, v79, s[54:55]
  v_cndmask_b32 v77, 0, v79, s[56:57]
  v_cndmask_b32 v78, 0, v79, s[58:59]
  v_cndmask_b32 v79, 0, v79, s[60:61]
  s_sleep 2
L_58:
  buffer_load_dwordx4 v[40:43], v6, s[4:7], s45 offen offset:0 sc1
  buffer_load_dwordx4 v[44:47], v6, s[4:7], s45 offen offset:1024 sc1
  buffer_load_dwordx4 v[48:51], v6, s[4:7], s45 offen offset:2048 sc1
  buffer_load_dwordx4 v[52:55], v6, s[4:7], s45 offen offset:3072 sc1
  s_waitcnt vmcnt(7)
  v_mfma_f32_16x16x32_bf16 v[56:59], v[76:79], v[24:27], 0
  v_max3_u32 v14, v24, v25, 0
  v_max3_u32 v14, v26, v27, v14
  s_waitcnt vmcnt(6)
  v_mfma_f32_16x16x32_bf16 v[56:59], v[76:79], v[28:31], v[56:59]
  v_max3_u32 v14, v28, v29, v14
  v_max3_u32 v14, v30, v31, v14
  s_waitcnt vmcnt(5)
  v_mfma_f32_16x16x32_bf16 v[56:59], v[76:79], v[32:35], v[56:59]
  v_max3_u32 v14, v32, v33, v14
  v_max3_u32 v14, v34, v35, v14
  s_waitcnt vmcnt(4)
  v_mfma_f32_16x16x32_bf16 v[56:59], v[76:79], v[36:39], v[56:59]
  v_max3_u32 v14, v36, v37, v14
  v_max3_u32 v14, v38, v39, v14
  v_cmp_eq_u32 vcc, -1, v14
  s_nop 3
  s_cbranch_vccz L_59
  buffer_load_dwordx4 v[24:27], v6, s[4:7], s45 offen offset:0 sc1
  buffer_load_dwordx4 v[28:31], v6, s[4:7], s45 offen offset:1024 sc1
  buffer_load_dwordx4 v[32:35], v6, s[4:7], s45 offen offset:2048 sc1
  buffer_load_dwordx4 v[36:39], v6, s[4:7], s45 offen offset:3072 sc1
  s_waitcnt vmcnt(7)
  v_mfma_f32_16x16x32_bf16 v[56:59], v[76:79], v[40:43], 0
  v_max3_u32 v14, v40, v41, 0
  v_max3_u32 v14, v42, v43, v14
  s_waitcnt vmcnt(6)
  v_mfma_f32_16x16x32_bf16 v[56:59], v[76:79], v[44:47], v[56:59]
  v_max3_u32 v14, v44, v45, v14
  v_max3_u32 v14, v46, v47, v14
  s_waitcnt vmcnt(5)
  v_mfma_f32_16x16x32_bf16 v[56:59], v[76:79], v[48:51], v[56:59]
  v_max3_u32 v14, v48, v49, v14
  v_max3_u32 v14, v50, v51, v14
  s_waitcnt vmcnt(4)
  v_mfma_f32_16x16x32_bf16 v[56:59], v[76:79], v[52:55], v[56:59]
  v_max3_u32 v14, v52, v53, v14
  v_max3_u32 v14, v54, v55, v14
  v_cmp_eq_u32 vcc, -1, v14
  s_nop 3
  s_cbranch_vccz L_59
  s_sub_u32 s30, s30, 1
  s_cbranch_scc0 L_58
  s_mov_b32 s30, 0
L_59:
  v_add_f32_dpp v56, v56, v56 row_ror:8 row_mask:0xf bank_mask:0xf
  v_add_f32_dpp v57, v57, v57 row_ror:8 row_mask:0xf bank_mask:0xf
  v_add_f32_dpp v58, v58, v58 row_ror:8 row_mask:0xf bank_mask:0xf
  v_add_f32_dpp v59, v59, v59 row_ror:8 row_mask:0xf bank_mask:0xf
  v_cvt_pk_bf16_f32 v56, v56, v57
  v_cvt_pk_bf16_f32 v57, v58, v59
  buffer_store_dwordx2 v[56:57], v10, s[4:7], s29 offen sc1
  s_add_u32 s45, s45, s46
  s_sub_u32 s46, 0, s46
  s_branch L_rSR
L_rMSR:
  s_add_u32 s31, s42, 16515072
  s_waitcnt lgkmcnt(0)
  s_nop 7
  s_nop 7
  buffer_load_dwordx4 v[80:83], v6, s[4:7], s31 offen offset:0
  buffer_load_dwordx4 v[84:87], v6, s[4:7], s31 offen offset:1024
  ds_read_b128 v[24:27], v6 offset:0
  ds_read_b128 v[28:31], v6 offset:1024
  ds_read_b128 v[88:91], v6 offset:2048
  ds_read_b128 v[92:95], v6 offset:3072
  s_waitcnt vmcnt(0) lgkmcnt(0)
  v_pk_add_f32 v[24:25], v[24:25], v[28:29]
  v_pk_add_f32 v[26:27], v[26:27], v[30:31]
  v_pk_add_f32 v[88:89], v[88:89], v[92:93]
  v_pk_add_f32 v[90:91], v[90:91], v[94:95]
  v_pk_add_f32 v[24:25], v[24:25], v[88:89]
  v_pk_add_f32 v[26:27], v[26:27], v[90:91]
  v_max3_f32 v57, v24, v25, v26
  v_max3_f32 v57, v27, v56, v57
  s_nop 1
  v_mov_b32_dpp v44, v57 quad_perm:[1,0,3,2] row_mask:0xf bank_mask:0xf
  v_max_f32 v57, v57, v44
  v_mov_b32 v44, v57
  s_nop 1
  v_permlane16_swap_b32 v44, v57
  v_max_f32 v57, v57, v44
  v_mov_b32 v44, v57
  s_nop 1
  v_permlane32_swap_b32 v44, v57
  v_max_f32 v57, v57, v44
  v_sub_f32 v24, v24, v57
  v_sub_f32 v25, v25, v57
  v_sub_f32 v26, v26, v57
  v_sub_f32 v27, v27, v57
  v_sub_f32 v56, v56, v57
  v_exp_f32 v28, v24
  v_exp_f32 v29, v25
  v_exp_f32 v30, v26
  v_exp_f32 v31, v27
  v_max3_f32 v57, |v24|, |v25|, |v26|
  v_cvt_pk_bf16_f32 v28, v28, v29
  v_cvt_pk_bf16_f32 v29, v30, v31
  v_max_f32 v57, |v27|, v57
  v_mov_b32_dpp v24, v28 quad_perm:[0,0,2,2] row_mask:0xf bank_mask:0xf
  v_mov_b32_dpp v25, v29 quad_perm:[0,0,2,2] row_mask:0xf bank_mask:0xf
  v_mov_b32_dpp v26, v28 quad_perm:[1,1,3,3] row_mask:0xf bank_mask:0xf
  v_mov_b32_dpp v27, v29 quad_perm:[1,1,3,3] row_mask:0xf bank_mask:0xf
  s_nop 1
  v_mfma_f32_16x16x32_bf16 v[28:31], v[20:23], v[24:27], 0
  v_mfma_f32_16x16x32_bf16 v[88:91], v[80:83], v[24:27], 0
  v_exp_f32 v36, v56
  v_mfma_f32_16x16x32_bf16 v[92:95], v[84:87], v[24:27], 0
  s_nop 0
  v_mov_b32_dpp v37, v36 quad_perm:[0,0,2,2] row_mask:0xf bank_mask:0xf
  v_mov_b32_dpp v38, v36 quad_perm:[1,1,3,3] row_mask:0xf bank_mask:0xf
  v_cvt_pk_bf16_f32 v32, v37, v38
  v_cvt_pk_bf16_f32 v35, v37, v38
  s_nop 0
  v_mfma_f32_16x16x16_bf16 v[28:31], v[20:21], v[32:33], v[28:31]
  v_mfma_f32_16x16x16_bf16 v[88:91], v[58:59], v[32:33], v[88:91]
  v_mfma_f32_16x16x16_bf16 v[92:95], v[58:59], v[34:35], v[92:95]
  ds_read_b128 v[80:83], v0 offset:16384
  ds_read_b128 v[84:87], v0 offset:20480
  s_nop 7
  s_nop 7
  s_branch L_rMbSR
L_rS2:
  s_barrier
  s_sleep 3
  buffer_load_dwordx4 v[76:79], v4, s[4:7], s39 offen sc1
  buffer_load_dword v14, v5, s[4:7], s39 offen sc1
  s_waitcnt vmcnt(3)
  v_mov_b64 v[24:25], 0
  v_mov_b64 v[26:27], 0
  v_mov_b64 v[28:29], 0
  v_mov_b64 v[30:31], 0
  v_mov_b64 v[32:33], 0
  v_mov_b64 v[34:35], 0
  v_mov_b64 v[36:37], 0
  v_mov_b64 v[38:39], 0
  v_mov_b64 v[40:41], 0
  v_mov_b64 v[42:43], 0
  v_mov_b64 v[44:45], 0
  v_mov_b64 v[46:47], 0
  s_waitcnt vmcnt(0)
L_61:
  ds_write_b128 v4, v[76:79] offset:0
  ds_write_b32 v5, v14 offset:0
  v_max3_u32 v48, v76, v77, v14
  v_max3_u32 v48, v78, v79, v48
  v_cmp_eq_u32 vcc, -1, v48
  s_cbranch_vccz L_62
  buffer_load_dwordx4 v[76:79], v4, s[4:7], s39 offen sc1
  buffer_load_dword v14, v5, s[4:7], s39 offen sc1
  s_waitcnt vmcnt(0)
  s_sub_u32 s30, s30, 1
  s_cbranch_scc0 L_61
  s_mov_b32 s30, 0
L_62:
  s_waitcnt lgkmcnt(0)
  s_barrier
  ds_read_b128 v[48:51], v1 offset:0
  ds_read_b128 v[52:55], v1 offset:1024
  ds_read_b128 v[56:59], v1 offset:2048
  s_add_u32 s31, s42, 16777216
  s_add_u32 s32, s37, 1
  s_min_u32 s32, s32, 63
  buffer_load_dwordx4 v[76:79], v4, s[4:7], s40 offen sc1
  buffer_load_dword v14, v5, s[4:7], s40 offen sc1
  s_waitcnt lgkmcnt(2)
  v_smfmac_f32_16x16x64_bf16 v[32:35], v[48:51], v[60:67], v15
  ds_read_b128 v[60:63], v0 offset:4096
  ds_read_b128 v[64:67], v0 offset:5120
  v_smfmac_f32_16x16x64_bf16 v[24:27], v[48:51], a[0:7], v15
  v_smfmac_f32_16x16x64_bf16 v[40:43], v[48:51], a[160:167], v15
  v_smfmac_f32_16x16x64_bf16 v[36:39], v[48:51], v[68:75], v15
  ds_read_b128 v[68:71], v0 offset:6144
  ds_read_b128 v[72:75], v0 offset:7168
  v_smfmac_f32_16x16x64_bf16 v[28:31], v[48:51], a[8:15], v15
  v_smfmac_f32_16x16x64_bf16 v[44:47], v[48:51], a[168:175], v15
  ds_read_b128 v[48:51], v1 offset:3072
  s_waitcnt lgkmcnt(6)
  v_smfmac_f32_16x16x64_bf16 v[32:35], v[52:55], v[80:87], v15
  ds_read_b128 v[80:83], v0 offset:8192
  ds_read_b128 v[84:87], v0 offset:9216
  v_smfmac_f32_16x16x64_bf16 v[24:27], v[52:55], a[16:23], v15
  v_smfmac_f32_16x16x64_bf16 v[40:43], v[52:55], a[176:183], v15
  v_smfmac_f32_16x16x64_bf16 v[36:39], v[52:55], v[88:95], v15
  ds_read_b128 v[88:91], v0 offset:10240
  ds_read_b128 v[92:95], v0 offset:11264
  v_smfmac_f32_16x16x64_bf16 v[28:31], v[52:55], a[24:31], v15
  v_smfmac_f32_16x16x64_bf16 v[44:47], v[52:55], a[184:191], v15
  ds_read_b128 v[52:55], v1 offset:4096
  s_waitcnt lgkmcnt(10)
  s_waitcnt lgkmcnt(8)
  v_smfmac_f32_16x16x64_bf16 v[32:35], v[56:59], v[60:67], v15
  ds_read_b128 v[60:63], v0 offset:12288
  ds_read_b128 v[64:67], v0 offset:13312
  v_smfmac_f32_16x16x64_bf16 v[24:27], v[56:59], a[32:39], v15
  s_waitcnt lgkmcnt(8)
  v_smfmac_f32_16x16x64_bf16 v[36:39], v[56:59], v[68:75], v15
  ds_read_b128 v[68:71], v0 offset:14336
  ds_read_b128 v[72:75], v0 offset:15360
  v_smfmac_f32_16x16x64_bf16 v[28:31], v[56:59], a[40:47], v15
  s_waitcnt lgkmcnt(9)
  s_waitcnt lgkmcnt(7)
  v_smfmac_f32_16x16x64_bf16 v[32:35], v[48:51], v[80:87], v15
  v_smfmac_f32_16x16x64_bf16 v[24:27], v[48:51], a[48:55], v15
  s_waitcnt lgkmcnt(5)
  v_smfmac_f32_16x16x64_bf16 v[36:39], v[48:51], v[88:95], v15
  buffer_load_dwordx4 v[80:83], v6, s[4:7], s31 offen offset:0
  v_smfmac_f32_16x16x64_bf16 v[28:31], v[48:51], a[56:63], v15
  buffer_load_dwordx4 v[88:91], v6, s[4:7], s42 offen offset:0
  s_waitcnt vmcnt(2)
L_63:
  ds_write_b128 v4, v[76:79] offset:5120
  ds_write_b32 v5, v14 offset:5120
  v_max3_u32 v14, v76, v77, v14
  v_max3_u32 v14, v78, v79, v14
  v_cmp_eq_u32 vcc, -1, v14
  s_cbranch_vccz L_64
  buffer_load_dwordx4 v[76:79], v4, s[4:7], s40 offen sc1
  buffer_load_dword v14, v5, s[4:7], s40 offen sc1
  s_waitcnt vmcnt(0)
  s_sub_u32 s30, s30, 1
  s_cbranch_scc0 L_63
  s_mov_b32 s30, 0
L_64:
  s_waitcnt lgkmcnt(2)
  v_smfmac_f32_16x16x64_bf16 v[32:35], v[52:55], v[60:67], v15
  buffer_load_dwordx4 v[92:95], v6, s[4:7], s42 offen offset:1024
  v_smfmac_f32_16x16x64_bf16 v[36:39], v[52:55], v[68:75], v15
  buffer_load_dwordx4 v[84:87], v6, s[4:7], s31 offen offset:1024
  s_waitcnt lgkmcnt(0)
  s_add_u32 s42, s42, 262144
  s_add_u32 s41, s41, 5120
  s_add_u32 s31, s31, 262144
  v_cmp_ge_u32 vcc, s32, v13
  s_barrier
  ds_read_b128 v[60:63], v1 offset:5120
  ds_read_b128 v[64:67], v1 offset:6144
  ds_read_b128 v[68:71], v1 offset:7168
  ds_read_b128 v[72:75], v1 offset:8192
  ds_read_b128 v[76:79], v1 offset:9216
  v_smfmac_f32_16x16x64_bf16 v[24:27], v[52:55], a[64:71], v15
  s_cbranch_vccnz L_rPS2
L_rPbS2:
  buffer_load_dword v14, v10, s[4:7], s42 offen
  v_smfmac_f32_16x16x64_bf16 v[28:31], v[52:55], a[72:79], v15
  buffer_load_dword v14, v10, s[4:7], s31 offen
  v_smfmac_f32_16x16x64_bf16 v[40:43], v[56:59], a[192:199], v15
  buffer_store_dwordx2 v[2:3], v8, s[4:7], s43 offen sc1
  v_smfmac_f32_16x16x64_bf16 v[44:47], v[56:59], a[200:207], v15
  buffer_load_dword v13, v12, s[4:7], s48 offen sc1
  v_smfmac_f32_16x16x64_bf16 v[40:43], v[48:51], a[208:215], v15
  s_add_u32 s43, s43, 65536
  s_add_u32 s39, s39, 32768
  v_smfmac_f32_16x16x64_bf16 v[44:47], v[48:51], a[216:223], v15
  s_add_u32 s40, s40, 32768
  s_add_u32 s29, s29, 32768
  v_smfmac_f32_16x16x64_bf16 v[40:43], v[52:55], a[224:231], v15
  v_smfmac_f32_16x16x64_bf16 v[44:47], v[52:55], a[232:239], v15
  s_waitcnt lgkmcnt(4)
  v_smfmac_f32_16x16x64_bf16 v[24:27], v[60:63], a[80:87], v15
  v_smfmac_f32_16x16x64_bf16 v[28:31], v[60:63], a[88:95], v15
  s_waitcnt lgkmcnt(3)
  v_smfmac_f32_16x16x64_bf16 v[24:27], v[64:67], a[96:103], v15
  v_smfmac_f32_16x16x64_bf16 v[28:31], v[64:67], a[104:111], v15
  s_waitcnt lgkmcnt(2)
  v_smfmac_f32_16x16x64_bf16 v[24:27], v[68:71], a[112:119], v15
  v_smfmac_f32_16x16x64_bf16 v[28:31], v[68:71], a[120:127], v15
  s_waitcnt lgkmcnt(1)
  v_smfmac_f32_16x16x64_bf16 v[24:27], v[72:75], a[128:135], v15
  v_smfmac_f32_16x16x64_bf16 v[28:31], v[72:75], a[136:143], v15
  s_waitcnt lgkmcnt(0)
  v_smfmac_f32_16x16x64_bf16 v[24:27], v[76:79], a[144:151], v15
  v_smfmac_f32_16x16x64_bf16 v[28:31], v[76:79], a[152:159], v15
  v_smfmac_f32_16x16x64_bf16 v[32:35], v[60:63], v[160:167], v15
  v_smfmac_f32_16x16x64_bf16 v[36:39], v[60:63], v[168:175], v15
  v_add_f32 v24, v24, v25
  v_add_f32 v25, v26, v27
  v_smfmac_f32_16x16x64_bf16 v[32:35], v[64:67], v[176:183], v15
  v_add_f32 v26, v28, v29
  v_add_f32 v27, v30, v31
  v_smfmac_f32_16x16x64_bf16 v[36:39], v[64:67], v[184:191], v15
  v_pk_mul_f32 v[24:25], v[24:25], s[48:49] op_sel:[0,1] op_sel_hi:[1,1]
  v_pk_mul_f32 v[26:27], v[26:27], s[48:49] op_sel:[0,1] op_sel_hi:[1,1]
  v_smfmac_f32_16x16x64_bf16 v[32:35], v[68:71], v[192:199], v15
  v_cvt_pk_bf16_f32 v48, v24, v25
  v_cvt_pk_bf16_f32 v49, v26, v27
  v_smfmac_f32_16x16x64_bf16 v[36:39], v[68:71], v[200:207], v15
  v_mfma_f32_16x16x16_bf16 v[24:27], v[48:49], v[16:17], 0
  v_mfma_f32_16x16x16_bf16 v[28:31], v[48:49], v[18:19], 0
  v_smfmac_f32_16x16x64_bf16 v[32:35], v[72:75], v[208:215], v15
  v_smfmac_f32_16x16x64_bf16 v[36:39], v[72:75], v[216:223], v15
  v_cvt_pk_bf16_f32 v52, v24, v25
  v_cvt_pk_bf16_f32 v53, v26, v27
  v_smfmac_f32_16x16x64_bf16 v[32:35], v[76:79], v[224:231], v15
  v_cvt_pk_bf16_f32 v54, v28, v29
  v_cvt_pk_bf16_f32 v55, v30, v31
  v_smfmac_f32_16x16x64_bf16 v[36:39], v[76:79], v[232:239], v15
  s_waitcnt vmcnt(4)
  v_mfma_f32_16x16x32_bf16 v[24:27], v[88:91], v[52:55], 0
  v_mfma_f32_16x16x32_bf16 v[28:31], v[92:95], v[52:55], 0
  v_add_f32 v32, v32, v33
  v_add_f32 v33, v34, v35
  v_cvt_pk_bf16_f32 v50, v32, v33
  v_add_f32 v34, v36, v37
  v_add_f32 v35, v38, v39
  v_cvt_pk_bf16_f32 v51, v34, v35
  s_nop 1
  v_cndmask_b32 v24, v24, v28, s[52:53]
  v_cndmask_b32 v25, v25, v29, s[52:53]
  v_mfma_f32_16x16x16_bf16 v[32:35], v[50:51], v[16:17], 0
  v_cndmask_b32 v26, v26, v30, s[52:53]
  v_cndmask_b32 v27, v27, v31, s[52:53]
  ds_write_b128 v4, v[24:27]
  v_mfma_f32_16x16x16_bf16 v[36:39], v[50:51], v[18:19], 0
  v_mov_b64 v[2:3], v[50:51]
  v_smfmac_f32_16x16x64_bf16 v[40:43], v[60:63], a[240:247], v15
  s_nop 1
  v_cvt_pk_bf16_f32 v56, v32, v33
  v_cvt_pk_bf16_f32 v57, v34, v35
  s_nop 1
  v_cvt_pk_bf16_f32 v58, v36, v37
  v_cvt_pk_bf16_f32 v59, v38, v39
  v_smfmac_f32_16x16x64_bf16 v[44:47], v[60:63], a[248:255], v15
  v_mfma_f32_16x16x32_bf16 v[32:35], v[56:59], v[52:55], 0
  s_waitcnt lgkmcnt(0)
  s_barrier
  ds_read_b128 v[24:27], v6 offset:0
  ds_read_b128 v[28:31], v6 offset:1024
  ds_read_b128 v[88:91], v6 offset:2048
  ds_read_b128 v[92:95], v6 offset:3072
  v_smfmac_f32_16x16x64_bf16 v[40:43], v[64:67], v[96:103], v15
  s_nop 0
  v_cndmask_b32 v48, v32, v34, s[52:53]
  ds_write_b32 v5, v48
  v_smfmac_f32_16x16x64_bf16 v[44:47], v[64:67], v[104:111], v15
  v_mov_b32 v33, 0
  v_smfmac_f32_16x16x64_bf16 v[40:43], v[68:71], v[112:119], v15
  v_mov_b32 v34, 0
  v_smfmac_f32_16x16x64_bf16 v[44:47], v[68:71], v[120:127], v15
  v_smfmac_f32_16x16x64_bf16 v[40:43], v[72:75], v[128:135], v15
  s_waitcnt lgkmcnt(3)
  v_pk_add_f32 v[24:25], v[24:25], v[28:29]
  v_pk_add_f32 v[26:27], v[26:27], v[30:31]
  s_waitcnt lgkmcnt(0)
  s_barrier
  ds_read2st64_b32 v[48:49], v7 offset0:0 offset1:1
  ds_read2st64_b32 v[50:51], v7 offset0:2 offset1:3
  v_pk_add_f32 v[88:89], v[88:89], v[92:93]
  v_pk_add_f32 v[90:91], v[90:91], v[94:95]
  v_smfmac_f32_16x16x64_bf16 v[44:47], v[72:75], v[136:143], v15
  v_pk_add_f32 v[24:25], v[24:25], v[88:89]
  v_pk_add_f32 v[26:27], v[26:27], v[90:91]
  v_smfmac_f32_16x16x64_bf16 v[40:43], v[76:79], v[144:151], v15
  v_exp_f32 v28, v24
  v_exp_f32 v29, v25
  v_smfmac_f32_16x16x64_bf16 v[44:47], v[76:79], v[152:159], v15
  v_exp_f32 v30, v26
  v_exp_f32 v31, v27
  ds_read_b128 v[64:67], v0 offset:17408
  ds_read_b128 v[68:71], v0 offset:21504
  v_max3_f32 v57, |v24|, |v25|, |v26|
  v_cvt_pk_bf16_f32 v28, v28, v29
  v_cvt_pk_bf16_f32 v29, v30, v31
  ds_read_b128 v[72:75], v0 offset:24576
  ds_read_b128 v[76:79], v0 offset:28672
  v_max_f32 v57, |v27|, v57
  v_mov_b32_dpp v24, v28 quad_perm:[0,0,2,2] row_mask:0xf bank_mask:0xf
  v_mov_b32_dpp v25, v29 quad_perm:[0,0,2,2] row_mask:0xf bank_mask:0xf
  v_mov_b32_dpp v26, v28 quad_perm:[1,1,3,3] row_mask:0xf bank_mask:0xf
  v_mov_b32_dpp v27, v29 quad_perm:[1,1,3,3] row_mask:0xf bank_mask:0xf
  s_waitcnt lgkmcnt(4)
  v_pk_add_f32 v[48:49], v[48:49], v[50:51]
  v_mfma_f32_16x16x32_bf16 v[28:31], v[20:23], v[24:27], 0
  v_add_f32 v56, v48, v49
  v_mfma_f32_16x16x32_bf16 v[88:91], v[80:83], v[24:27], 0
  v_exp_f32 v36, v56
  v_mfma_f32_16x16x32_bf16 v[92:95], v[84:87], v[24:27], 0
  ds_read_b128 v[48:51], v0 offset:25600
  ds_read_b128 v[52:55], v0 offset:29696
  v_add_f32 v58, v40, v41
  v_add_f32 v59, v42, v43
  v_mov_b32_dpp v37, v36 quad_perm:[0,0,2,2] row_mask:0xf bank_mask:0xf
  v_mov_b32_dpp v38, v36 quad_perm:[1,1,3,3] row_mask:0xf bank_mask:0xf
  v_add_f32 v44, v44, v45
  v_add_f32 v45, v46, v47
  v_cvt_pk_bf16_f32 v32, v37, v38
  v_cvt_pk_bf16_f32 v35, v37, v38
  v_cvt_pk_bf16_f32 v58, v58, v59
  v_cvt_pk_bf16_f32 v59, v44, v45
  v_mfma_f32_16x16x16_bf16 v[28:31], v[20:21], v[32:33], v[28:31]
  ds_read_b128 v[80:83], v0 offset:16384
  ds_read_b128 v[84:87], v0 offset:20480
  v_max_f32 v57, |v56|, v57
  v_mfma_f32_16x16x16_bf16 v[88:91], v[58:59], v[32:33], v[88:91]
  v_cmp_nge_f32 vcc, s51, v57
  v_mfma_f32_16x16x16_bf16 v[92:95], v[58:59], v[34:35], v[92:95]
  s_cbranch_vccnz L_rMS2
L_rMbS2:
  s_nop 0
  v_rcp_f32 v28, v28
  v_cndmask_b32 v2, v2, v58, s[26:27]
  v_cndmask_b32 v3, v3, v59, s[26:27]
  s_cmp_eq_u32 s37, 63
  s_cbranch_scc1 L_rX
  s_nop 0
  v_cndmask_b32 v40, v88, v92, s[52:53]
  v_cndmask_b32 v41, v89, v93, s[52:53]
  v_cndmask_b32 v42, v90, v94, s[52:53]
  v_cndmask_b32 v43, v91, v95, s[52:53]
  v_pk_mul_f32 v[40:41], v[40:41], v[28:29] op_sel_hi:[1,0]
  v_pk_mul_f32 v[42:43], v[42:43], v[28:29] op_sel_hi:[1,0]
  v_cvt_pk_bf16_f32 v40, v40, v41
  v_cvt_pk_bf16_f32 v41, v42, v43
  ds_write_b64 v8, v[40:41]
  v_mov_b64 v[44:45], 0
  v_mov_b64 v[46:47], 0
  v_mov_b64 v[60:61], 0
  v_mov_b64 v[62:63], 0
  s_waitcnt lgkmcnt(0)
  s_barrier
  ds_read_b128 v[32:35], v6 offset:10240
  ds_read_b128 v[36:39], v6 offset:11264
  ds_read_b128 v[88:91], v0 offset:18432
  ds_read_b128 v[92:95], v0 offset:22528
  v_mov_b64 v[24:25], 0
  v_mov_b64 v[26:27], 0
  v_mov_b64 v[28:29], 0
  v_mov_b64 v[30:31], 0
  v_mov_b64 v[56:57], 0
  v_mov_b64 v[58:59], 0
  s_add_u32 s31, s44, 32768
  s_waitcnt lgkmcnt(3)
  v_smfmac_f32_16x16x64_bf16 v[44:47], v[32:35], v[80:87], v15
  ds_read_b128 v[80:83], v0 offset:26624
  ds_read_b128 v[84:87], v0 offset:30720
  s_waitcnt lgkmcnt(4)
  v_smfmac_f32_16x16x64_bf16 v[44:47], v[36:39], v[72:79], v15
  ds_read_b128 v[72:75], v0 offset:19456
  ds_read_b128 v[76:79], v0 offset:23552
  v_smfmac_f32_16x16x64_bf16 v[60:63], v[32:35], v[64:71], v15
  ds_read_b128 v[64:67], v0 offset:27648
  ds_read_b128 v[68:71], v0 offset:31744
  v_smfmac_f32_16x16x64_bf16 v[60:63], v[36:39], v[48:55], v15
  v_smfmac_f32_16x16x64_bf16 v[24:27], v[32:35], v[240:247], v15
  v_add_f32 v44, v44, v45
  v_add_f32 v45, v46, v47
  v_smfmac_f32_16x16x64_bf16 v[24:27], v[36:39], v[248:255], v15
  v_cvt_pk_bf16_f32 v40, v44, v45
  s_waitcnt lgkmcnt(6)
  v_smfmac_f32_16x16x64_bf16 v[28:31], v[32:35], v[88:95], v15
  s_waitcnt lgkmcnt(4)
  v_add_f32 v60, v60, v61
  v_add_f32 v61, v62, v63
  v_smfmac_f32_16x16x64_bf16 v[28:31], v[36:39], v[80:87], v15
  v_cvt_pk_bf16_f32 v41, v60, v61
  s_waitcnt lgkmcnt(2)
  v_smfmac_f32_16x16x64_bf16 v[56:59], v[32:35], v[72:79], v15
  s_waitcnt lgkmcnt(0)
  v_add_f32 v24, v24, v25
  v_add_f32 v25, v26, v27
  v_smfmac_f32_16x16x64_bf16 v[56:59], v[36:39], v[64:71], v15
  v_cvt_pk_bf16_f32 v24, v24, v25
  buffer_store_dword v24, v9, s[4:7], s31 offen sc1
  v_add_f32 v28, v28, v29
  v_add_f32 v29, v30, v31
  v_cvt_pk_bf16_f32 v42, v28, v29
  s_nop 2
  v_add_f32 v56, v56, v57
  v_add_f32 v57, v58, v59
  v_cvt_pk_bf16_f32 v43, v56, v57
  buffer_store_dwordx4 v[40:43], v11, s[4:7], s44 offen sc1
  ds_read_b128 v[60:63], v0 offset:32768
  ds_read_b128 v[64:67], v0 offset:33792
  ds_read_b128 v[68:71], v0 offset:34816
  ds_read_b128 v[72:75], v0 offset:35840
  ds_read_b128 v[80:83], v0 offset:0
  ds_read_b128 v[84:87], v0 offset:1024
  ds_read_b128 v[88:91], v0 offset:2048
  ds_read_b128 v[92:95], v0 offset:3072
  s_add_u32 s44, s44, s46
  s_add_u32 s37, s37, 1
  s_sub_u32 s46, 0, s46
  s_branch L_rS2
L_rPS2:
wf_68:
  buffer_load_dword v13, v12, s[4:7], s48 offen offset:0 sc1
  s_waitcnt vmcnt(0)
  v_cmp_ge_u32 vcc, s32, v13
  s_cbranch_vccz wf_69
  s_sleep 1
  s_sub_u32 s30, s30, 1
  s_cbranch_scc0 wf_68
  s_mov_b32 s30, 0
wf_69:
  s_branch L_rPbS2
L_rMS2:
  s_add_u32 s31, s42, 16515072
  s_waitcnt lgkmcnt(0)
  s_nop 7
  s_nop 7
  buffer_load_dwordx4 v[80:83], v6, s[4:7], s31 offen offset:0
  buffer_load_dwordx4 v[84:87], v6, s[4:7], s31 offen offset:1024
  ds_read_b128 v[24:27], v6 offset:0
  ds_read_b128 v[28:31], v6 offset:1024
  ds_read_b128 v[88:91], v6 offset:2048
  ds_read_b128 v[92:95], v6 offset:3072
  s_waitcnt vmcnt(0) lgkmcnt(0)
  v_pk_add_f32 v[24:25], v[24:25], v[28:29]
  v_pk_add_f32 v[26:27], v[26:27], v[30:31]
  v_pk_add_f32 v[88:89], v[88:89], v[92:93]
  v_pk_add_f32 v[90:91], v[90:91], v[94:95]
  v_pk_add_f32 v[24:25], v[24:25], v[88:89]
  v_pk_add_f32 v[26:27], v[26:27], v[90:91]
  v_max3_f32 v57, v24, v25, v26
  v_max3_f32 v57, v27, v56, v57
  s_nop 1
  v_mov_b32_dpp v44, v57 quad_perm:[1,0,3,2] row_mask:0xf bank_mask:0xf
  v_max_f32 v57, v57, v44
  v_mov_b32 v44, v57
  s_nop 1
  v_permlane16_swap_b32 v44, v57
  v_max_f32 v57, v57, v44
  v_mov_b32 v44, v57
  s_nop 1
  v_permlane32_swap_b32 v44, v57
  v_max_f32 v57, v57, v44
  v_sub_f32 v24, v24, v57
  v_sub_f32 v25, v25, v57
  v_sub_f32 v26, v26, v57
  v_sub_f32 v27, v27, v57
  v_sub_f32 v56, v56, v57
  v_exp_f32 v28, v24
  v_exp_f32 v29, v25
  v_exp_f32 v30, v26
  v_exp_f32 v31, v27
  v_max3_f32 v57, |v24|, |v25|, |v26|
  v_cvt_pk_bf16_f32 v28, v28, v29
  v_cvt_pk_bf16_f32 v29, v30, v31
  v_max_f32 v57, |v27|, v57
  v_mov_b32_dpp v24, v28 quad_perm:[0,0,2,2] row_mask:0xf bank_mask:0xf
  v_mov_b32_dpp v25, v29 quad_perm:[0,0,2,2] row_mask:0xf bank_mask:0xf
  v_mov_b32_dpp v26, v28 quad_perm:[1,1,3,3] row_mask:0xf bank_mask:0xf
  v_mov_b32_dpp v27, v29 quad_perm:[1,1,3,3] row_mask:0xf bank_mask:0xf
  s_nop 1
  v_mfma_f32_16x16x32_bf16 v[28:31], v[20:23], v[24:27], 0
  v_mfma_f32_16x16x32_bf16 v[88:91], v[80:83], v[24:27], 0
  v_exp_f32 v36, v56
  v_mfma_f32_16x16x32_bf16 v[92:95], v[84:87], v[24:27], 0
  s_nop 0
  v_mov_b32_dpp v37, v36 quad_perm:[0,0,2,2] row_mask:0xf bank_mask:0xf
  v_mov_b32_dpp v38, v36 quad_perm:[1,1,3,3] row_mask:0xf bank_mask:0xf
  v_cvt_pk_bf16_f32 v32, v37, v38
  v_cvt_pk_bf16_f32 v35, v37, v38
  s_nop 0
  v_mfma_f32_16x16x16_bf16 v[28:31], v[20:21], v[32:33], v[28:31]
  v_mfma_f32_16x16x16_bf16 v[88:91], v[58:59], v[32:33], v[88:91]
  v_mfma_f32_16x16x16_bf16 v[92:95], v[58:59], v[34:35], v[92:95]
  ds_read_b128 v[80:83], v0 offset:16384
  ds_read_b128 v[84:87], v0 offset:20480
  s_nop 7
  s_nop 7
  s_branch L_rMbS2
L_rS3:
  s_barrier
  s_sleep 3
  buffer_load_dwordx4 v[76:79], v4, s[4:7], s39 offen sc1
  buffer_load_dword v14, v5, s[4:7], s39 offen sc1
  s_waitcnt vmcnt(3)
  v_mov_b64 v[24:25], 0
  v_mov_b64 v[26:27], 0
  v_mov_b64 v[28:29], 0
  v_mov_b64 v[30:31], 0
  v_mov_b64 v[32:33], 0
  v_mov_b64 v[34:35], 0
  v_mov_b64 v[36:37], 0
  v_mov_b64 v[38:39], 0
  v_mov_b64 v[40:41], 0
  v_mov_b64 v[42:43], 0
  v_mov_b64 v[44:45], 0
  v_mov_b64 v[46:47], 0
  s_waitcnt vmcnt(0)
L_70:
  ds_write_b128 v4, v[76:79] offset:0
  ds_write_b32 v5, v14 offset:0
  v_max3_u32 v48, v76, v77, v14
  v_max3_u32 v48, v78, v79, v48
  v_cmp_eq_u32 vcc, -1, v48
  s_cbranch_vccz L_71
  buffer_load_dwordx4 v[76:79], v4, s[4:7], s39 offen sc1
  buffer_load_dword v14, v5, s[4:7], s39 offen sc1
  s_waitcnt vmcnt(0)
  s_sub_u32 s30, s30, 1
  s_cbranch_scc0 L_70
  s_mov_b32 s30, 0
L_71:
  s_waitcnt lgkmcnt(0)
  s_barrier
  ds_read_b128 v[48:51], v1 offset:0
  ds_read_b128 v[52:55], v1 offset:1024
  ds_read_b128 v[56:59], v1 offset:2048
  s_add_u32 s31, s42, 16777216
  buffer_load_dwordx4 v[76:79], v4, s[4:7], s40 offen sc1
  buffer_load_dword v14, v5, s[4:7], s40 offen sc1
  s_waitcnt lgkmcnt(2)
  v_smfmac_f32_16x16x64_bf16 v[32:35], v[48:51], v[60:67], v15
  ds_read_b128 v[60:63], v0 offset:4096
  ds_read_b128 v[64:67], v0 offset:5120
  v_smfmac_f32_16x16x64_bf16 v[24:27], v[48:51], a[0:7], v15
  v_smfmac_f32_16x16x64_bf16 v[40:43], v[48:51], a[160:167], v15
  v_smfmac_f32_16x16x64_bf16 v[36:39], v[48:51], v[68:75], v15
  ds_read_b128 v[68:71], v0 offset:6144
  ds_read_b128 v[72:75], v0 offset:7168
  v_smfmac_f32_16x16x64_bf16 v[28:31], v[48:51], a[8:15], v15
  v_smfmac_f32_16x16x64_bf16 v[44:47], v[48:51], a[168:175], v15
  ds_read_b128 v[48:51], v1 offset:3072
  s_waitcnt lgkmcnt(6)
  v_smfmac_f32_16x16x64_bf16 v[32:35], v[52:55], v[80:87], v15
  ds_read_b128 v[80:83], v0 offset:8192
  ds_read_b128 v[84:87], v0 offset:9216
  v_smfmac_f32_16x16x64_bf16 v[24:27], v[52:55], a[16:23], v15
  v_smfmac_f32_16x16x64_bf16 v[40:43], v[52:55], a[176:183], v15
  v_smfmac_f32_16x16x64_bf16 v[36:39], v[52:55], v[88:95], v15
  ds_read_b128 v[88:91], v0 offset:10240
  ds_read_b128 v[92:95], v0 offset:11264
  v_smfmac_f32_16x16x64_bf16 v[28:31], v[52:55], a[24:31], v15
  v_smfmac_f32_16x16x64_bf16 v[44:47], v[52:55], a[184:191], v15
  ds_read_b128 v[52:55], v1 offset:4096
  s_waitcnt lgkmcnt(10)
  s_waitcnt lgkmcnt(8)
  v_smfmac_f32_16x16x64_bf16 v[32:35], v[56:59], v[60:67], v15
  ds_read_b128 v[60:63], v0 offset:12288
  ds_read_b128 v[64:67], v0 offset:13312
  v_smfmac_f32_16x16x64_bf16 v[24:27], v[56:59], a[32:39], v15
  s_waitcnt lgkmcnt(8)
  v_smfmac_f32_16x16x64_bf16 v[36:39], v[56:59], v[68:75], v15
  ds_read_b128 v[68:71], v0 offset:14336
  ds_read_b128 v[72:75], v0 offset:15360
  v_smfmac_f32_16x16x64_bf16 v[28:31], v[56:59], a[40:47], v15
  s_waitcnt lgkmcnt(9)
  s_waitcnt lgkmcnt(7)
  v_smfmac_f32_16x16x64_bf16 v[32:35], v[48:51], v[80:87], v15
  v_smfmac_f32_16x16x64_bf16 v[24:27], v[48:51], a[48:55], v15
  s_waitcnt lgkmcnt(5)
  v_smfmac_f32_16x16x64_bf16 v[36:39], v[48:51], v[88:95], v15
  buffer_load_dwordx4 v[80:83], v6, s[4:7], s31 offen offset:0
  v_smfmac_f32_16x16x64_bf16 v[28:31], v[48:51], a[56:63], v15
  buffer_load_dwordx4 v[88:91], v6, s[4:7], s42 offen offset:0
  s_waitcnt vmcnt(2)
L_72:
  ds_write_b128 v4, v[76:79] offset:5120
  ds_write_b32 v5, v14 offset:5120
  v_max3_u32 v14, v76, v77, v14
  v_max3_u32 v14, v78, v79, v14
  v_cmp_eq_u32 vcc, -1, v14
  s_cbranch_vccz L_73
  buffer_load_dwordx4 v[76:79], v4, s[4:7], s40 offen sc1
  buffer_load_dword v14, v5, s[4:7], s40 offen sc1
  s_waitcnt vmcnt(0)
  s_sub_u32 s30, s30, 1
  s_cbranch_scc0 L_72
  s_mov_b32 s30, 0
L_73:
  s_waitcnt lgkmcnt(2)
  v_smfmac_f32_16x16x64_bf16 v[32:35], v[52:55], v[60:67], v15
  buffer_load_dwordx4 v[92:95], v6, s[4:7], s42 offen offset:1024
  v_smfmac_f32_16x16x64_bf16 v[36:39], v[52:55], v[68:75], v15
  buffer_load_dwordx4 v[84:87], v6, s[4:7], s31 offen offset:1024
  s_waitcnt lgkmcnt(0)
  s_add_u32 s42, s42, 262144
  s_add_u32 s41, s41, 5120
  s_barrier
  ds_read_b128 v[60:63], v1 offset:5120
  ds_read_b128 v[64:67], v1 offset:6144
  ds_read_b128 v[68:71], v1 offset:7168
  ds_read_b128 v[72:75], v1 offset:8192
  ds_read_b128 v[76:79], v1 offset:9216
  v_smfmac_f32_16x16x64_bf16 v[24:27], v[52:55], a[64:71], v15
  buffer_store_dwordx2 v[2:3], v8, s[4:7], s43 offen sc1
  v_smfmac_f32_16x16x64_bf16 v[28:31], v[52:55], a[72:79], v15
  buffer_store_dword v13, v10, s[4:7], s47 offen sc1
  v_smfmac_f32_16x16x64_bf16 v[40:43], v[56:59], a[192:199], v15
  v_mov_b32 v13, s37
  v_smfmac_f32_16x16x64_bf16 v[44:47], v[56:59], a[200:207], v15
  s_add_u32 s43, s43, 65536
  s_add_u32 s39, s39, 32768
  v_smfmac_f32_16x16x64_bf16 v[40:43], v[48:51], a[208:215], v15
  s_add_u32 s40, s40, 32768
  s_add_u32 s29, s29, 32768
  v_smfmac_f32_16x16x64_bf16 v[44:47], v[48:51], a[216:223], v15
  v_smfmac_f32_16x16x64_bf16 v[40:43], v[52:55], a[224:231], v15
  v_smfmac_f32_16x16x64_bf16 v[44:47], v[52:55], a[232:239], v15
  s_waitcnt lgkmcnt(4)
  v_smfmac_f32_16x16x64_bf16 v[24:27], v[60:63], a[80:87], v15
  v_smfmac_f32_16x16x64_bf16 v[28:31], v[60:63], a[88:95], v15
  s_waitcnt lgkmcnt(3)
  v_smfmac_f32_16x16x64_bf16 v[24:27], v[64:67], a[96:103], v15
  v_smfmac_f32_16x16x64_bf16 v[28:31], v[64:67], a[104:111], v15
  s_waitcnt lgkmcnt(2)
  v_smfmac_f32_16x16x64_bf16 v[24:27], v[68:71], a[112:119], v15
  v_smfmac_f32_16x16x64_bf16 v[28:31], v[68:71], a[120:127], v15
  s_waitcnt lgkmcnt(1)
  v_smfmac_f32_16x16x64_bf16 v[24:27], v[72:75], a[128:135], v15
  v_smfmac_f32_16x16x64_bf16 v[28:31], v[72:75], a[136:143], v15
  s_waitcnt lgkmcnt(0)
  v_smfmac_f32_16x16x64_bf16 v[24:27], v[76:79], a[144:151], v15
  v_smfmac_f32_16x16x64_bf16 v[28:31], v[76:79], a[152:159], v15
  v_smfmac_f32_16x16x64_bf16 v[32:35], v[60:63], v[160:167], v15
  v_smfmac_f32_16x16x64_bf16 v[36:39], v[60:63], v[168:175], v15
  v_add_f32 v24, v24, v25
  v_add_f32 v25, v26, v27
  v_smfmac_f32_16x16x64_bf16 v[32:35], v[64:67], v[176:183], v15
  v_add_f32 v26, v28, v29
  v_add_f32 v27, v30, v31
  v_smfmac_f32_16x16x64_bf16 v[36:39], v[64:67], v[184:191], v15
  v_pk_mul_f32 v[24:25], v[24:25], s[48:49] op_sel:[0,1] op_sel_hi:[1,1]
  v_pk_mul_f32 v[26:27], v[26:27], s[48:49] op_sel:[0,1] op_sel_hi:[1,1]
  v_smfmac_f32_16x16x64_bf16 v[32:35], v[68:71], v[192:199], v15
  v_cvt_pk_bf16_f32 v48, v24, v25
  v_cvt_pk_bf16_f32 v49, v26, v27
  v_smfmac_f32_16x16x64_bf16 v[36:39], v[68:71], v[200:207], v15
  v_mfma_f32_16x16x16_bf16 v[24:27], v[48:49], v[16:17], 0
  v_mfma_f32_16x16x16_bf16 v[28:31], v[48:49], v[18:19], 0
  v_smfmac_f32_16x16x64_bf16 v[32:35], v[72:75], v[208:215], v15
  v_smfmac_f32_16x16x64_bf16 v[36:39], v[72:75], v[216:223], v15
  v_cvt_pk_bf16_f32 v52, v24, v25
  v_cvt_pk_bf16_f32 v53, v26, v27
  v_smfmac_f32_16x16x64_bf16 v[32:35], v[76:79], v[224:231], v15
  v_cvt_pk_bf16_f32 v54, v28, v29
  v_cvt_pk_bf16_f32 v55, v30, v31
  v_smfmac_f32_16x16x64_bf16 v[36:39], v[76:79], v[232:239], v15
  s_waitcnt vmcnt(2)
  v_mfma_f32_16x16x32_bf16 v[24:27], v[88:91], v[52:55], 0
  v_mfma_f32_16x16x32_bf16 v[28:31], v[92:95], v[52:55], 0
  v_add_f32 v32, v32, v33
  v_add_f32 v33, v34, v35
  v_cvt_pk_bf16_f32 v50, v32, v33
  v_add_f32 v34, v36, v37
  v_add_f32 v35, v38, v39
  v_cvt_pk_bf16_f32 v51, v34, v35
  s_nop 1
  v_cndmask_b32 v24, v24, v28, s[52:53]
  v_cndmask_b32 v25, v25, v29, s[52:53]
  v_mfma_f32_16x16x16_bf16 v[32:35], v[50:51], v[16:17], 0
  v_cndmask_b32 v26, v26, v30, s[52:53]
  v_cndmask_b32 v27, v27, v31, s[52:53]
  ds_write_b128 v4, v[24:27]
  v_mfma_f32_16x16x16_bf16 v[36:39], v[50:51], v[18:19], 0
  v_mov_b64 v[2:3], v[50:51]
  v_smfmac_f32_16x16x64_bf16 v[40:43], v[60:63], a[240:247], v15
  s_nop 1
  v_cvt_pk_bf16_f32 v56, v32, v33
  v_cvt_pk_bf16_f32 v57, v34, v35
  s_nop 1
  v_cvt_pk_bf16_f32 v58, v36, v37
  v_cvt_pk_bf16_f32 v59, v38, v39
  v_smfmac_f32_16x16x64_bf16 v[44:47], v[60:63], a[248:255], v15
  v_mfma_f32_16x16x32_bf16 v[32:35], v[56:59], v[52:55], 0
  s_waitcnt lgkmcnt(0)
  s_barrier
  ds_read_b128 v[24:27], v6 offset:0
  ds_read_b128 v[28:31], v6 offset:1024
  ds_read_b128 v[88:91], v6 offset:2048
  ds_read_b128 v[92:95], v6 offset:3072
  v_smfmac_f32_16x16x64_bf16 v[40:43], v[64:67], v[96:103], v15
  s_nop 0
  v_cndmask_b32 v48, v32, v34, s[52:53]
  ds_write_b32 v5, v48
  v_smfmac_f32_16x16x64_bf16 v[44:47], v[64:67], v[104:111], v15
  v_mov_b32 v33, 0
  v_smfmac_f32_16x16x64_bf16 v[40:43], v[68:71], v[112:119], v15
  v_mov_b32 v34, 0
  v_smfmac_f32_16x16x64_bf16 v[44:47], v[68:71], v[120:127], v15
  v_smfmac_f32_16x16x64_bf16 v[40:43], v[72:75], v[128:135], v15
  s_waitcnt lgkmcnt(3)
  v_pk_add_f32 v[24:25], v[24:25], v[28:29]
  v_pk_add_f32 v[26:27], v[26:27], v[30:31]
  s_waitcnt lgkmcnt(0)
  s_barrier
  ds_read2st64_b32 v[48:49], v7 offset0:0 offset1:1
  ds_read2st64_b32 v[50:51], v7 offset0:2 offset1:3
  v_pk_add_f32 v[88:89], v[88:89], v[92:93]
  v_pk_add_f32 v[90:91], v[90:91], v[94:95]
  v_smfmac_f32_16x16x64_bf16 v[44:47], v[72:75], v[136:143], v15
  v_pk_add_f32 v[24:25], v[24:25], v[88:89]
  v_pk_add_f32 v[26:27], v[26:27], v[90:91]
  v_smfmac_f32_16x16x64_bf16 v[40:43], v[76:79], v[144:151], v15
  v_exp_f32 v28, v24
  v_exp_f32 v29, v25
  v_smfmac_f32_16x16x64_bf16 v[44:47], v[76:79], v[152:159], v15
  v_exp_f32 v30, v26
  v_exp_f32 v31, v27
  ds_read_b128 v[64:67], v0 offset:17408
  ds_read_b128 v[68:71], v0 offset:21504
  v_max3_f32 v57, |v24|, |v25|, |v26|
  v_cvt_pk_bf16_f32 v28, v28, v29
  v_cvt_pk_bf16_f32 v29, v30, v31
  ds_read_b128 v[72:75], v0 offset:24576
  ds_read_b128 v[76:79], v0 offset:28672
  v_max_f32 v57, |v27|, v57
  v_mov_b32_dpp v24, v28 quad_perm:[0,0,2,2] row_mask:0xf bank_mask:0xf
  v_mov_b32_dpp v25, v29 quad_perm:[0,0,2,2] row_mask:0xf bank_mask:0xf
  v_mov_b32_dpp v26, v28 quad_perm:[1,1,3,3] row_mask:0xf bank_mask:0xf
  v_mov_b32_dpp v27, v29 quad_perm:[1,1,3,3] row_mask:0xf bank_mask:0xf
  s_waitcnt lgkmcnt(4)
  v_pk_add_f32 v[48:49], v[48:49], v[50:51]
  v_mfma_f32_16x16x32_bf16 v[28:31], v[20:23], v[24:27], 0
  v_add_f32 v56, v48, v49
  v_mfma_f32_16x16x32_bf16 v[88:91], v[80:83], v[24:27], 0
  v_exp_f32 v36, v56
  v_mfma_f32_16x16x32_bf16 v[92:95], v[84:87], v[24:27], 0
  ds_read_b128 v[48:51], v0 offset:25600
  ds_read_b128 v[52:55], v0 offset:29696
  v_add_f32 v58, v40, v41
  v_add_f32 v59, v42, v43
  v_mov_b32_dpp v37, v36 quad_perm:[0,0,2,2] row_mask:0xf bank_mask:0xf
  v_mov_b32_dpp v38, v36 quad_perm:[1,1,3,3] row_mask:0xf bank_mask:0xf
  v_add_f32 v44, v44, v45
  v_add_f32 v45, v46, v47
  v_cvt_pk_bf16_f32 v32, v37, v38
  v_cvt_pk_bf16_f32 v35, v37, v38
  v_cvt_pk_bf16_f32 v58, v58, v59
  v_cvt_pk_bf16_f32 v59, v44, v45
  v_mfma_f32_16x16x16_bf16 v[28:31], v[20:21], v[32:33], v[28:31]
  ds_read_b128 v[80:83], v0 offset:16384
  ds_read_b128 v[84:87], v0 offset:20480
  v_max_f32 v57, |v56|, v57
  v_mfma_f32_16x16x16_bf16 v[88:91], v[58:59], v[32:33], v[88:91]
  v_cmp_nge_f32 vcc, s51, v57
  v_mfma_f32_16x16x16_bf16 v[92:95], v[58:59], v[34:35], v[92:95]
  s_cbranch_vccnz L_rMS3
L_rMbS3:
  s_nop 0
  v_rcp_f32 v28, v28
  v_cndmask_b32 v2, v2, v58, s[26:27]
  v_cndmask_b32 v3, v3, v59, s[26:27]
  s_cmp_eq_u32 s37, 63
  s_cbranch_scc1 L_rX
  s_nop 0
  v_cndmask_b32 v40, v88, v92, s[52:53]
  v_cndmask_b32 v41, v89, v93, s[52:53]
  v_cndmask_b32 v42, v90, v94, s[52:53]
  v_cndmask_b32 v43, v91, v95, s[52:53]
  v_pk_mul_f32 v[40:41], v[40:41], v[28:29] op_sel_hi:[1,0]
  v_pk_mul_f32 v[42:43], v[42:43], v[28:29] op_sel_hi:[1,0]
  v_cvt_pk_bf16_f32 v40, v40, v41
  v_cvt_pk_bf16_f32 v41, v42, v43
  ds_write_b64 v8, v[40:41]
  v_mov_b64 v[44:45], 0
  v_mov_b64 v[46:47], 0
  v_mov_b64 v[60:61], 0
  v_mov_b64 v[62:63], 0
  s_waitcnt lgkmcnt(0)
  s_barrier
  ds_read_b128 v[32:35], v6 offset:10240
  ds_read_b128 v[36:39], v6 offset:11264
  ds_read_b128 v[88:91], v0 offset:18432
  ds_read_b128 v[92:95], v0 offset:22528
  v_mov_b64 v[24:25], 0
  v_mov_b64 v[26:27], 0
  v_mov_b64 v[28:29], 0
  v_mov_b64 v[30:31], 0
  v_mov_b64 v[56:57], 0
  v_mov_b64 v[58:59], 0
  s_add_u32 s31, s44, 32768
  s_waitcnt lgkmcnt(3)
  v_smfmac_f32_16x16x64_bf16 v[44:47], v[32:35], v[80:87], v15
  ds_read_b128 v[80:83], v0 offset:26624
  ds_read_b128 v[84:87], v0 offset:30720
  s_waitcnt lgkmcnt(4)
  v_smfmac_f32_16x16x64_bf16 v[44:47], v[36:39], v[72:79], v15
  ds_read_b128 v[72:75], v0 offset:19456
  ds_read_b128 v[76:79], v0 offset:23552
  v_smfmac_f32_16x16x64_bf16 v[60:63], v[32:35], v[64:71], v15
  ds_read_b128 v[64:67], v0 offset:27648
  ds_read_b128 v[68:71], v0 offset:31744
  v_smfmac_f32_16x16x64_bf16 v[60:63], v[36:39], v[48:55], v15
  v_smfmac_f32_16x16x64_bf16 v[24:27], v[32:35], v[240:247], v15
  v_add_f32 v44, v44, v45
  v_add_f32 v45, v46, v47
  v_smfmac_f32_16x16x64_bf16 v[24:27], v[36:39], v[248:255], v15
  v_cvt_pk_bf16_f32 v40, v44, v45
  s_waitcnt lgkmcnt(6)
  v_smfmac_f32_16x16x64_bf16 v[28:31], v[32:35], v[88:95], v15
  s_waitcnt lgkmcnt(4)
  v_add_f32 v60, v60, v61
  v_add_f32 v61, v62, v63
  v_smfmac_f32_16x16x64_bf16 v[28:31], v[36:39], v[80:87], v15
  v_cvt_pk_bf16_f32 v41, v60, v61
  s_waitcnt lgkmcnt(2)
  v_smfmac_f32_16x16x64_bf16 v[56:59], v[32:35], v[72:79], v15
  s_waitcnt lgkmcnt(0)
  v_add_f32 v24, v24, v25
  v_add_f32 v25, v26, v27
  v_smfmac_f32_16x16x64_bf16 v[56:59], v[36:39], v[64:71], v15
  v_cvt_pk_bf16_f32 v24, v24, v25
  buffer_store_dword v24, v9, s[4:7], s31 offen sc1
  v_add_f32 v28, v28, v29
  v_add_f32 v29, v30, v31
  v_cvt_pk_bf16_f32 v42, v28, v29
  s_nop 2
  v_add_f32 v56, v56, v57
  v_add_f32 v57, v58, v59
  v_cvt_pk_bf16_f32 v43, v56, v57
  buffer_store_dwordx4 v[40:43], v11, s[4:7], s44 offen sc1
  ds_read_b128 v[60:63], v0 offset:32768
  ds_read_b128 v[64:67], v0 offset:33792
  ds_read_b128 v[68:71], v0 offset:34816
  ds_read_b128 v[72:75], v0 offset:35840
  ds_read_b128 v[80:83], v0 offset:0
  ds_read_b128 v[84:87], v0 offset:1024
  ds_read_b128 v[88:91], v0 offset:2048
  ds_read_b128 v[92:95], v0 offset:3072
  s_add_u32 s44, s44, s46
  s_add_u32 s37, s37, 1
  s_sub_u32 s46, 0, s46
  s_branch L_rS3
L_rMS3:
  s_add_u32 s31, s42, 16515072
  s_waitcnt lgkmcnt(0)
  s_nop 7
  s_nop 7
  buffer_load_dwordx4 v[80:83], v6, s[4:7], s31 offen offset:0
  buffer_load_dwordx4 v[84:87], v6, s[4:7], s31 offen offset:1024
  ds_read_b128 v[24:27], v6 offset:0
  ds_read_b128 v[28:31], v6 offset:1024
  ds_read_b128 v[88:91], v6 offset:2048
  ds_read_b128 v[92:95], v6 offset:3072
  s_waitcnt vmcnt(0) lgkmcnt(0)
  v_pk_add_f32 v[24:25], v[24:25], v[28:29]
  v_pk_add_f32 v[26:27], v[26:27], v[30:31]
  v_pk_add_f32 v[88:89], v[88:89], v[92:93]
  v_pk_add_f32 v[90:91], v[90:91], v[94:95]
  v_pk_add_f32 v[24:25], v[24:25], v[88:89]
  v_pk_add_f32 v[26:27], v[26:27], v[90:91]
  v_max3_f32 v57, v24, v25, v26
  v_max3_f32 v57, v27, v56, v57
  s_nop 1
  v_mov_b32_dpp v44, v57 quad_perm:[1,0,3,2] row_mask:0xf bank_mask:0xf
  v_max_f32 v57, v57, v44
  v_mov_b32 v44, v57
  s_nop 1
  v_permlane16_swap_b32 v44, v57
  v_max_f32 v57, v57, v44
  v_mov_b32 v44, v57
  s_nop 1
  v_permlane32_swap_b32 v44, v57
  v_max_f32 v57, v57, v44
  v_sub_f32 v24, v24, v57
  v_sub_f32 v25, v25, v57
  v_sub_f32 v26, v26, v57
  v_sub_f32 v27, v27, v57
  v_sub_f32 v56, v56, v57
  v_exp_f32 v28, v24
  v_exp_f32 v29, v25
  v_exp_f32 v30, v26
  v_exp_f32 v31, v27
  v_max3_f32 v57, |v24|, |v25|, |v26|
  v_cvt_pk_bf16_f32 v28, v28, v29
  v_cvt_pk_bf16_f32 v29, v30, v31
  v_max_f32 v57, |v27|, v57
  v_mov_b32_dpp v24, v28 quad_perm:[0,0,2,2] row_mask:0xf bank_mask:0xf
  v_mov_b32_dpp v25, v29 quad_perm:[0,0,2,2] row_mask:0xf bank_mask:0xf
  v_mov_b32_dpp v26, v28 quad_perm:[1,1,3,3] row_mask:0xf bank_mask:0xf
  v_mov_b32_dpp v27, v29 quad_perm:[1,1,3,3] row_mask:0xf bank_mask:0xf
  s_nop 1
  v_mfma_f32_16x16x32_bf16 v[28:31], v[20:23], v[24:27], 0
  v_mfma_f32_16x16x32_bf16 v[88:91], v[80:83], v[24:27], 0
  v_exp_f32 v36, v56
  v_mfma_f32_16x16x32_bf16 v[92:95], v[84:87], v[24:27], 0
  s_nop 0
  v_mov_b32_dpp v37, v36 quad_perm:[0,0,2,2] row_mask:0xf bank_mask:0xf
  v_mov_b32_dpp v38, v36 quad_perm:[1,1,3,3] row_mask:0xf bank_mask:0xf
  v_cvt_pk_bf16_f32 v32, v37, v38
  v_cvt_pk_bf16_f32 v35, v37, v38
  s_nop 0
  v_mfma_f32_16x16x16_bf16 v[28:31], v[20:21], v[32:33], v[28:31]
  v_mfma_f32_16x16x16_bf16 v[88:91], v[58:59], v[32:33], v[88:91]
  v_mfma_f32_16x16x16_bf16 v[92:95], v[58:59], v[34:35], v[92:95]
  ds_read_b128 v[80:83], v0 offset:16384
  ds_read_b128 v[84:87], v0 offset:20480
  s_nop 7
  s_nop 7
  s_branch L_rMbS3
L_rX:
  buffer_store_dwordx2 v[2:3], v8, s[4:7], s43 offen sc1
  s_waitcnt vmcnt(0)
  s_barrier
  v_mov_b32 v24, 64
  s_mov_b64 exec, 1
  buffer_store_dword v24, off, s[4:7], s47 sc1
  s_mov_b64 exec, -1
  s_endpgm
L_bulk:
  s_lshl_b32 s97, s29, 2
  s_add_u32 s97, s97, s28
  s_lshl_b32 s97, s97, 8
  s_add_u32 s97, s97, 65536
  s_cmp_lg_u32 s29, 0
  s_cbranch_scc1 L_77_
  s_cmp_lg_u32 s28, 0
  s_cbranch_scc1 L_77
  s_mov_b64 exec, 0xff
  s_mov_b32 s32, -1
  s_mov_b32 s33, -1
  s_mov_b32 s34, 2103296
  s_mov_b32 s35, 2111488
  s_memtime s[36:37]
  s_waitcnt lgkmcnt(0)
  buffer_store_dwordx4 v[0:3], v1, s[4:7], s34 offen sc1
  s_waitcnt vmcnt(0)
  s_memtime s[38:39]
  s_waitcnt lgkmcnt(0)
  s_sub_u32 s36, s38, s36
  s_min_u32 s32, s32, s36
  s_memtime s[36:37]
  s_waitcnt lgkmcnt(0)
  buffer_store_dwordx4 v[0:3], v1, s[4:7], s35 offen sc1
  s_waitcnt vmcnt(0)
  s_memtime s[38:39]
  s_waitcnt lgkmcnt(0)
  s_sub_u32 s36, s38, s36
  s_min_u32 s33, s33, s36
  s_memtime s[36:37]
  s_waitcnt lgkmcnt(0)
  buffer_store_dwordx4 v[0:3], v1, s[4:7], s34 offen sc1
  s_waitcnt vmcnt(0)
  s_memtime s[38:39]
  s_waitcnt lgkmcnt(0)
  s_sub_u32 s36, s38, s36
  s_min_u32 s32, s32, s36
  s_memtime s[36:37]
  s_waitcnt lgkmcnt(0)
  buffer_store_dwordx4 v[0:3], v1, s[4:7], s35 offen sc1
  s_waitcnt vmcnt(0)
  s_memtime s[38:39]
  s_waitcnt lgkmcnt(0)
  s_sub_u32 s36, s38, s36
  s_min_u32 s33, s33, s36
  s_memtime s[36:37]
  s_waitcnt lgkmcnt(0)
  buffer_store_dwordx4 v[0:3], v1, s[4:7], s34 offen sc1
  s_waitcnt vmcnt(0)
  s_memtime s[38:39]
  s_waitcnt lgkmcnt(0)
  s_sub_u32 s36, s38, s36
  s_min_u32 s32, s32, s36
  s_memtime s[36:37]
  s_waitcnt lgkmcnt(0)
  buffer_store_dwordx4 v[0:3], v1, s[4:7], s35 offen sc1
  s_waitcnt vmcnt(0)
  s_memtime s[38:39]
  s_waitcnt lgkmcnt(0)
  s_sub_u32 s36, s38, s36
  s_min_u32 s33, s33, s36
  s_memtime s[36:37]
  s_waitcnt lgkmcnt(0)
  buffer_store_dwordx4 v[0:3], v1, s[4:7], s34 offen sc1
  s_waitcnt vmcnt(0)
  s_memtime s[38:39]
  s_waitcnt lgkmcnt(0)
  s_sub_u32 s36, s38, s36
  s_min_u32 s32, s32, s36
  s_memtime s[36:37]
  s_waitcnt lgkmcnt(0)
  buffer_store_dwordx4 v[0:3], v1, s[4:7], s35 offen sc1
  s_waitcnt vmcnt(0)
  s_memtime s[38:39]
  s_waitcnt lgkmcnt(0)
  s_sub_u32 s36, s38, s36
  s_min_u32 s33, s33, s36
  s_cmp_gt_u32 s32, s33
  s_cselect_b32 s36, 3, 1
  s_lshr_b32 s37, s3, 1
  s_and_b32 s37, s37, 2
  s_xor_b32 s36, s36, s37
  v_mov_b32 v4, s36
  v_mov_b32 v5, s32
  v_mov_b32 v6, s33
  v_mov_b32 v7, s3
  s_mov_b64 exec, 1
  buffer_store_dword v4, off, s[20:23], 0 offset:136 sc1
  s_mov_b64 exec, -1
L_77:
  s_barrier
L_77_:
  s_and_b32 s32, s29, 3
  s_lshr_b32 s33, s29, 2
  s_lshr_b32 s34, s33, 4
  s_mov_b32 s12, s78
  s_mov_b32 s13, s79
  s_mov_b32 s14, 5242880
  s_mov_b32 s15, 0x20000
  s_cmp_lg_u32 s34, 1
  s_cbranch_scc1 L_78
  s_mov_b32 s12, s80
  s_mov_b32 s13, s81
L_78:
  s_cmp_lg_u32 s34, 2
  s_cbranch_scc1 L_79
  s_mov_b32 s12, s82
  s_mov_b32 s13, s83
L_79:
  v_and_b32 v2, 15, v0
  v_lshrrev_b32 v3, 4, v0
  v_mul_u32_u24 v6, 1280, v2
  v_lshl_add_u32 v6, v3, 4, v6
  s_and_b32 s31, s28, 1
  s_lshr_b32 s48, s28, 1
  s_mul_i32 s38, s31, 20480
  s_mul_i32 s49, s48, 640
  s_add_u32 s38, s38, s49
  s_mul_i32 s49, s32, 40960
  s_add_u32 s38, s38, s49
  s_mul_i32 s39, s31, 20480
  s_mul_i32 s49, s48, 10240
  s_add_u32 s39, s39, s49
  s_add_u32 m0, s39, 0
  s_add_u32 s31, s38, 0
  buffer_load_dwordx4 v6, s[8:11], s31 offen lds
  s_add_u32 m0, s39, 1024
  s_add_u32 s31, s38, 64
  buffer_load_dwordx4 v6, s[8:11], s31 offen lds
  s_add_u32 m0, s39, 2048
  s_add_u32 s31, s38, 128
  buffer_load_dwordx4 v6, s[8:11], s31 offen lds
  s_add_u32 m0, s39, 3072
  s_add_u32 s31, s38, 192
  buffer_load_dwordx4 v6, s[8:11], s31 offen lds
  s_add_u32 m0, s39, 4096
  s_add_u32 s31, s38, 256
  buffer_load_dwordx4 v6, s[8:11], s31 offen lds
  s_add_u32 m0, s39, 5120
  s_add_u32 s31, s38, 320
  buffer_load_dwordx4 v6, s[8:11], s31 offen lds
  s_add_u32 m0, s39, 6144
  s_add_u32 s31, s38, 384
  buffer_load_dwordx4 v6, s[8:11], s31 offen lds
  s_add_u32 m0, s39, 7168
  s_add_u32 s31, s38, 448
  buffer_load_dwordx4 v6, s[8:11], s31 offen lds
  s_add_u32 m0, s39, 8192
  s_add_u32 s31, s38, 512
  buffer_load_dwordx4 v6, s[8:11], s31 offen lds
  s_add_u32 m0, s39, 9216
  s_add_u32 s31, s38, 576
  buffer_load_dwordx4 v6, s[8:11], s31 offen lds
  s_add_u32 m0, s39, 40960
  s_add_u32 s31, s38, 163840
  buffer_load_dwordx4 v6, s[8:11], s31 offen lds
  s_add_u32 m0, s39, 41984
  s_add_u32 s31, s38, 163904
  buffer_load_dwordx4 v6, s[8:11], s31 offen lds
  s_add_u32 m0, s39, 43008
  s_add_u32 s31, s38, 163968
  buffer_load_dwordx4 v6, s[8:11], s31 offen lds
  s_add_u32 m0, s39, 44032
  s_add_u32 s31, s38, 164032
  buffer_load_dwordx4 v6, s[8:11], s31 offen lds
  s_add_u32 m0, s39, 45056
  s_add_u32 s31, s38, 164096
  buffer_load_dwordx4 v6, s[8:11], s31 offen lds
  s_add_u32 m0, s39, 46080
  s_add_u32 s31, s38, 164160
  buffer_load_dwordx4 v6, s[8:11], s31 offen lds
  s_add_u32 m0, s39, 47104
  s_add_u32 s31, s38, 164224
  buffer_load_dwordx4 v6, s[8:11], s31 offen lds
  s_add_u32 m0, s39, 48128
  s_add_u32 s31, s38, 164288
  buffer_load_dwordx4 v6, s[8:11], s31 offen lds
  s_add_u32 m0, s39, 49152
  s_add_u32 s31, s38, 164352
  buffer_load_dwordx4 v6, s[8:11], s31 offen lds
  s_add_u32 m0, s39, 50176
  s_add_u32 s31, s38, 164416
  buffer_load_dwordx4 v6, s[8:11], s31 offen lds
  v_lshrrev_b32 v4, 3, v0
  v_lshlrev_b32 v4, 13, v4
  v_and_b32 v13, 7, v0
  v_lshl_add_u32 v4, v13, 4, v4
  s_and_b32 s35, s33, 15
  s_lshl_b32 s35, s35, 2
  s_add_u32 s35, s35, s28
  s_lshl_b32 s40, s35, 12
  s_lshr_b32 s41, s35, 1
  s_lshl_b32 s41, s41, 5
  s_lshl_b32 s35, s35, 7
  s_mul_i32 s36, s28, 20480
  s_add_u32 s36, s36, 81920
  v_lshrrev_b32 v13, 2, v2
  v_lshl_add_u32 v13, v3, 3, v13
  v_and_b32 v14, 3, v0
  v_lshlrev_b32 v14, 3, v14
  v_add_u32 v14, s36, v14
  v_lshl_add_u32 v5, v13, 7, v14
  v_lshl_add_u32 v15, v13, 5, v14
  s_lshl_b32 s49, s34, 24
  s_add_u32 s40, s40, s49
  s_lshl_b32 s49, s32, 18
  s_add_u32 s40, s40, s49
  s_add_u32 s40, s40, 33554432
  s_lshl_b32 s49, s34, 3
  s_add_u32 s41, s41, s49
  s_and_b32 s49, s28, 1
  s_lshl_b32 s49, s49, 2
  s_add_u32 s41, s41, s49
  s_add_u32 s41, s41, s32
  s_lshl_b32 s41, s41, 2
  v_mov_b32 v10, 0
  s_mov_b32 s45, 1.0
  s_mov_b32 s50, 0x7ff00000
  s_cmp_ge_u32 s33, 44
  s_cbranch_scc1 L_82
  s_cmp_ge_u32 s33, 42
  s_cbranch_scc1 L_81
  s_cmp_ge_u32 s33, 40
  s_cbranch_scc1 L_80
  s_mov_b32 s16, s66
  s_mov_b32 s17, s67
  s_mov_b32 s18, 819200
  s_mov_b32 s19, 0x20000
  s_mov_b32 s37, 1280
  s_lshl_b32 s51, s33, 5
  s_mov_b32 s45, 1051011932
  s_mov_b32 s43, 20480
  s_add_u32 s44, s51, 4194304
  v_mul_u32_u24 v9, 1280, v2
  v_lshl_add_u32 v9, v3, 3, v9
  s_mov_b32 s46, 0
  s_branch L_83
L_80:
  s_mov_b32 s16, s68
  s_mov_b32 s17, s69
  s_mov_b32 s18, 25600
  s_mov_b32 s19, 0x20000
  s_mov_b32 s37, 40
  s_and_b32 s51, s33, 1
  s_lshl_b32 s51, s51, 5
  s_mov_b32 s43, 640
  s_add_u32 s44, s51, 7340032
  v_mul_u32_u24 v9, 40, v2
  v_lshlrev_b32 v13, 3, v3
  v_add_u32 v9, v9, v13
  v_add_u32 v13, s51, v13
  v_cmp_gt_u32 vcc, 40, v13
  v_mov_b32 v13, s50
  s_nop 0
  v_cndmask_b32 v9, v13, v9, vcc
  s_mov_b32 s46, 0
  s_branch L_83
L_81:
  s_mov_b32 s16, s70
  s_mov_b32 s17, s71
  s_mov_b32 s18, 25600
  s_mov_b32 s19, 0x20000
  s_mov_b32 s37, 40
  s_and_b32 s51, s33, 1
  s_lshl_b32 s52, s51, 4
  s_lshl_b32 s51, s51, 5
  s_mov_b32 s43, 32
  s_mov_b32 s44, 7471104
  v_add_u32 v13, s52, v2
  v_lshlrev_b32 v9, 12, v13
  v_lshl_add_u32 v9, v3, 3, v9
  v_cmp_gt_u32 vcc, 20, v13
  v_mov_b32 v13, s50
  s_nop 0
  v_cndmask_b32 v9, v13, v9, vcc
  s_mov_b32 s46, 1
  s_branch L_83
L_82:
  s_mov_b32 s16, s88
  s_mov_b32 s17, s89
  s_mov_b32 s18, 1280
  s_mov_b32 s19, 0x20000
  s_mov_b32 s37, 0
  s_mov_b32 s51, 0
  s_mov_b32 s43, 32
  s_cmp_eq_u32 s33, 44
  s_mov_b32 s44, 7553024
  s_cselect_b32 s44, 7557120, s44
  s_cselect_b32 s45, 1.0, 0
  s_cselect_b32 s52, 0, 1.0
  v_mov_b32 v10, s52
  s_cmp_le_u32 s33, 45
  s_cselect_b32 s52, 1, 0
  v_lshlrev_b32 v9, 3, v3
  v_cmp_gt_u32 vcc, s52, v2
  v_mov_b32 v13, s50
  s_nop 0
  v_cndmask_b32 v9, v13, v9, vcc
  s_mov_b32 s46, 1
L_83:
  v_lshrrev_b32 v13, 1, v0
  v_mul_lo_u32 v13, v13, s37
  v_and_b32 v14, 1, v0
  v_lshl_add_u32 v13, v14, 4, v13
  s_lshl_b32 s37, s37, 5
  s_add_u32 m0, s36, 0
  s_add_u32 s31, s35, 0
  buffer_load_dwordx4 v4, s[12:15], s31 offen lds
  s_add_u32 m0, s36, 1024
  s_add_u32 s31, s35, 65536
  buffer_load_dwordx4 v4, s[12:15], s31 offen lds
  s_add_u32 m0, s36, 2048
  s_add_u32 s31, s35, 131072
  buffer_load_dwordx4 v4, s[12:15], s31 offen lds
  s_add_u32 m0, s36, 3072
  s_add_u32 s31, s35, 196608
  buffer_load_dwordx4 v4, s[12:15], s31 offen lds
  s_add_u32 m0, s36, 4096
  s_add_u32 s31, s35, 262144
  buffer_load_dwordx4 v4, s[12:15], s31 offen lds
  s_add_u32 m0, s36, 5120
  s_add_u32 s31, s35, 327680
  buffer_load_dwordx4 v4, s[12:15], s31 offen lds
  s_add_u32 m0, s36, 6144
  s_add_u32 s31, s35, 393216
  buffer_load_dwordx4 v4, s[12:15], s31 offen lds
  s_add_u32 m0, s36, 7168
  s_add_u32 s31, s35, 458752
  buffer_load_dwordx4 v4, s[12:15], s31 offen lds
  s_add_u32 m0, s36, 8192
  s_add_u32 s31, s35, 524288
  buffer_load_dwordx4 v4, s[12:15], s31 offen lds
  s_add_u32 m0, s36, 9216
  s_add_u32 s31, s35, 589824
  buffer_load_dwordx4 v4, s[12:15], s31 offen lds
  s_add_u32 m0, s36, 10240
  s_add_u32 s31, s35, 655360
  buffer_load_dwordx4 v4, s[12:15], s31 offen lds
  s_add_u32 m0, s36, 11264
  s_add_u32 s31, s35, 720896
  buffer_load_dwordx4 v4, s[12:15], s31 offen lds
  s_add_u32 m0, s36, 12288
  s_add_u32 s31, s35, 786432
  buffer_load_dwordx4 v4, s[12:15], s31 offen lds
  s_add_u32 m0, s36, 13312
  s_add_u32 s31, s35, 851968
  buffer_load_dwordx4 v4, s[12:15], s31 offen lds
  s_add_u32 m0, s36, 14336
  s_add_u32 s31, s35, 917504
  buffer_load_dwordx4 v4, s[12:15], s31 offen lds
  s_add_u32 m0, s36, 15360
  s_add_u32 s31, s35, 983040
  buffer_load_dwordx4 v4, s[12:15], s31 offen lds
  s_add_u32 m0, s36, 16384
  s_add_u32 s31, s35, 1048576
  buffer_load_dwordx4 v4, s[12:15], s31 offen lds
  s_add_u32 m0, s36, 17408
  s_add_u32 s31, s35, 1114112
  buffer_load_dwordx4 v4, s[12:15], s31 offen lds
  s_add_u32 m0, s36, 18432
  s_add_u32 s31, s35, 1179648
  buffer_load_dwordx4 v4, s[12:15], s31 offen lds
  s_add_u32 m0, s36, 19456
  s_add_u32 s31, s35, 1245184
  buffer_load_dwordx4 v4, s[12:15], s31 offen lds
  s_waitcnt vmcnt(16)
  ds_read_b64_tr_b16 a[0:1], v5 offset:0
  ds_read_b64_tr_b16 a[2:3], v5 offset:512
  ds_read_b64_tr_b16 a[80:81], v5 offset:32
  ds_read_b64_tr_b16 a[82:83], v5 offset:544
  ds_read_b64_tr_b16 a[160:161], v5 offset:64
  ds_read_b64_tr_b16 a[162:163], v5 offset:576
  ds_read_b64_tr_b16 a[240:241], v5 offset:96
  ds_read_b64_tr_b16 a[242:243], v5 offset:608
  s_waitcnt lgkmcnt(0)
  s_add_u32 m0, s36, 0
  s_add_u32 s31, s35, 1310720
  buffer_load_dwordx4 v4, s[12:15], s31 offen lds
  s_add_u32 m0, s36, 1024
  s_add_u32 s31, s35, 1376256
  buffer_load_dwordx4 v4, s[12:15], s31 offen lds
  s_add_u32 m0, s36, 2048
  s_add_u32 s31, s35, 1441792
  buffer_load_dwordx4 v4, s[12:15], s31 offen lds
  s_add_u32 m0, s36, 3072
  s_add_u32 s31, s35, 1507328
  buffer_load_dwordx4 v4, s[12:15], s31 offen lds
  s_waitcnt vmcnt(16)
  ds_read_b64_tr_b16 a[4:5], v5 offset:4096
  ds_read_b64_tr_b16 a[6:7], v5 offset:4608
  ds_read_b64_tr_b16 a[84:85], v5 offset:4128
  ds_read_b64_tr_b16 a[86:87], v5 offset:4640
  ds_read_b64_tr_b16 a[164:165], v5 offset:4160
  ds_read_b64_tr_b16 a[166:167], v5 offset:4672
  ds_read_b64_tr_b16 a[244:245], v5 offset:4192
  ds_read_b64_tr_b16 a[246:247], v5 offset:4704
  s_waitcnt lgkmcnt(0)
  s_add_u32 m0, s36, 4096
  s_add_u32 s31, s35, 1572864
  buffer_load_dwordx4 v4, s[12:15], s31 offen lds
  s_add_u32 m0, s36, 5120
  s_add_u32 s31, s35, 1638400
  buffer_load_dwordx4 v4, s[12:15], s31 offen lds
  s_add_u32 m0, s36, 6144
  s_add_u32 s31, s35, 1703936
  buffer_load_dwordx4 v4, s[12:15], s31 offen lds
  s_add_u32 m0, s36, 7168
  s_add_u32 s31, s35, 1769472
  buffer_load_dwordx4 v4, s[12:15], s31 offen lds
  s_waitcnt vmcnt(16)
  ds_read_b64_tr_b16 a[8:9], v5 offset:8192
  ds_read_b64_tr_b16 a[10:11], v5 offset:8704
  ds_read_b64_tr_b16 a[88:89], v5 offset:8224
  ds_read_b64_tr_b16 a[90:91], v5 offset:8736
  ds_read_b64_tr_b16 a[168:169], v5 offset:8256
  ds_read_b64_tr_b16 a[170:171], v5 offset:8768
  ds_read_b64_tr_b16 a[248:249], v5 offset:8288
  ds_read_b64_tr_b16 a[250:251], v5 offset:8800
  s_waitcnt lgkmcnt(0)
  s_add_u32 m0, s36, 8192
  s_add_u32 s31, s35, 1835008
  buffer_load_dwordx4 v4, s[12:15], s31 offen lds
  s_add_u32 m0, s36, 9216
  s_add_u32 s31, s35, 1900544
  buffer_load_dwordx4 v4, s[12:15], s31 offen lds
  s_add_u32 m0, s36, 10240
  s_add_u32 s31, s35, 1966080
  buffer_load_dwordx4 v4, s[12:15], s31 offen lds
  s_add_u32 m0, s36, 11264
  s_add_u32 s31, s35, 2031616
  buffer_load_dwordx4 v4, s[12:15], s31 offen lds
  s_waitcnt vmcnt(16)
  ds_read_b64_tr_b16 a[12:13], v5 offset:12288
  ds_read_b64_tr_b16 a[14:15], v5 offset:12800
  ds_read_b64_tr_b16 a[92:93], v5 offset:12320
  ds_read_b64_tr_b16 a[94:95], v5 offset:12832
  ds_read_b64_tr_b16 a[172:173], v5 offset:12352
  ds_read_b64_tr_b16 a[174:175], v5 offset:12864
  ds_read_b64_tr_b16 a[252:253], v5 offset:12384
  ds_read_b64_tr_b16 a[254:255], v5 offset:12896
  s_waitcnt lgkmcnt(0)
  s_add_u32 m0, s36, 12288
  s_add_u32 s31, s35, 2097152
  buffer_load_dwordx4 v4, s[12:15], s31 offen lds
  s_add_u32 m0, s36, 13312
  s_add_u32 s31, s35, 2162688
  buffer_load_dwordx4 v4, s[12:15], s31 offen lds
  s_add_u32 m0, s36, 14336
  s_add_u32 s31, s35, 2228224
  buffer_load_dwordx4 v4, s[12:15], s31 offen lds
  s_add_u32 m0, s36, 15360
  s_add_u32 s31, s35, 2293760
  buffer_load_dwordx4 v4, s[12:15], s31 offen lds
  s_waitcnt vmcnt(16)
  ds_read_b64_tr_b16 a[16:17], v5 offset:16384
  ds_read_b64_tr_b16 a[18:19], v5 offset:16896
  ds_read_b64_tr_b16 a[96:97], v5 offset:16416
  ds_read_b64_tr_b16 a[98:99], v5 offset:16928
  ds_read_b64_tr_b16 a[176:177], v5 offset:16448
  ds_read_b64_tr_b16 a[178:179], v5 offset:16960
  ds_read_b64_tr_b16 v[112:113], v5 offset:16480
  ds_read_b64_tr_b16 v[114:115], v5 offset:16992
  s_waitcnt lgkmcnt(0)
  s_add_u32 m0, s36, 16384
  s_add_u32 s31, s35, 2359296
  buffer_load_dwordx4 v4, s[12:15], s31 offen lds
  s_add_u32 m0, s36, 17408
  s_add_u32 s31, s35, 2424832
  buffer_load_dwordx4 v4, s[12:15], s31 offen lds
  s_add_u32 m0, s36, 18432
  s_add_u32 s31, s35, 2490368
  buffer_load_dwordx4 v4, s[12:15], s31 offen lds
  s_add_u32 m0, s36, 19456
  s_add_u32 s31, s35, 2555904
  buffer_load_dwordx4 v4, s[12:15], s31 offen lds
  s_waitcnt vmcnt(16)
  ds_read_b64_tr_b16 a[20:21], v5 offset:0
  ds_read_b64_tr_b16 a[22:23], v5 offset:512
  ds_read_b64_tr_b16 a[100:101], v5 offset:32
  ds_read_b64_tr_b16 a[102:103], v5 offset:544
  ds_read_b64_tr_b16 a[180:181], v5 offset:64
  ds_read_b64_tr_b16 a[182:183], v5 offset:576
  ds_read_b64_tr_b16 v[116:117], v5 offset:96
  ds_read_b64_tr_b16 v[118:119], v5 offset:608
  s_waitcnt lgkmcnt(0)
  s_add_u32 m0, s36, 0
  s_add_u32 s31, s35, 2621440
  buffer_load_dwordx4 v4, s[12:15], s31 offen lds
  s_add_u32 m0, s36, 1024
  s_add_u32 s31, s35, 2686976
  buffer_load_dwordx4 v4, s[12:15], s31 offen lds
  s_add_u32 m0, s36, 2048
  s_add_u32 s31, s35, 2752512
  buffer_load_dwordx4 v4, s[12:15], s31 offen lds
  s_add_u32 m0, s36, 3072
  s_add_u32 s31, s35, 2818048
  buffer_load_dwordx4 v4, s[12:15], s31 offen lds
  s_waitcnt vmcnt(16)
  ds_read_b64_tr_b16 a[24:25], v5 offset:4096
  ds_read_b64_tr_b16 a[26:27], v5 offset:4608
  ds_read_b64_tr_b16 a[104:105], v5 offset:4128
  ds_read_b64_tr_b16 a[106:107], v5 offset:4640
  ds_read_b64_tr_b16 a[184:185], v5 offset:4160
  ds_read_b64_tr_b16 a[186:187], v5 offset:4672
  ds_read_b64_tr_b16 v[120:121], v5 offset:4192
  ds_read_b64_tr_b16 v[122:123], v5 offset:4704
  s_waitcnt lgkmcnt(0)
  s_add_u32 m0, s36, 4096
  s_add_u32 s31, s35, 2883584
  buffer_load_dwordx4 v4, s[12:15], s31 offen lds
  s_add_u32 m0, s36, 5120
  s_add_u32 s31, s35, 2949120
  buffer_load_dwordx4 v4, s[12:15], s31 offen lds
  s_add_u32 m0, s36, 6144
  s_add_u32 s31, s35, 3014656
  buffer_load_dwordx4 v4, s[12:15], s31 offen lds
  s_add_u32 m0, s36, 7168
  s_add_u32 s31, s35, 3080192
  buffer_load_dwordx4 v4, s[12:15], s31 offen lds
  s_waitcnt vmcnt(16)
  ds_read_b64_tr_b16 a[28:29], v5 offset:8192
  ds_read_b64_tr_b16 a[30:31], v5 offset:8704
  ds_read_b64_tr_b16 a[108:109], v5 offset:8224
  ds_read_b64_tr_b16 a[110:111], v5 offset:8736
  ds_read_b64_tr_b16 a[188:189], v5 offset:8256
  ds_read_b64_tr_b16 a[190:191], v5 offset:8768
  ds_read_b64_tr_b16 v[124:125], v5 offset:8288
  ds_read_b64_tr_b16 v[126:127], v5 offset:8800
  s_waitcnt lgkmcnt(0)
  s_add_u32 m0, s36, 8192
  s_add_u32 s31, s35, 3145728
  buffer_load_dwordx4 v4, s[12:15], s31 offen lds
  s_add_u32 m0, s36, 9216
  s_add_u32 s31, s35, 3211264
  buffer_load_dwordx4 v4, s[12:15], s31 offen lds
  s_add_u32 m0, s36, 10240
  s_add_u32 s31, s35, 3276800
  buffer_load_dwordx4 v4, s[12:15], s31 offen lds
  s_add_u32 m0, s36, 11264
  s_add_u32 s31, s35, 3342336
  buffer_load_dwordx4 v4, s[12:15], s31 offen lds
  s_waitcnt vmcnt(16)
  ds_read_b64_tr_b16 a[32:33], v5 offset:12288
  ds_read_b64_tr_b16 a[34:35], v5 offset:12800
  ds_read_b64_tr_b16 a[112:113], v5 offset:12320
  ds_read_b64_tr_b16 a[114:115], v5 offset:12832
  ds_read_b64_tr_b16 a[192:193], v5 offset:12352
  ds_read_b64_tr_b16 a[194:195], v5 offset:12864
  ds_read_b64_tr_b16 v[128:129], v5 offset:12384
  ds_read_b64_tr_b16 v[130:131], v5 offset:12896
  s_waitcnt lgkmcnt(0)
  s_add_u32 m0, s36, 12288
  s_add_u32 s31, s35, 3407872
  buffer_load_dwordx4 v4, s[12:15], s31 offen lds
  s_add_u32 m0, s36, 13312
  s_add_u32 s31, s35, 3473408
  buffer_load_dwordx4 v4, s[12:15], s31 offen lds
  s_add_u32 m0, s36, 14336
  s_add_u32 s31, s35, 3538944
  buffer_load_dwordx4 v4, s[12:15], s31 offen lds
  s_add_u32 m0, s36, 15360
  s_add_u32 s31, s35, 3604480
  buffer_load_dwordx4 v4, s[12:15], s31 offen lds
  s_waitcnt vmcnt(16)
  ds_read_b64_tr_b16 a[36:37], v5 offset:16384
  ds_read_b64_tr_b16 a[38:39], v5 offset:16896
  ds_read_b64_tr_b16 a[116:117], v5 offset:16416
  ds_read_b64_tr_b16 a[118:119], v5 offset:16928
  ds_read_b64_tr_b16 a[196:197], v5 offset:16448
  ds_read_b64_tr_b16 a[198:199], v5 offset:16960
  ds_read_b64_tr_b16 v[132:133], v5 offset:16480
  ds_read_b64_tr_b16 v[134:135], v5 offset:16992
  s_waitcnt lgkmcnt(0)
  s_add_u32 m0, s36, 16384
  s_add_u32 s31, s35, 3670016
  buffer_load_dwordx4 v4, s[12:15], s31 offen lds
  s_add_u32 m0, s36, 17408
  s_add_u32 s31, s35, 3735552
  buffer_load_dwordx4 v4, s[12:15], s31 offen lds
  s_add_u32 m0, s36, 18432
  s_add_u32 s31, s35, 3801088
  buffer_load_dwordx4 v4, s[12:15], s31 offen lds
  s_add_u32 m0, s36, 19456
  s_add_u32 s31, s35, 3866624
  buffer_load_dwordx4 v4, s[12:15], s31 offen lds
  s_waitcnt vmcnt(16)
  ds_read_b64_tr_b16 a[40:41], v5 offset:0
  ds_read_b64_tr_b16 a[42:43], v5 offset:512
  ds_read_b64_tr_b16 a[120:121], v5 offset:32
  ds_read_b64_tr_b16 a[122:123], v5 offset:544
  ds_read_b64_tr_b16 a[200:201], v5 offset:64
  ds_read_b64_tr_b16 a[202:203], v5 offset:576
  ds_read_b64_tr_b16 v[136:137], v5 offset:96
  ds_read_b64_tr_b16 v[138:139], v5 offset:608
  s_waitcnt lgkmcnt(0)
  s_add_u32 m0, s36, 0
  s_add_u32 s31, s35, 3932160
  buffer_load_dwordx4 v4, s[12:15], s31 offen lds
  s_add_u32 m0, s36, 1024
  s_add_u32 s31, s35, 3997696
  buffer_load_dwordx4 v4, s[12:15], s31 offen lds
  s_add_u32 m0, s36, 2048
  s_add_u32 s31, s35, 4063232
  buffer_load_dwordx4 v4, s[12:15], s31 offen lds
  s_add_u32 m0, s36, 3072
  s_add_u32 s31, s35, 4128768
  buffer_load_dwordx4 v4, s[12:15], s31 offen lds
  s_waitcnt vmcnt(16)
  ds_read_b64_tr_b16 a[44:45], v5 offset:4096
  ds_read_b64_tr_b16 a[46:47], v5 offset:4608
  ds_read_b64_tr_b16 a[124:125], v5 offset:4128
  ds_read_b64_tr_b16 a[126:127], v5 offset:4640
  ds_read_b64_tr_b16 a[204:205], v5 offset:4160
  ds_read_b64_tr_b16 a[206:207], v5 offset:4672
  ds_read_b64_tr_b16 v[140:141], v5 offset:4192
  ds_read_b64_tr_b16 v[142:143], v5 offset:4704
  s_waitcnt lgkmcnt(0)
  s_add_u32 m0, s36, 4096
  s_add_u32 s31, s35, 4194304
  buffer_load_dwordx4 v4, s[12:15], s31 offen lds
  s_add_u32 m0, s36, 5120
  s_add_u32 s31, s35, 4259840
  buffer_load_dwordx4 v4, s[12:15], s31 offen lds
  s_add_u32 m0, s36, 6144
  s_add_u32 s31, s35, 4325376
  buffer_load_dwordx4 v4, s[12:15], s31 offen lds
  s_add_u32 m0, s36, 7168
  s_add_u32 s31, s35, 4390912
  buffer_load_dwordx4 v4, s[12:15], s31 offen lds
  s_waitcnt vmcnt(16)
  ds_read_b64_tr_b16 a[48:49], v5 offset:8192
  ds_read_b64_tr_b16 a[50:51], v5 offset:8704
  ds_read_b64_tr_b16 a[128:129], v5 offset:8224
  ds_read_b64_tr_b16 a[130:131], v5 offset:8736
  ds_read_b64_tr_b16 a[208:209], v5 offset:8256
  ds_read_b64_tr_b16 a[210:211], v5 offset:8768
  ds_read_b64_tr_b16 v[144:145], v5 offset:8288
  ds_read_b64_tr_b16 v[146:147], v5 offset:8800
  s_waitcnt lgkmcnt(0)
  s_add_u32 m0, s36, 8192
  s_add_u32 s31, s35, 4456448
  buffer_load_dwordx4 v4, s[12:15], s31 offen lds
  s_add_u32 m0, s36, 9216
  s_add_u32 s31, s35, 4521984
  buffer_load_dwordx4 v4, s[12:15], s31 offen lds
  s_add_u32 m0, s36, 10240
  s_add_u32 s31, s35, 4587520
  buffer_load_dwordx4 v4, s[12:15], s31 offen lds
  s_add_u32 m0, s36, 11264
  s_add_u32 s31, s35, 4653056
  buffer_load_dwordx4 v4, s[12:15], s31 offen lds
  s_waitcnt vmcnt(16)
  ds_read_b64_tr_b16 a[52:53], v5 offset:12288
  ds_read_b64_tr_b16 a[54:55], v5 offset:12800
  ds_read_b64_tr_b16 a[132:133], v5 offset:12320
  ds_read_b64_tr_b16 a[134:135], v5 offset:12832
  ds_read_b64_tr_b16 a[212:213], v5 offset:12352
  ds_read_b64_tr_b16 a[214:215], v5 offset:12864
  ds_read_b64_tr_b16 v[148:149], v5 offset:12384
  ds_read_b64_tr_b16 v[150:151], v5 offset:12896
  s_waitcnt lgkmcnt(0)
  s_add_u32 m0, s36, 12288
  s_add_u32 s31, s35, 4718592
  buffer_load_dwordx4 v4, s[12:15], s31 offen lds
  s_add_u32 m0, s36, 13312
  s_add_u32 s31, s35, 4784128
  buffer_load_dwordx4 v4, s[12:15], s31 offen lds
  s_add_u32 m0, s36, 14336
  s_add_u32 s31, s35, 4849664
  buffer_load_dwordx4 v4, s[12:15], s31 offen lds
  s_add_u32 m0, s36, 15360
  s_add_u32 s31, s35, 4915200
  buffer_load_dwordx4 v4, s[12:15], s31 offen lds
  s_waitcnt vmcnt(16)
  ds_read_b64_tr_b16 a[56:57], v5 offset:16384
  ds_read_b64_tr_b16 a[58:59], v5 offset:16896
  ds_read_b64_tr_b16 a[136:137], v5 offset:16416
  ds_read_b64_tr_b16 a[138:139], v5 offset:16928
  ds_read_b64_tr_b16 a[216:217], v5 offset:16448
  ds_read_b64_tr_b16 a[218:219], v5 offset:16960
  ds_read_b64_tr_b16 v[152:153], v5 offset:16480
  ds_read_b64_tr_b16 v[154:155], v5 offset:16992
  s_waitcnt lgkmcnt(0)
  s_add_u32 m0, s36, 16384
  s_add_u32 s31, s35, 4980736
  buffer_load_dwordx4 v4, s[12:15], s31 offen lds
  s_add_u32 m0, s36, 17408
  s_add_u32 s31, s35, 5046272
  buffer_load_dwordx4 v4, s[12:15], s31 offen lds
  s_add_u32 m0, s36, 18432
  s_add_u32 s31, s35, 5111808
  buffer_load_dwordx4 v4, s[12:15], s31 offen lds
  s_add_u32 m0, s36, 19456
  s_add_u32 s31, s35, 5177344
  buffer_load_dwordx4 v4, s[12:15], s31 offen lds
  s_waitcnt vmcnt(16)
  ds_read_b64_tr_b16 a[60:61], v5 offset:0
  ds_read_b64_tr_b16 a[62:63], v5 offset:512
  ds_read_b64_tr_b16 a[140:141], v5 offset:32
  ds_read_b64_tr_b16 a[142:143], v5 offset:544
  ds_read_b64_tr_b16 a[220:221], v5 offset:64
  ds_read_b64_tr_b16 a[222:223], v5 offset:576
  ds_read_b64_tr_b16 v[156:157], v5 offset:96
  ds_read_b64_tr_b16 v[158:159], v5 offset:608
  s_waitcnt lgkmcnt(0)
  s_add_u32 m0, s36, 0
  s_add_u32 s31, s51, 0
  buffer_load_dwordx4 v13, s[16:19], s31 offen lds
  s_add_u32 s51, s51, s37
  s_add_u32 m0, s36, 1024
  s_add_u32 s31, s51, 0
  buffer_load_dwordx4 v13, s[16:19], s31 offen lds
  s_add_u32 s51, s51, s37
  s_add_u32 m0, s36, 2048
  s_add_u32 s31, s51, 0
  buffer_load_dwordx4 v13, s[16:19], s31 offen lds
  s_add_u32 s51, s51, s37
  s_add_u32 m0, s36, 3072
  s_add_u32 s31, s51, 0
  buffer_load_dwordx4 v13, s[16:19], s31 offen lds
  s_add_u32 s51, s51, s37
  s_waitcnt vmcnt(16)
  ds_read_b64_tr_b16 a[64:65], v5 offset:4096
  ds_read_b64_tr_b16 a[66:67], v5 offset:4608
  ds_read_b64_tr_b16 a[144:145], v5 offset:4128
  ds_read_b64_tr_b16 a[146:147], v5 offset:4640
  ds_read_b64_tr_b16 a[224:225], v5 offset:4160
  ds_read_b64_tr_b16 a[226:227], v5 offset:4672
  ds_read_b64_tr_b16 v[160:161], v5 offset:4192
  ds_read_b64_tr_b16 v[162:163], v5 offset:4704
  s_waitcnt lgkmcnt(0)
  s_add_u32 m0, s36, 4096
  s_add_u32 s31, s51, 0
  buffer_load_dwordx4 v13, s[16:19], s31 offen lds
  s_add_u32 s51, s51, s37
  s_add_u32 m0, s36, 5120
  s_add_u32 s31, s51, 0
  buffer_load_dwordx4 v13, s[16:19], s31 offen lds
  s_add_u32 s51, s51, s37
  s_add_u32 m0, s36, 6144
  s_add_u32 s31, s51, 0
  buffer_load_dwordx4 v13, s[16:19], s31 offen lds
  s_add_u32 s51, s51, s37
  s_add_u32 m0, s36, 7168
  s_add_u32 s31, s51, 0
  buffer_load_dwordx4 v13, s[16:19], s31 offen lds
  s_add_u32 s51, s51, s37
  s_waitcnt vmcnt(16)
  ds_read_b64_tr_b16 a[68:69], v5 offset:8192
  ds_read_b64_tr_b16 a[70:71], v5 offset:8704
  ds_read_b64_tr_b16 a[148:149], v5 offset:8224
  ds_read_b64_tr_b16 a[150:151], v5 offset:8736
  ds_read_b64_tr_b16 a[228:229], v5 offset:8256
  ds_read_b64_tr_b16 a[230:231], v5 offset:8768
  ds_read_b64_tr_b16 v[164:165], v5 offset:8288
  ds_read_b64_tr_b16 v[166:167], v5 offset:8800
  s_waitcnt lgkmcnt(0)
  s_add_u32 m0, s36, 8192
  s_add_u32 s31, s51, 0
  buffer_load_dwordx4 v13, s[16:19], s31 offen lds
  s_add_u32 s51, s51, s37
  s_add_u32 m0, s36, 9216
  s_add_u32 s31, s51, 0
  buffer_load_dwordx4 v13, s[16:19], s31 offen lds
  s_add_u32 s51, s51, s37
  s_add_u32 m0, s36, 10240
  s_add_u32 s31, s51, 0
  buffer_load_dwordx4 v13, s[16:19], s31 offen lds
  s_add_u32 s51, s51, s37
  s_add_u32 m0, s36, 11264
  s_add_u32 s31, s51, 0
  buffer_load_dwordx4 v13, s[16:19], s31 offen lds
  s_add_u32 s51, s51, s37
  s_waitcnt vmcnt(16)
  ds_read_b64_tr_b16 a[72:73], v5 offset:12288
  ds_read_b64_tr_b16 a[74:75], v5 offset:12800
  ds_read_b64_tr_b16 a[152:153], v5 offset:12320
  ds_read_b64_tr_b16 a[154:155], v5 offset:12832
  ds_read_b64_tr_b16 a[232:233], v5 offset:12352
  ds_read_b64_tr_b16 a[234:235], v5 offset:12864
  ds_read_b64_tr_b16 v[168:169], v5 offset:12384
  ds_read_b64_tr_b16 v[170:171], v5 offset:12896
  s_waitcnt lgkmcnt(0)
  s_add_u32 m0, s36, 12288
  s_add_u32 s31, s51, 0
  buffer_load_dwordx4 v13, s[16:19], s31 offen lds
  s_add_u32 s51, s51, s37
  s_add_u32 m0, s36, 13312
  s_add_u32 s31, s51, 0
  buffer_load_dwordx4 v13, s[16:19], s31 offen lds
  s_add_u32 s51, s51, s37
  s_add_u32 m0, s36, 14336
  s_add_u32 s31, s51, 0
  buffer_load_dwordx4 v13, s[16:19], s31 offen lds
  s_add_u32 s51, s51, s37
  s_add_u32 m0, s36, 15360
  s_add_u32 s31, s51, 0
  buffer_load_dwordx4 v13, s[16:19], s31 offen lds
  s_add_u32 s51, s51, s37
  s_waitcnt vmcnt(16)
  ds_read_b64_tr_b16 a[76:77], v5 offset:16384
  ds_read_b64_tr_b16 a[78:79], v5 offset:16896
  ds_read_b64_tr_b16 a[156:157], v5 offset:16416
  ds_read_b64_tr_b16 a[158:159], v5 offset:16928
  ds_read_b64_tr_b16 a[236:237], v5 offset:16448
  ds_read_b64_tr_b16 a[238:239], v5 offset:16960
  ds_read_b64_tr_b16 v[172:173], v5 offset:16480
  ds_read_b64_tr_b16 v[174:175], v5 offset:16992
  s_waitcnt lgkmcnt(0)
  s_add_u32 m0, s36, 16384
  s_add_u32 s31, s51, 0
  buffer_load_dwordx4 v13, s[16:19], s31 offen lds
  s_add_u32 s51, s51, s37
  s_add_u32 m0, s36, 17408
  s_add_u32 s31, s51, 0
  buffer_load_dwordx4 v13, s[16:19], s31 offen lds
  s_add_u32 s51, s51, s37
  s_add_u32 m0, s36, 18432
  s_add_u32 s31, s51, 0
  buffer_load_dwordx4 v13, s[16:19], s31 offen lds
  s_add_u32 s51, s51, s37
  s_add_u32 m0, s36, 19456
  s_add_u32 s31, s51, 0
  buffer_load_dwordx4 v13, s[16:19], s31 offen lds
  s_add_u32 s51, s51, s37
  s_waitcnt vmcnt(16)
  ds_read_b64_tr_b16 v[176:177], v15 offset:0
  ds_read_b64_tr_b16 v[178:179], v15 offset:128
  ds_read_b64_tr_b16 v[180:181], v15 offset:1024
  ds_read_b64_tr_b16 v[182:183], v15 offset:1152
  ds_read_b64_tr_b16 v[184:185], v15 offset:2048
  ds_read_b64_tr_b16 v[186:187], v15 offset:2176
  ds_read_b64_tr_b16 v[188:189], v15 offset:3072
  ds_read_b64_tr_b16 v[190:191], v15 offset:3200
  s_waitcnt lgkmcnt(0)
  s_waitcnt vmcnt(12)
  ds_read_b64_tr_b16 v[192:193], v15 offset:4096
  ds_read_b64_tr_b16 v[194:195], v15 offset:4224
  ds_read_b64_tr_b16 v[196:197], v15 offset:5120
  ds_read_b64_tr_b16 v[198:199], v15 offset:5248
  ds_read_b64_tr_b16 v[200:201], v15 offset:6144
  ds_read_b64_tr_b16 v[202:203], v15 offset:6272
  ds_read_b64_tr_b16 v[204:205], v15 offset:7168
  ds_read_b64_tr_b16 v[206:207], v15 offset:7296
  s_waitcnt lgkmcnt(0)
  s_waitcnt vmcnt(8)
  ds_read_b64_tr_b16 v[208:209], v15 offset:8192
  ds_read_b64_tr_b16 v[210:211], v15 offset:8320
  ds_read_b64_tr_b16 v[212:213], v15 offset:9216
  ds_read_b64_tr_b16 v[214:215], v15 offset:9344
  ds_read_b64_tr_b16 v[216:217], v15 offset:10240
  ds_read_b64_tr_b16 v[218:219], v15 offset:10368
  ds_read_b64_tr_b16 v[220:221], v15 offset:11264
  ds_read_b64_tr_b16 v[222:223], v15 offset:11392
  s_waitcnt lgkmcnt(0)
  s_waitcnt vmcnt(4)
  ds_read_b64_tr_b16 v[224:225], v15 offset:12288
  ds_read_b64_tr_b16 v[226:227], v15 offset:12416
  ds_read_b64_tr_b16 v[228:229], v15 offset:13312
  ds_read_b64_tr_b16 v[230:231], v15 offset:13440
  ds_read_b64_tr_b16 v[232:233], v15 offset:14336
  ds_read_b64_tr_b16 v[234:235], v15 offset:14464
  ds_read_b64_tr_b16 v[236:237], v15 offset:15360
  ds_read_b64_tr_b16 v[238:239], v15 offset:15488
  s_waitcnt lgkmcnt(0)
  s_waitcnt vmcnt(0)
  ds_read_b64_tr_b16 v[240:241], v15 offset:16384
  ds_read_b64_tr_b16 v[242:243], v15 offset:16512
  ds_read_b64_tr_b16 v[244:245], v15 offset:17408
  ds_read_b64_tr_b16 v[246:247], v15 offset:17536
  ds_read_b64_tr_b16 v[248:249], v15 offset:18432
  ds_read_b64_tr_b16 v[250:251], v15 offset:18560
  ds_read_b64_tr_b16 v[252:253], v15 offset:19456
  ds_read_b64_tr_b16 v[254:255], v15 offset:19584
  s_waitcnt lgkmcnt(0)
  s_cmp_lt_u32 s33, 44
  s_cbranch_scc1 L_84
  v_lshlrev_b32 v13, 4, v3
  buffer_load_dwordx4 v[176:179], v13, s[16:19], 0 offen offset:0
  buffer_load_dwordx4 v[180:183], v13, s[16:19], 0 offen offset:64
  buffer_load_dwordx4 v[184:187], v13, s[16:19], 0 offen offset:128
  buffer_load_dwordx4 v[188:191], v13, s[16:19], 0 offen offset:192
  buffer_load_dwordx4 v[192:195], v13, s[16:19], 0 offen offset:256
  buffer_load_dwordx4 v[196:199], v13, s[16:19], 0 offen offset:320
  buffer_load_dwordx4 v[200:203], v13, s[16:19], 0 offen offset:384
  buffer_load_dwordx4 v[204:207], v13, s[16:19], 0 offen offset:448
  buffer_load_dwordx4 v[208:211], v13, s[16:19], 0 offen offset:512
  buffer_load_dwordx4 v[212:215], v13, s[16:19], 0 offen offset:576
  buffer_load_dwordx4 v[216:219], v13, s[16:19], 0 offen offset:640
  buffer_load_dwordx4 v[220:223], v13, s[16:19], 0 offen offset:704
  buffer_load_dwordx4 v[224:227], v13, s[16:19], 0 offen offset:768
  buffer_load_dwordx4 v[228:231], v13, s[16:19], 0 offen offset:832
  buffer_load_dwordx4 v[232:235], v13, s[16:19], 0 offen offset:896
  buffer_load_dwordx4 v[236:239], v13, s[16:19], 0 offen offset:960
  buffer_load_dwordx4 v[240:243], v13, s[16:19], 0 offen offset:1024
  buffer_load_dwordx4 v[244:247], v13, s[16:19], 0 offen offset:1088
  buffer_load_dwordx4 v[248:251], v13, s[16:19], 0 offen offset:1152
  buffer_load_dwordx4 v[252:255], v13, s[16:19], 0 offen offset:1216
L_84:
wd_85:
  buffer_load_dword v13, off, s[20:23], 0 offset:128 sc1
  s_waitcnt vmcnt(0)
  v_readfirstlane_b32 s31, v13
  s_cmp_ge_u32 s31, 4
  s_cbranch_scc1 wd_86
  s_sleep 2
  s_sub_u32 s30, s30, 1
  s_cbranch_scc0 wd_85
  s_mov_b32 s30, 0
wd_86:
  v_mov_b32 v7, v1
  v_add_u32 v8, 40960, v1
  s_mul_i32 s49, s28, 20480
  v_add_u32 v12, s49, v1
  s_lshr_b32 s49, s28, 1
  s_lshl_b32 s49, s49, 2
  s_add_u32 s49, s49, s32
  s_lshl_b32 s49, s49, 1
  s_and_b32 s52, s28, 1
  s_add_u32 s49, s49, s52
  s_mul_i32 s49, s49, s43
  s_add_u32 s44, s44, s49
  s_lshl_b32 s43, s43, 4
  s_mov_b32 s42, 0
  s_mov_b32 s47, 81920
  v_mov_b32 v11, s32
  s_cmp_eq_u32 s34, 2
  s_cbranch_scc1 L_pN
L_pT:
  s_barrier
  s_add_u32 s38, s38, 327680
  s_add_u32 s39, s39, s47
  ds_read_b128 v[16:19], v7 offset:0
  ds_read_b128 v[20:23], v7 offset:20480
  ds_read_b128 v[24:27], v7 offset:1024
  ds_read_b128 v[28:31], v7 offset:21504
  ds_read_b128 v[32:35], v7 offset:2048
  ds_read_b128 v[36:39], v7 offset:22528
  s_add_u32 m0, s39, 0
  s_add_u32 s31, s38, 0
  buffer_load_dwordx4 v6, s[8:11], s31 offen lds
  s_waitcnt lgkmcnt(4)
  v_mfma_f32_16x16x32_bf16 v[40:43], a[0:3], v[16:19], 0
  v_mfma_f32_16x16x32_bf16 v[44:47], a[0:3], v[20:23], 0
  v_mfma_f32_16x16x32_bf16 v[48:51], a[80:83], v[16:19], 0
  v_mfma_f32_16x16x32_bf16 v[52:55], a[80:83], v[20:23], 0
  v_mfma_f32_16x16x32_bf16 v[56:59], a[160:163], v[16:19], 0
  v_mfma_f32_16x16x32_bf16 v[60:63], a[160:163], v[20:23], 0
  v_mfma_f32_16x16x32_bf16 v[64:67], a[240:243], v[16:19], 0
  v_mfma_f32_16x16x32_bf16 v[68:71], a[240:243], v[20:23], 0
  ds_read_b128 v[16:19], v7 offset:3072
  ds_read_b128 v[20:23], v7 offset:23552
  s_add_u32 m0, s39, 1024
  s_add_u32 s31, s38, 64
  buffer_load_dwordx4 v6, s[8:11], s31 offen lds
  s_waitcnt lgkmcnt(4)
  v_mfma_f32_16x16x32_bf16 v[40:43], a[4:7], v[24:27], v[40:43]
  v_mfma_f32_16x16x32_bf16 v[44:47], a[4:7], v[28:31], v[44:47]
  v_mfma_f32_16x16x32_bf16 v[48:51], a[84:87], v[24:27], v[48:51]
  v_mfma_f32_16x16x32_bf16 v[52:55], a[84:87], v[28:31], v[52:55]
  v_mfma_f32_16x16x32_bf16 v[56:59], a[164:167], v[24:27], v[56:59]
  v_mfma_f32_16x16x32_bf16 v[60:63], a[164:167], v[28:31], v[60:63]
  v_mfma_f32_16x16x32_bf16 v[64:67], a[244:247], v[24:27], v[64:67]
  v_mfma_f32_16x16x32_bf16 v[68:71], a[244:247], v[28:31], v[68:71]
  ds_read_b128 v[24:27], v7 offset:4096
  ds_read_b128 v[28:31], v7 offset:24576
  s_add_u32 m0, s39, 2048
  s_add_u32 s31, s38, 128
  buffer_load_dwordx4 v6, s[8:11], s31 offen lds
  s_waitcnt lgkmcnt(4)
  v_mfma_f32_16x16x32_bf16 v[40:43], a[8:11], v[32:35], v[40:43]
  v_mfma_f32_16x16x32_bf16 v[44:47], a[8:11], v[36:39], v[44:47]
  v_mfma_f32_16x16x32_bf16 v[48:51], a[88:91], v[32:35], v[48:51]
  v_mfma_f32_16x16x32_bf16 v[52:55], a[88:91], v[36:39], v[52:55]
  v_mfma_f32_16x16x32_bf16 v[56:59], a[168:171], v[32:35], v[56:59]
  v_mfma_f32_16x16x32_bf16 v[60:63], a[168:171], v[36:39], v[60:63]
  v_mfma_f32_16x16x32_bf16 v[64:67], a[248:251], v[32:35], v[64:67]
  v_mfma_f32_16x16x32_bf16 v[68:71], a[248:251], v[36:39], v[68:71]
  ds_read_b128 v[32:35], v7 offset:5120
  ds_read_b128 v[36:39], v7 offset:25600
  s_add_u32 m0, s39, 3072
  s_add_u32 s31, s38, 192
  buffer_load_dwordx4 v6, s[8:11], s31 offen lds
  s_waitcnt lgkmcnt(4)
  v_mfma_f32_16x16x32_bf16 v[40:43], a[12:15], v[16:19], v[40:43]
  v_mfma_f32_16x16x32_bf16 v[44:47], a[12:15], v[20:23], v[44:47]
  v_mfma_f32_16x16x32_bf16 v[48:51], a[92:95], v[16:19], v[48:51]
  v_mfma_f32_16x16x32_bf16 v[52:55], a[92:95], v[20:23], v[52:55]
  v_mfma_f32_16x16x32_bf16 v[56:59], a[172:175], v[16:19], v[56:59]
  v_mfma_f32_16x16x32_bf16 v[60:63], a[172:175], v[20:23], v[60:63]
  v_mfma_f32_16x16x32_bf16 v[64:67], a[252:255], v[16:19], v[64:67]
  v_mfma_f32_16x16x32_bf16 v[68:71], a[252:255], v[20:23], v[68:71]
  ds_read_b128 v[16:19], v7 offset:6144
  ds_read_b128 v[20:23], v7 offset:26624
  s_add_u32 m0, s39, 4096
  s_add_u32 s31, s38, 256
  buffer_load_dwordx4 v6, s[8:11], s31 offen lds
  s_waitcnt lgkmcnt(4)
  v_mfma_f32_16x16x32_bf16 v[40:43], a[16:19], v[24:27], v[40:43]
  v_mfma_f32_16x16x32_bf16 v[44:47], a[16:19], v[28:31], v[44:47]
  v_mfma_f32_16x16x32_bf16 v[48:51], a[96:99], v[24:27], v[48:51]
  v_mfma_f32_16x16x32_bf16 v[52:55], a[96:99], v[28:31], v[52:55]
  v_mfma_f32_16x16x32_bf16 v[56:59], a[176:179], v[24:27], v[56:59]
  v_mfma_f32_16x16x32_bf16 v[60:63], a[176:179], v[28:31], v[60:63]
  v_mfma_f32_16x16x32_bf16 v[64:67], v[112:115], v[24:27], v[64:67]
  v_mfma_f32_16x16x32_bf16 v[68:71], v[112:115], v[28:31], v[68:71]
  ds_read_b128 v[24:27], v7 offset:7168
  ds_read_b128 v[28:31], v7 offset:27648
  s_add_u32 m0, s39, 5120
  s_add_u32 s31, s38, 320
  buffer_load_dwordx4 v6, s[8:11], s31 offen lds
  s_waitcnt lgkmcnt(4)
  v_mfma_f32_16x16x32_bf16 v[40:43], a[20:23], v[32:35], v[40:43]
  v_mfma_f32_16x16x32_bf16 v[44:47], a[20:23], v[36:39], v[44:47]
  v_mfma_f32_16x16x32_bf16 v[48:51], a[100:103], v[32:35], v[48:51]
  v_mfma_f32_16x16x32_bf16 v[52:55], a[100:103], v[36:39], v[52:55]
  v_mfma_f32_16x16x32_bf16 v[56:59], a[180:183], v[32:35], v[56:59]
  v_mfma_f32_16x16x32_bf16 v[60:63], a[180:183], v[36:39], v[60:63]
  v_mfma_f32_16x16x32_bf16 v[64:67], v[116:119], v[32:35], v[64:67]
  v_mfma_f32_16x16x32_bf16 v[68:71], v[116:119], v[36:39], v[68:71]
  ds_read_b128 v[32:35], v7 offset:8192
  ds_read_b128 v[36:39], v7 offset:28672
  s_add_u32 m0, s39, 6144
  s_add_u32 s31, s38, 384
  buffer_load_dwordx4 v6, s[8:11], s31 offen lds
  s_waitcnt lgkmcnt(4)
  v_mfma_f32_16x16x32_bf16 v[40:43], a[24:27], v[16:19], v[40:43]
  v_mfma_f32_16x16x32_bf16 v[44:47], a[24:27], v[20:23], v[44:47]
  v_mfma_f32_16x16x32_bf16 v[48:51], a[104:107], v[16:19], v[48:51]
  v_mfma_f32_16x16x32_bf16 v[52:55], a[104:107], v[20:23], v[52:55]
  v_mfma_f32_16x16x32_bf16 v[56:59], a[184:187], v[16:19], v[56:59]
  v_mfma_f32_16x16x32_bf16 v[60:63], a[184:187], v[20:23], v[60:63]
  v_mfma_f32_16x16x32_bf16 v[64:67], v[120:123], v[16:19], v[64:67]
  v_mfma_f32_16x16x32_bf16 v[68:71], v[120:123], v[20:23], v[68:71]
  ds_read_b128 v[16:19], v7 offset:9216
  ds_read_b128 v[20:23], v7 offset:29696
  s_add_u32 m0, s39, 7168
  s_add_u32 s31, s38, 448
  buffer_load_dwordx4 v6, s[8:11], s31 offen lds
  s_waitcnt lgkmcnt(4)
  v_mfma_f32_16x16x32_bf16 v[40:43], a[28:31], v[24:27], v[40:43]
  v_mfma_f32_16x16x32_bf16 v[44:47], a[28:31], v[28:31], v[44:47]
  v_mfma_f32_16x16x32_bf16 v[48:51], a[108:111], v[24:27], v[48:51]
  v_mfma_f32_16x16x32_bf16 v[52:55], a[108:111], v[28:31], v[52:55]
  v_mfma_f32_16x16x32_bf16 v[56:59], a[188:191], v[24:27], v[56:59]
  v_mfma_f32_16x16x32_bf16 v[60:63], a[188:191], v[28:31], v[60:63]
  v_mfma_f32_16x16x32_bf16 v[64:67], v[124:127], v[24:27], v[64:67]
  v_mfma_f32_16x16x32_bf16 v[68:71], v[124:127], v[28:31], v[68:71]
  ds_read_b128 v[24:27], v7 offset:10240
  ds_read_b128 v[28:31], v7 offset:30720
  s_add_u32 m0, s39, 8192
  s_add_u32 s31, s38, 512
  buffer_load_dwordx4 v6, s[8:11], s31 offen lds
  s_waitcnt lgkmcnt(4)
  v_mfma_f32_16x16x32_bf16 v[40:43], a[32:35], v[32:35], v[40:43]
  v_mfma_f32_16x16x32_bf16 v[44:47], a[32:35], v[36:39], v[44:47]
  v_mfma_f32_16x16x32_bf16 v[48:51], a[112:115], v[32:35], v[48:51]
  v_mfma_f32_16x16x32_bf16 v[52:55], a[112:115], v[36:39], v[52:55]
  v_mfma_f32_16x16x32_bf16 v[56:59], a[192:195], v[32:35], v[56:59]
  v_mfma_f32_16x16x32_bf16 v[60:63], a[192:195], v[36:39], v[60:63]
  v_mfma_f32_16x16x32_bf16 v[64:67], v[128:131], v[32:35], v[64:67]
  v_mfma_f32_16x16x32_bf16 v[68:71], v[128:131], v[36:39], v[68:71]
  ds_read_b128 v[32:35], v7 offset:11264
  ds_read_b128 v[36:39], v7 offset:31744
  s_add_u32 m0, s39, 9216
  s_add_u32 s31, s38, 576
  buffer_load_dwordx4 v6, s[8:11], s31 offen lds
  s_waitcnt lgkmcnt(4)
  v_mfma_f32_16x16x32_bf16 v[40:43], a[36:39], v[16:19], v[40:43]
  v_mfma_f32_16x16x32_bf16 v[44:47], a[36:39], v[20:23], v[44:47]
  v_mfma_f32_16x16x32_bf16 v[48:51], a[116:119], v[16:19], v[48:51]
  v_mfma_f32_16x16x32_bf16 v[52:55], a[116:119], v[20:23], v[52:55]
  v_mfma_f32_16x16x32_bf16 v[56:59], a[196:199], v[16:19], v[56:59]
  v_mfma_f32_16x16x32_bf16 v[60:63], a[196:199], v[20:23], v[60:63]
  v_mfma_f32_16x16x32_bf16 v[64:67], v[132:135], v[16:19], v[64:67]
  v_mfma_f32_16x16x32_bf16 v[68:71], v[132:135], v[20:23], v[68:71]
  ds_read_b128 v[16:19], v7 offset:12288
  ds_read_b128 v[20:23], v7 offset:32768
  s_add_u32 m0, s39, 40960
  s_add_u32 s31, s38, 163840
  buffer_load_dwordx4 v6, s[8:11], s31 offen lds
  s_waitcnt lgkmcnt(4)
  v_mfma_f32_16x16x32_bf16 v[40:43], a[40:43], v[24:27], v[40:43]
  v_mfma_f32_16x16x32_bf16 v[44:47], a[40:43], v[28:31], v[44:47]
  v_mfma_f32_16x16x32_bf16 v[48:51], a[120:123], v[24:27], v[48:51]
  v_mfma_f32_16x16x32_bf16 v[52:55], a[120:123], v[28:31], v[52:55]
  v_mfma_f32_16x16x32_bf16 v[56:59], a[200:203], v[24:27], v[56:59]
  v_mfma_f32_16x16x32_bf16 v[60:63], a[200:203], v[28:31], v[60:63]
  v_mfma_f32_16x16x32_bf16 v[64:67], v[136:139], v[24:27], v[64:67]
  v_mfma_f32_16x16x32_bf16 v[68:71], v[136:139], v[28:31], v[68:71]
  ds_read_b128 v[24:27], v7 offset:13312
  ds_read_b128 v[28:31], v7 offset:33792
  s_add_u32 m0, s39, 41984
  s_add_u32 s31, s38, 163904
  buffer_load_dwordx4 v6, s[8:11], s31 offen lds
  s_waitcnt lgkmcnt(4)
  v_mfma_f32_16x16x32_bf16 v[40:43], a[44:47], v[32:35], v[40:43]
  v_mfma_f32_16x16x32_bf16 v[44:47], a[44:47], v[36:39], v[44:47]
  v_mfma_f32_16x16x32_bf16 v[48:51], a[124:127], v[32:35], v[48:51]
  v_mfma_f32_16x16x32_bf16 v[52:55], a[124:127], v[36:39], v[52:55]
  v_mfma_f32_16x16x32_bf16 v[56:59], a[204:207], v[32:35], v[56:59]
  v_mfma_f32_16x16x32_bf16 v[60:63], a[204:207], v[36:39], v[60:63]
  v_mfma_f32_16x16x32_bf16 v[64:67], v[140:143], v[32:35], v[64:67]
  v_mfma_f32_16x16x32_bf16 v[68:71], v[140:143], v[36:39], v[68:71]
  ds_read_b128 v[32:35], v7 offset:14336
  ds_read_b128 v[36:39], v7 offset:34816
  s_add_u32 m0, s39, 43008
  s_add_u32 s31, s38, 163968
  buffer_load_dwordx4 v6, s[8:11], s31 offen lds
  s_waitcnt lgkmcnt(4)
  v_mfma_f32_16x16x32_bf16 v[40:43], a[48:51], v[16:19], v[40:43]
  v_mfma_f32_16x16x32_bf16 v[44:47], a[48:51], v[20:23], v[44:47]
  v_mfma_f32_16x16x32_bf16 v[48:51], a[128:131], v[16:19], v[48:51]
  v_mfma_f32_16x16x32_bf16 v[52:55], a[128:131], v[20:23], v[52:55]
  v_mfma_f32_16x16x32_bf16 v[56:59], a[208:211], v[16:19], v[56:59]
  v_mfma_f32_16x16x32_bf16 v[60:63], a[208:211], v[20:23], v[60:63]
  v_mfma_f32_16x16x32_bf16 v[64:67], v[144:147], v[16:19], v[64:67]
  v_mfma_f32_16x16x32_bf16 v[68:71], v[144:147], v[20:23], v[68:71]
  ds_read_b128 v[16:19], v7 offset:15360
  ds_read_b128 v[20:23], v7 offset:35840
  s_add_u32 m0, s39, 44032
  s_add_u32 s31, s38, 164032
  buffer_load_dwordx4 v6, s[8:11], s31 offen lds
  s_waitcnt lgkmcnt(4)
  v_mfma_f32_16x16x32_bf16 v[40:43], a[52:55], v[24:27], v[40:43]
  v_mfma_f32_16x16x32_bf16 v[44:47], a[52:55], v[28:31], v[44:47]
  v_mfma_f32_16x16x32_bf16 v[48:51], a[132:135], v[24:27], v[48:51]
  v_mfma_f32_16x16x32_bf16 v[52:55], a[132:135], v[28:31], v[52:55]
  v_mfma_f32_16x16x32_bf16 v[56:59], a[212:215], v[24:27], v[56:59]
  v_mfma_f32_16x16x32_bf16 v[60:63], a[212:215], v[28:31], v[60:63]
  v_mfma_f32_16x16x32_bf16 v[64:67], v[148:151], v[24:27], v[64:67]
  v_mfma_f32_16x16x32_bf16 v[68:71], v[148:151], v[28:31], v[68:71]
  ds_read_b128 v[24:27], v7 offset:16384
  ds_read_b128 v[28:31], v7 offset:36864
  s_add_u32 m0, s39, 45056
  s_add_u32 s31, s38, 164096
  buffer_load_dwordx4 v6, s[8:11], s31 offen lds
  s_waitcnt lgkmcnt(4)
  v_mfma_f32_16x16x32_bf16 v[40:43], a[56:59], v[32:35], v[40:43]
  v_mfma_f32_16x16x32_bf16 v[44:47], a[56:59], v[36:39], v[44:47]
  v_mfma_f32_16x16x32_bf16 v[48:51], a[136:139], v[32:35], v[48:51]
  v_mfma_f32_16x16x32_bf16 v[52:55], a[136:139], v[36:39], v[52:55]
  v_mfma_f32_16x16x32_bf16 v[56:59], a[216:219], v[32:35], v[56:59]
  v_mfma_f32_16x16x32_bf16 v[60:63], a[216:219], v[36:39], v[60:63]
  v_mfma_f32_16x16x32_bf16 v[64:67], v[152:155], v[32:35], v[64:67]
  v_mfma_f32_16x16x32_bf16 v[68:71], v[152:155], v[36:39], v[68:71]
  ds_read_b128 v[32:35], v7 offset:17408
  ds_read_b128 v[36:39], v7 offset:37888
  s_add_u32 m0, s39, 46080
  s_add_u32 s31, s38, 164160
  buffer_load_dwordx4 v6, s[8:11], s31 offen lds
  s_waitcnt lgkmcnt(4)
  v_mfma_f32_16x16x32_bf16 v[40:43], a[60:63], v[16:19], v[40:43]
  v_mfma_f32_16x16x32_bf16 v[44:47], a[60:63], v[20:23], v[44:47]
  v_mfma_f32_16x16x32_bf16 v[48:51], a[140:143], v[16:19], v[48:51]
  v_mfma_f32_16x16x32_bf16 v[52:55], a[140:143], v[20:23], v[52:55]
  v_mfma_f32_16x16x32_bf16 v[56:59], a[220:223], v[16:19], v[56:59]
  v_mfma_f32_16x16x32_bf16 v[60:63], a[220:223], v[20:23], v[60:63]
  v_mfma_f32_16x16x32_bf16 v[64:67], v[156:159], v[16:19], v[64:67]
  v_mfma_f32_16x16x32_bf16 v[68:71], v[156:159], v[20:23], v[68:71]
  ds_read_b128 v[16:19], v7 offset:18432
  ds_read_b128 v[20:23], v7 offset:38912
  s_add_u32 m0, s39, 47104
  s_add_u32 s31, s38, 164224
  buffer_load_dwordx4 v6, s[8:11], s31 offen lds
  s_waitcnt lgkmcnt(4)
  v_mfma_f32_16x16x32_bf16 v[40:43], a[64:67], v[24:27], v[40:43]
  v_mfma_f32_16x16x32_bf16 v[44:47], a[64:67], v[28:31], v[44:47]
  v_mfma_f32_16x16x32_bf16 v[48:51], a[144:147], v[24:27], v[48:51]
  v_mfma_f32_16x16x32_bf16 v[52:55], a[144:147], v[28:31], v[52:55]
  v_mfma_f32_16x16x32_bf16 v[56:59], a[224:227], v[24:27], v[56:59]
  v_mfma_f32_16x16x32_bf16 v[60:63], a[224:227], v[28:31], v[60:63]
  v_mfma_f32_16x16x32_bf16 v[64:67], v[160:163], v[24:27], v[64:67]
  v_mfma_f32_16x16x32_bf16 v[68:71], v[160:163], v[28:31], v[68:71]
  ds_read_b128 v[24:27], v7 offset:19456
  ds_read_b128 v[28:31], v7 offset:39936
  s_add_u32 m0, s39, 48128
  s_add_u32 s31, s38, 164288
  buffer_load_dwordx4 v6, s[8:11], s31 offen lds
  s_waitcnt lgkmcnt(4)
  v_mfma_f32_16x16x32_bf16 v[40:43], a[68:71], v[32:35], v[40:43]
  v_mfma_f32_16x16x32_bf16 v[44:47], a[68:71], v[36:39], v[44:47]
  v_mfma_f32_16x16x32_bf16 v[48:51], a[148:151], v[32:35], v[48:51]
  v_mfma_f32_16x16x32_bf16 v[52:55], a[148:151], v[36:39], v[52:55]
  v_mfma_f32_16x16x32_bf16 v[56:59], a[228:231], v[32:35], v[56:59]
  v_mfma_f32_16x16x32_bf16 v[60:63], a[228:231], v[36:39], v[60:63]
  v_mfma_f32_16x16x32_bf16 v[64:67], v[164:167], v[32:35], v[64:67]
  v_mfma_f32_16x16x32_bf16 v[68:71], v[164:167], v[36:39], v[68:71]
  s_add_u32 m0, s39, 49152
  s_add_u32 s31, s38, 164352
  buffer_load_dwordx4 v6, s[8:11], s31 offen lds
  s_waitcnt lgkmcnt(2)
  v_mfma_f32_16x16x32_bf16 v[40:43], a[72:75], v[16:19], v[40:43]
  v_mfma_f32_16x16x32_bf16 v[44:47], a[72:75], v[20:23], v[44:47]
  v_mfma_f32_16x16x32_bf16 v[48:51], a[152:155], v[16:19], v[48:51]
  v_mfma_f32_16x16x32_bf16 v[52:55], a[152:155], v[20:23], v[52:55]
  v_mfma_f32_16x16x32_bf16 v[56:59], a[232:235], v[16:19], v[56:59]
  v_mfma_f32_16x16x32_bf16 v[60:63], a[232:235], v[20:23], v[60:63]
  v_mfma_f32_16x16x32_bf16 v[64:67], v[168:171], v[16:19], v[64:67]
  v_mfma_f32_16x16x32_bf16 v[68:71], v[168:171], v[20:23], v[68:71]
  s_add_u32 m0, s39, 50176
  s_add_u32 s31, s38, 164416
  buffer_load_dwordx4 v6, s[8:11], s31 offen lds
  s_waitcnt lgkmcnt(0)
  v_mfma_f32_16x16x32_bf16 v[40:43], a[76:79], v[24:27], v[40:43]
  v_mfma_f32_16x16x32_bf16 v[44:47], a[76:79], v[28:31], v[44:47]
  v_mfma_f32_16x16x32_bf16 v[48:51], a[156:159], v[24:27], v[48:51]
  v_mfma_f32_16x16x32_bf16 v[52:55], a[156:159], v[28:31], v[52:55]
  v_mfma_f32_16x16x32_bf16 v[56:59], a[236:239], v[24:27], v[56:59]
  v_mfma_f32_16x16x32_bf16 v[60:63], a[236:239], v[28:31], v[60:63]
  v_mfma_f32_16x16x32_bf16 v[64:67], v[172:175], v[24:27], v[64:67]
  v_mfma_f32_16x16x32_bf16 v[68:71], v[172:175], v[28:31], v[68:71]
  s_waitcnt vmcnt(20)
  s_mov_b64 exec, 1
  buffer_store_dword v11, off, s[4:7], s41 sc1
  s_mov_b64 exec, -1
  v_add_u32 v11, 4, v11
  v_cvt_pk_bf16_f32 v72, v40, v41
  v_cvt_pk_bf16_f32 v73, v42, v43
  v_cvt_pk_bf16_f32 v74, v48, v49
  v_cvt_pk_bf16_f32 v75, v50, v51
  buffer_store_dwordx4 v[72:75], v1, s[4:7], s40 offen offset:0 sc1
  v_cvt_pk_bf16_f32 v76, v44, v45
  v_cvt_pk_bf16_f32 v77, v46, v47
  v_cvt_pk_bf16_f32 v78, v52, v53
  v_cvt_pk_bf16_f32 v79, v54, v55
  buffer_store_dwordx4 v[76:79], v1, s[4:7], s40 offen offset:1024 sc1
  v_cvt_pk_bf16_f32 v80, v56, v57
  v_cvt_pk_bf16_f32 v81, v58, v59
  v_cvt_pk_bf16_f32 v82, v64, v65
  v_cvt_pk_bf16_f32 v83, v66, v67
  buffer_store_dwordx4 v[80:83], v1, s[4:7], s40 offen offset:2048 sc1
  v_cvt_pk_bf16_f32 v84, v60, v61
  v_cvt_pk_bf16_f32 v85, v62, v63
  v_cvt_pk_bf16_f32 v86, v68, v69
  v_cvt_pk_bf16_f32 v87, v70, v71
  buffer_store_dwordx4 v[84:87], v1, s[4:7], s40 offen offset:3072 sc1
  s_add_u32 s40, s40, 1048576
  ds_read_b128 v[16:19], v8 offset:0
  ds_read_b128 v[20:23], v8 offset:20480
  ds_read_b128 v[24:27], v8 offset:1024
  ds_read_b128 v[28:31], v8 offset:21504
  ds_read_b128 v[32:35], v8 offset:2048
  ds_read_b128 v[36:39], v8 offset:22528
  s_waitcnt lgkmcnt(4)
  v_mfma_f32_16x16x32_bf16 v[40:43], a[0:3], v[16:19], 0
  v_mfma_f32_16x16x32_bf16 v[44:47], a[0:3], v[20:23], 0
  v_mfma_f32_16x16x32_bf16 v[48:51], a[80:83], v[16:19], 0
  v_mfma_f32_16x16x32_bf16 v[52:55], a[80:83], v[20:23], 0
  v_mfma_f32_16x16x32_bf16 v[56:59], a[160:163], v[16:19], 0
  v_mfma_f32_16x16x32_bf16 v[60:63], a[160:163], v[20:23], 0
  v_mfma_f32_16x16x32_bf16 v[64:67], a[240:243], v[16:19], 0
  v_mfma_f32_16x16x32_bf16 v[68:71], a[240:243], v[20:23], 0
  ds_read_b128 v[16:19], v8 offset:3072
  ds_read_b128 v[20:23], v8 offset:23552
  s_waitcnt lgkmcnt(4)
  v_mfma_f32_16x16x32_bf16 v[40:43], a[4:7], v[24:27], v[40:43]
  v_mfma_f32_16x16x32_bf16 v[44:47], a[4:7], v[28:31], v[44:47]
  v_mfma_f32_16x16x32_bf16 v[48:51], a[84:87], v[24:27], v[48:51]
  v_mfma_f32_16x16x32_bf16 v[52:55], a[84:87], v[28:31], v[52:55]
  v_mfma_f32_16x16x32_bf16 v[56:59], a[164:167], v[24:27], v[56:59]
  v_mfma_f32_16x16x32_bf16 v[60:63], a[164:167], v[28:31], v[60:63]
  v_mfma_f32_16x16x32_bf16 v[64:67], a[244:247], v[24:27], v[64:67]
  v_mfma_f32_16x16x32_bf16 v[68:71], a[244:247], v[28:31], v[68:71]
  ds_read_b128 v[24:27], v8 offset:4096
  ds_read_b128 v[28:31], v8 offset:24576
  s_waitcnt lgkmcnt(4)
  v_mfma_f32_16x16x32_bf16 v[40:43], a[8:11], v[32:35], v[40:43]
  v_mfma_f32_16x16x32_bf16 v[44:47], a[8:11], v[36:39], v[44:47]
  v_mfma_f32_16x16x32_bf16 v[48:51], a[88:91], v[32:35], v[48:51]
  v_mfma_f32_16x16x32_bf16 v[52:55], a[88:91], v[36:39], v[52:55]
  v_mfma_f32_16x16x32_bf16 v[56:59], a[168:171], v[32:35], v[56:59]
  v_mfma_f32_16x16x32_bf16 v[60:63], a[168:171], v[36:39], v[60:63]
  v_mfma_f32_16x16x32_bf16 v[64:67], a[248:251], v[32:35], v[64:67]
  v_mfma_f32_16x16x32_bf16 v[68:71], a[248:251], v[36:39], v[68:71]
  ds_read_b128 v[32:35], v8 offset:5120
  ds_read_b128 v[36:39], v8 offset:25600
  s_waitcnt lgkmcnt(4)
  v_mfma_f32_16x16x32_bf16 v[40:43], a[12:15], v[16:19], v[40:43]
  v_mfma_f32_16x16x32_bf16 v[44:47], a[12:15], v[20:23], v[44:47]
  v_mfma_f32_16x16x32_bf16 v[48:51], a[92:95], v[16:19], v[48:51]
  v_mfma_f32_16x16x32_bf16 v[52:55], a[92:95], v[20:23], v[52:55]
  v_mfma_f32_16x16x32_bf16 v[56:59], a[172:175], v[16:19], v[56:59]
  v_mfma_f32_16x16x32_bf16 v[60:63], a[172:175], v[20:23], v[60:63]
  v_mfma_f32_16x16x32_bf16 v[64:67], a[252:255], v[16:19], v[64:67]
  v_mfma_f32_16x16x32_bf16 v[68:71], a[252:255], v[20:23], v[68:71]
  ds_read_b128 v[16:19], v8 offset:6144
  ds_read_b128 v[20:23], v8 offset:26624
  s_waitcnt lgkmcnt(4)
  v_mfma_f32_16x16x32_bf16 v[40:43], a[16:19], v[24:27], v[40:43]
  v_mfma_f32_16x16x32_bf16 v[44:47], a[16:19], v[28:31], v[44:47]
  v_mfma_f32_16x16x32_bf16 v[48:51], a[96:99], v[24:27], v[48:51]
  v_mfma_f32_16x16x32_bf16 v[52:55], a[96:99], v[28:31], v[52:55]
  v_mfma_f32_16x16x32_bf16 v[56:59], a[176:179], v[24:27], v[56:59]
  v_mfma_f32_16x16x32_bf16 v[60:63], a[176:179], v[28:31], v[60:63]
  v_mfma_f32_16x16x32_bf16 v[64:67], v[112:115], v[24:27], v[64:67]
  v_mfma_f32_16x16x32_bf16 v[68:71], v[112:115], v[28:31], v[68:71]
  ds_read_b128 v[24:27], v8 offset:7168
  ds_read_b128 v[28:31], v8 offset:27648
  s_waitcnt lgkmcnt(4)
  v_mfma_f32_16x16x32_bf16 v[40:43], a[20:23], v[32:35], v[40:43]
  v_mfma_f32_16x16x32_bf16 v[44:47], a[20:23], v[36:39], v[44:47]
  v_mfma_f32_16x16x32_bf16 v[48:51], a[100:103], v[32:35], v[48:51]
  v_mfma_f32_16x16x32_bf16 v[52:55], a[100:103], v[36:39], v[52:55]
  v_mfma_f32_16x16x32_bf16 v[56:59], a[180:183], v[32:35], v[56:59]
  v_mfma_f32_16x16x32_bf16 v[60:63], a[180:183], v[36:39], v[60:63]
  v_mfma_f32_16x16x32_bf16 v[64:67], v[116:119], v[32:35], v[64:67]
  v_mfma_f32_16x16x32_bf16 v[68:71], v[116:119], v[36:39], v[68:71]
  ds_read_b128 v[32:35], v8 offset:8192
  ds_read_b128 v[36:39], v8 offset:28672
  s_waitcnt lgkmcnt(4)
  v_mfma_f32_16x16x32_bf16 v[40:43], a[24:27], v[16:19], v[40:43]
  v_mfma_f32_16x16x32_bf16 v[44:47], a[24:27], v[20:23], v[44:47]
  v_mfma_f32_16x16x32_bf16 v[48:51], a[104:107], v[16:19], v[48:51]
  v_mfma_f32_16x16x32_bf16 v[52:55], a[104:107], v[20:23], v[52:55]
  v_mfma_f32_16x16x32_bf16 v[56:59], a[184:187], v[16:19], v[56:59]
  v_mfma_f32_16x16x32_bf16 v[60:63], a[184:187], v[20:23], v[60:63]
  v_mfma_f32_16x16x32_bf16 v[64:67], v[120:123], v[16:19], v[64:67]
  v_mfma_f32_16x16x32_bf16 v[68:71], v[120:123], v[20:23], v[68:71]
  ds_read_b128 v[16:19], v8 offset:9216
  ds_read_b128 v[20:23], v8 offset:29696
  s_waitcnt lgkmcnt(4)
  v_mfma_f32_16x16x32_bf16 v[40:43], a[28:31], v[24:27], v[40:43]
  v_mfma_f32_16x16x32_bf16 v[44:47], a[28:31], v[28:31], v[44:47]
  v_mfma_f32_16x16x32_bf16 v[48:51], a[108:111], v[24:27], v[48:51]
  v_mfma_f32_16x16x32_bf16 v[52:55], a[108:111], v[28:31], v[52:55]
  v_mfma_f32_16x16x32_bf16 v[56:59], a[188:191], v[24:27], v[56:59]
  v_mfma_f32_16x16x32_bf16 v[60:63], a[188:191], v[28:31], v[60:63]
  v_mfma_f32_16x16x32_bf16 v[64:67], v[124:127], v[24:27], v[64:67]
  v_mfma_f32_16x16x32_bf16 v[68:71], v[124:127], v[28:31], v[68:71]
  ds_read_b128 v[24:27], v8 offset:10240
  ds_read_b128 v[28:31], v8 offset:30720
  s_waitcnt lgkmcnt(4)
  v_mfma_f32_16x16x32_bf16 v[40:43], a[32:35], v[32:35], v[40:43]
  v_mfma_f32_16x16x32_bf16 v[44:47], a[32:35], v[36:39], v[44:47]
  v_mfma_f32_16x16x32_bf16 v[48:51], a[112:115], v[32:35], v[48:51]
  v_mfma_f32_16x16x32_bf16 v[52:55], a[112:115], v[36:39], v[52:55]
  v_mfma_f32_16x16x32_bf16 v[56:59], a[192:195], v[32:35], v[56:59]
  v_mfma_f32_16x16x32_bf16 v[60:63], a[192:195], v[36:39], v[60:63]
  v_mfma_f32_16x16x32_bf16 v[64:67], v[128:131], v[32:35], v[64:67]
  v_mfma_f32_16x16x32_bf16 v[68:71], v[128:131], v[36:39], v[68:71]
  ds_read_b128 v[32:35], v8 offset:11264
  ds_read_b128 v[36:39], v8 offset:31744
  s_waitcnt lgkmcnt(4)
  v_mfma_f32_16x16x32_bf16 v[40:43], a[36:39], v[16:19], v[40:43]
  v_mfma_f32_16x16x32_bf16 v[44:47], a[36:39], v[20:23], v[44:47]
  v_mfma_f32_16x16x32_bf16 v[48:51], a[116:119], v[16:19], v[48:51]
  v_mfma_f32_16x16x32_bf16 v[52:55], a[116:119], v[20:23], v[52:55]
  v_mfma_f32_16x16x32_bf16 v[56:59], a[196:199], v[16:19], v[56:59]
  v_mfma_f32_16x16x32_bf16 v[60:63], a[196:199], v[20:23], v[60:63]
  v_mfma_f32_16x16x32_bf16 v[64:67], v[132:135], v[16:19], v[64:67]
  v_mfma_f32_16x16x32_bf16 v[68:71], v[132:135], v[20:23], v[68:71]
  ds_read_b128 v[16:19], v8 offset:12288
  ds_read_b128 v[20:23], v8 offset:32768
  s_waitcnt lgkmcnt(4)
  v_mfma_f32_16x16x32_bf16 v[40:43], a[40:43], v[24:27], v[40:43]
  v_mfma_f32_16x16x32_bf16 v[44:47], a[40:43], v[28:31], v[44:47]
  v_mfma_f32_16x16x32_bf16 v[48:51], a[120:123], v[24:27], v[48:51]
  v_mfma_f32_16x16x32_bf16 v[52:55], a[120:123], v[28:31], v[52:55]
  v_mfma_f32_16x16x32_bf16 v[56:59], a[200:203], v[24:27], v[56:59]
  v_mfma_f32_16x16x32_bf16 v[60:63], a[200:203], v[28:31], v[60:63]
  v_mfma_f32_16x16x32_bf16 v[64:67], v[136:139], v[24:27], v[64:67]
  v_mfma_f32_16x16x32_bf16 v[68:71], v[136:139], v[28:31], v[68:71]
  ds_read_b128 v[24:27], v8 offset:13312
  ds_read_b128 v[28:31], v8 offset:33792
  s_waitcnt lgkmcnt(4)
  v_mfma_f32_16x16x32_bf16 v[40:43], a[44:47], v[32:35], v[40:43]
  v_mfma_f32_16x16x32_bf16 v[44:47], a[44:47], v[36:39], v[44:47]
  v_mfma_f32_16x16x32_bf16 v[48:51], a[124:127], v[32:35], v[48:51]
  v_mfma_f32_16x16x32_bf16 v[52:55], a[124:127], v[36:39], v[52:55]
  v_mfma_f32_16x16x32_bf16 v[56:59], a[204:207], v[32:35], v[56:59]
  v_mfma_f32_16x16x32_bf16 v[60:63], a[204:207], v[36:39], v[60:63]
  v_mfma_f32_16x16x32_bf16 v[64:67], v[140:143], v[32:35], v[64:67]
  v_mfma_f32_16x16x32_bf16 v[68:71], v[140:143], v[36:39], v[68:71]
  ds_read_b128 v[32:35], v8 offset:14336
  ds_read_b128 v[36:39], v8 offset:34816
  s_waitcnt lgkmcnt(4)
  v_mfma_f32_16x16x32_bf16 v[40:43], a[48:51], v[16:19], v[40:43]
  v_mfma_f32_16x16x32_bf16 v[44:47], a[48:51], v[20:23], v[44:47]
  v_mfma_f32_16x16x32_bf16 v[48:51], a[128:131], v[16:19], v[48:51]
  v_mfma_f32_16x16x32_bf16 v[52:55], a[128:131], v[20:23], v[52:55]
  v_mfma_f32_16x16x32_bf16 v[56:59], a[208:211], v[16:19], v[56:59]
  v_mfma_f32_16x16x32_bf16 v[60:63], a[208:211], v[20:23], v[60:63]
  v_mfma_f32_16x16x32_bf16 v[64:67], v[144:147], v[16:19], v[64:67]
  v_mfma_f32_16x16x32_bf16 v[68:71], v[144:147], v[20:23], v[68:71]
  ds_read_b128 v[16:19], v8 offset:15360
  ds_read_b128 v[20:23], v8 offset:35840
  s_waitcnt lgkmcnt(4)
  v_mfma_f32_16x16x32_bf16 v[40:43], a[52:55], v[24:27], v[40:43]
  v_mfma_f32_16x16x32_bf16 v[44:47], a[52:55], v[28:31], v[44:47]
  v_mfma_f32_16x16x32_bf16 v[48:51], a[132:135], v[24:27], v[48:51]
  v_mfma_f32_16x16x32_bf16 v[52:55], a[132:135], v[28:31], v[52:55]
  v_mfma_f32_16x16x32_bf16 v[56:59], a[212:215], v[24:27], v[56:59]
  v_mfma_f32_16x16x32_bf16 v[60:63], a[212:215], v[28:31], v[60:63]
  v_mfma_f32_16x16x32_bf16 v[64:67], v[148:151], v[24:27], v[64:67]
  v_mfma_f32_16x16x32_bf16 v[68:71], v[148:151], v[28:31], v[68:71]
  ds_read_b128 v[24:27], v8 offset:16384
  ds_read_b128 v[28:31], v8 offset:36864
  s_waitcnt lgkmcnt(4)
  v_mfma_f32_16x16x32_bf16 v[40:43], a[56:59], v[32:35], v[40:43]
  v_mfma_f32_16x16x32_bf16 v[44:47], a[56:59], v[36:39], v[44:47]
  v_mfma_f32_16x16x32_bf16 v[48:51], a[136:139], v[32:35], v[48:51]
  v_mfma_f32_16x16x32_bf16 v[52:55], a[136:139], v[36:39], v[52:55]
  v_mfma_f32_16x16x32_bf16 v[56:59], a[216:219], v[32:35], v[56:59]
  v_mfma_f32_16x16x32_bf16 v[60:63], a[216:219], v[36:39], v[60:63]
  v_mfma_f32_16x16x32_bf16 v[64:67], v[152:155], v[32:35], v[64:67]
  v_mfma_f32_16x16x32_bf16 v[68:71], v[152:155], v[36:39], v[68:71]
  ds_read_b128 v[32:35], v8 offset:17408
  ds_read_b128 v[36:39], v8 offset:37888
  s_waitcnt lgkmcnt(4)
  v_mfma_f32_16x16x32_bf16 v[40:43], a[60:63], v[16:19], v[40:43]
  v_mfma_f32_16x16x32_bf16 v[44:47], a[60:63], v[20:23], v[44:47]
  v_mfma_f32_16x16x32_bf16 v[48:51], a[140:143], v[16:19], v[48:51]
  v_mfma_f32_16x16x32_bf16 v[52:55], a[140:143], v[20:23], v[52:55]
  v_mfma_f32_16x16x32_bf16 v[56:59], a[220:223], v[16:19], v[56:59]
  v_mfma_f32_16x16x32_bf16 v[60:63], a[220:223], v[20:23], v[60:63]
  v_mfma_f32_16x16x32_bf16 v[64:67], v[156:159], v[16:19], v[64:67]
  v_mfma_f32_16x16x32_bf16 v[68:71], v[156:159], v[20:23], v[68:71]
  ds_read_b128 v[16:19], v8 offset:18432
  ds_read_b128 v[20:23], v8 offset:38912
  s_waitcnt lgkmcnt(4)
  v_mfma_f32_16x16x32_bf16 v[40:43], a[64:67], v[24:27], v[40:43]
  v_mfma_f32_16x16x32_bf16 v[44:47], a[64:67], v[28:31], v[44:47]
  v_mfma_f32_16x16x32_bf16 v[48:51], a[144:147], v[24:27], v[48:51]
  v_mfma_f32_16x16x32_bf16 v[52:55], a[144:147], v[28:31], v[52:55]
  v_mfma_f32_16x16x32_bf16 v[56:59], a[224:227], v[24:27], v[56:59]
  v_mfma_f32_16x16x32_bf16 v[60:63], a[224:227], v[28:31], v[60:63]
  v_mfma_f32_16x16x32_bf16 v[64:67], v[160:163], v[24:27], v[64:67]
  v_mfma_f32_16x16x32_bf16 v[68:71], v[160:163], v[28:31], v[68:71]
  ds_read_b128 v[24:27], v8 offset:19456
  ds_read_b128 v[28:31], v8 offset:39936
  s_waitcnt lgkmcnt(4)
  v_mfma_f32_16x16x32_bf16 v[40:43], a[68:71], v[32:35], v[40:43]
  v_mfma_f32_16x16x32_bf16 v[44:47], a[68:71], v[36:39], v[44:47]
  v_mfma_f32_16x16x32_bf16 v[48:51], a[148:151], v[32:35], v[48:51]
  v_mfma_f32_16x16x32_bf16 v[52:55], a[148:151], v[36:39], v[52:55]
  v_mfma_f32_16x16x32_bf16 v[56:59], a[228:231], v[32:35], v[56:59]
  v_mfma_f32_16x16x32_bf16 v[60:63], a[228:231], v[36:39], v[60:63]
  v_mfma_f32_16x16x32_bf16 v[64:67], v[164:167], v[32:35], v[64:67]
  v_mfma_f32_16x16x32_bf16 v[68:71], v[164:167], v[36:39], v[68:71]
  s_waitcnt lgkmcnt(2)
  v_mfma_f32_16x16x32_bf16 v[40:43], a[72:75], v[16:19], v[40:43]
  v_mfma_f32_16x16x32_bf16 v[44:47], a[72:75], v[20:23], v[44:47]
  v_mfma_f32_16x16x32_bf16 v[48:51], a[152:155], v[16:19], v[48:51]
  v_mfma_f32_16x16x32_bf16 v[52:55], a[152:155], v[20:23], v[52:55]
  v_mfma_f32_16x16x32_bf16 v[56:59], a[232:235], v[16:19], v[56:59]
  v_mfma_f32_16x16x32_bf16 v[60:63], a[232:235], v[20:23], v[60:63]
  v_mfma_f32_16x16x32_bf16 v[64:67], v[168:171], v[16:19], v[64:67]
  v_mfma_f32_16x16x32_bf16 v[68:71], v[168:171], v[20:23], v[68:71]
  s_waitcnt lgkmcnt(0)
  v_mfma_f32_16x16x32_bf16 v[40:43], a[76:79], v[24:27], v[40:43]
  v_mfma_f32_16x16x32_bf16 v[44:47], a[76:79], v[28:31], v[44:47]
  v_mfma_f32_16x16x32_bf16 v[48:51], a[156:159], v[24:27], v[48:51]
  v_mfma_f32_16x16x32_bf16 v[52:55], a[156:159], v[28:31], v[52:55]
  v_mfma_f32_16x16x32_bf16 v[56:59], a[236:239], v[24:27], v[56:59]
  v_mfma_f32_16x16x32_bf16 v[60:63], a[236:239], v[28:31], v[60:63]
  v_mfma_f32_16x16x32_bf16 v[64:67], v[172:175], v[24:27], v[64:67]
  v_mfma_f32_16x16x32_bf16 v[68:71], v[172:175], v[28:31], v[68:71]
  s_waitcnt vmcnt(0)
  s_mov_b64 exec, 1
  buffer_store_dword v11, off, s[4:7], s41 sc1
  s_mov_b64 exec, -1
  v_add_u32 v11, 4, v11
  v_cvt_pk_bf16_f32 v72, v40, v41
  v_cvt_pk_bf16_f32 v73, v42, v43
  v_cvt_pk_bf16_f32 v74, v48, v49
  v_cvt_pk_bf16_f32 v75, v50, v51
  buffer_store_dwordx4 v[72:75], v1, s[4:7], s40 offen offset:0 sc1
  v_cvt_pk_bf16_f32 v76, v44, v45
  v_cvt_pk_bf16_f32 v77, v46, v47
  v_cvt_pk_bf16_f32 v78, v52, v53
  v_cvt_pk_bf16_f32 v79, v54, v55
  buffer_store_dwordx4 v[76:79], v1, s[4:7], s40 offen offset:1024 sc1
  v_cvt_pk_bf16_f32 v80, v56, v57
  v_cvt_pk_bf16_f32 v81, v58, v59
  v_cvt_pk_bf16_f32 v82, v64, v65
  v_cvt_pk_bf16_f32 v83, v66, v67
  buffer_store_dwordx4 v[80:83], v1, s[4:7], s40 offen offset:2048 sc1
  v_cvt_pk_bf16_f32 v84, v60, v61
  v_cvt_pk_bf16_f32 v85, v62, v63
  v_cvt_pk_bf16_f32 v86, v68, v69
  v_cvt_pk_bf16_f32 v87, v70, v71
  buffer_store_dwordx4 v[84:87], v1, s[4:7], s40 offen offset:3072 sc1
  s_add_u32 s40, s40, 1048576
  s_cmp_lg_u32 s46, 0
  s_cbranch_scc1 L_87
  ds_read_b128 v[16:19], v12 offset:0
  ds_read_b128 v[20:23], v12 offset:1024
  ds_read_b128 v[24:27], v12 offset:2048
  ds_read_b128 v[28:31], v12 offset:3072
  ds_read_b128 v[32:35], v12 offset:4096
  ds_read_b128 v[36:39], v12 offset:5120
  s_waitcnt lgkmcnt(5)
  v_mfma_f32_16x16x32_bf16 v[88:91], v[176:179], v[16:19], 0
  ds_read_b128 v[16:19], v12 offset:6144
  s_waitcnt lgkmcnt(5)
  v_mfma_f32_16x16x32_bf16 v[88:91], v[180:183], v[20:23], v[88:91]
  ds_read_b128 v[20:23], v12 offset:7168
  s_waitcnt lgkmcnt(5)
  v_mfma_f32_16x16x32_bf16 v[88:91], v[184:187], v[24:27], v[88:91]
  ds_read_b128 v[24:27], v12 offset:8192
  s_waitcnt lgkmcnt(5)
  v_mfma_f32_16x16x32_bf16 v[88:91], v[188:191], v[28:31], v[88:91]
  ds_read_b128 v[28:31], v12 offset:9216
  s_waitcnt lgkmcnt(5)
  v_mfma_f32_16x16x32_bf16 v[88:91], v[192:195], v[32:35], v[88:91]
  ds_read_b128 v[32:35], v12 offset:10240
  s_waitcnt lgkmcnt(5)
  v_mfma_f32_16x16x32_bf16 v[88:91], v[196:199], v[36:39], v[88:91]
  ds_read_b128 v[36:39], v12 offset:11264
  s_waitcnt lgkmcnt(5)
  v_mfma_f32_16x16x32_bf16 v[88:91], v[200:203], v[16:19], v[88:91]
  ds_read_b128 v[16:19], v12 offset:12288
  s_waitcnt lgkmcnt(5)
  v_mfma_f32_16x16x32_bf16 v[88:91], v[204:207], v[20:23], v[88:91]
  ds_read_b128 v[20:23], v12 offset:13312
  s_waitcnt lgkmcnt(5)
  v_mfma_f32_16x16x32_bf16 v[88:91], v[208:211], v[24:27], v[88:91]
  ds_read_b128 v[24:27], v12 offset:14336
  s_waitcnt lgkmcnt(5)
  v_mfma_f32_16x16x32_bf16 v[88:91], v[212:215], v[28:31], v[88:91]
  ds_read_b128 v[28:31], v12 offset:15360
  s_waitcnt lgkmcnt(5)
  v_mfma_f32_16x16x32_bf16 v[88:91], v[216:219], v[32:35], v[88:91]
  ds_read_b128 v[32:35], v12 offset:16384
  s_waitcnt lgkmcnt(5)
  v_mfma_f32_16x16x32_bf16 v[88:91], v[220:223], v[36:39], v[88:91]
  ds_read_b128 v[36:39], v12 offset:17408
  s_waitcnt lgkmcnt(5)
  v_mfma_f32_16x16x32_bf16 v[88:91], v[224:227], v[16:19], v[88:91]
  ds_read_b128 v[16:19], v12 offset:18432
  s_waitcnt lgkmcnt(5)
  v_mfma_f32_16x16x32_bf16 v[88:91], v[228:231], v[20:23], v[88:91]
  ds_read_b128 v[20:23], v12 offset:19456
  s_waitcnt lgkmcnt(5)
  v_mfma_f32_16x16x32_bf16 v[88:91], v[232:235], v[24:27], v[88:91]
  s_waitcnt lgkmcnt(4)
  v_mfma_f32_16x16x32_bf16 v[88:91], v[236:239], v[28:31], v[88:91]
  s_waitcnt lgkmcnt(3)
  v_mfma_f32_16x16x32_bf16 v[88:91], v[240:243], v[32:35], v[88:91]
  s_waitcnt lgkmcnt(2)
  v_mfma_f32_16x16x32_bf16 v[88:91], v[244:247], v[36:39], v[88:91]
  s_waitcnt lgkmcnt(1)
  v_mfma_f32_16x16x32_bf16 v[88:91], v[248:251], v[16:19], v[88:91]
  s_waitcnt lgkmcnt(0)
  v_mfma_f32_16x16x32_bf16 v[88:91], v[252:255], v[20:23], v[88:91]
  s_nop 6
  s_branch L_88
L_87:
  ds_read_b128 v[16:19], v12 offset:0
  ds_read_b128 v[20:23], v12 offset:1024
  ds_read_b128 v[24:27], v12 offset:2048
  ds_read_b128 v[28:31], v12 offset:3072
  ds_read_b128 v[32:35], v12 offset:4096
  ds_read_b128 v[36:39], v12 offset:5120
  s_waitcnt lgkmcnt(5)
  v_mfma_f32_16x16x32_bf16 v[88:91], v[16:19], v[176:179], 0
  ds_read_b128 v[16:19], v12 offset:6144
  s_waitcnt lgkmcnt(5)
  v_mfma_f32_16x16x32_bf16 v[88:91], v[20:23], v[180:183], v[88:91]
  ds_read_b128 v[20:23], v12 offset:7168
  s_waitcnt lgkmcnt(5)
  v_mfma_f32_16x16x32_bf16 v[88:91], v[24:27], v[184:187], v[88:91]
  ds_read_b128 v[24:27], v12 offset:8192
  s_waitcnt lgkmcnt(5)
  v_mfma_f32_16x16x32_bf16 v[88:91], v[28:31], v[188:191], v[88:91]
  ds_read_b128 v[28:31], v12 offset:9216
  s_waitcnt lgkmcnt(5)
  v_mfma_f32_16x16x32_bf16 v[88:91], v[32:35], v[192:195], v[88:91]
  ds_read_b128 v[32:35], v12 offset:10240
  s_waitcnt lgkmcnt(5)
  v_mfma_f32_16x16x32_bf16 v[88:91], v[36:39], v[196:199], v[88:91]
  ds_read_b128 v[36:39], v12 offset:11264
  s_waitcnt lgkmcnt(5)
  v_mfma_f32_16x16x32_bf16 v[88:91], v[16:19], v[200:203], v[88:91]
  ds_read_b128 v[16:19], v12 offset:12288
  s_waitcnt lgkmcnt(5)
  v_mfma_f32_16x16x32_bf16 v[88:91], v[20:23], v[204:207], v[88:91]
  ds_read_b128 v[20:23], v12 offset:13312
  s_waitcnt lgkmcnt(5)
  v_mfma_f32_16x16x32_bf16 v[88:91], v[24:27], v[208:211], v[88:91]
  ds_read_b128 v[24:27], v12 offset:14336
  s_waitcnt lgkmcnt(5)
  v_mfma_f32_16x16x32_bf16 v[88:91], v[28:31], v[212:215], v[88:91]
  ds_read_b128 v[28:31], v12 offset:15360
  s_waitcnt lgkmcnt(5)
  v_mfma_f32_16x16x32_bf16 v[88:91], v[32:35], v[216:219], v[88:91]
  ds_read_b128 v[32:35], v12 offset:16384
  s_waitcnt lgkmcnt(5)
  v_mfma_f32_16x16x32_bf16 v[88:91], v[36:39], v[220:223], v[88:91]
  ds_read_b128 v[36:39], v12 offset:17408
  s_waitcnt lgkmcnt(5)
  v_mfma_f32_16x16x32_bf16 v[88:91], v[16:19], v[224:227], v[88:91]
  ds_read_b128 v[16:19], v12 offset:18432
  s_waitcnt lgkmcnt(5)
  v_mfma_f32_16x16x32_bf16 v[88:91], v[20:23], v[228:231], v[88:91]
  ds_read_b128 v[20:23], v12 offset:19456
  s_waitcnt lgkmcnt(5)
  v_mfma_f32_16x16x32_bf16 v[88:91], v[24:27], v[232:235], v[88:91]
  s_waitcnt lgkmcnt(4)
  v_mfma_f32_16x16x32_bf16 v[88:91], v[28:31], v[236:239], v[88:91]
  s_waitcnt lgkmcnt(3)
  v_mfma_f32_16x16x32_bf16 v[88:91], v[32:35], v[240:243], v[88:91]
  s_waitcnt lgkmcnt(2)
  v_mfma_f32_16x16x32_bf16 v[88:91], v[36:39], v[244:247], v[88:91]
  s_waitcnt lgkmcnt(1)
  v_mfma_f32_16x16x32_bf16 v[88:91], v[16:19], v[248:251], v[88:91]
  s_waitcnt lgkmcnt(0)
  v_mfma_f32_16x16x32_bf16 v[88:91], v[20:23], v[252:255], v[88:91]
L_88:
  s_nop 7
  v_fma_f32 v92, v88, s45, v10
  v_fma_f32 v93, v89, s45, v10
  v_fma_f32 v94, v90, s45, v10
  v_fma_f32 v95, v91, s45, v10
  v_cvt_pk_bf16_f32 v92, v92, v93
  v_cvt_pk_bf16_f32 v93, v94, v95
  buffer_store_dwordx2 v[92:93], v9, s[4:7], s44 offen sc1
  s_add_u32 s44, s44, s43
  v_add_u32 v7, s47, v7
  v_add_u32 v8, s47, v8
  v_add_u32 v12, s47, v12
  s_sub_u32 s47, 0, s47
  s_add_u32 s42, s42, 1
  s_cmp_lt_u32 s42, 8
  s_cbranch_scc1 L_pT
  s_branch L_pE
L_pN:
  s_barrier
  s_add_u32 s38, s38, 327680
  s_add_u32 s39, s39, s47
  ds_read_b128 v[16:19], v7 offset:0
  ds_read_b128 v[20:23], v7 offset:20480
  ds_read_b128 v[24:27], v7 offset:1024
  ds_read_b128 v[28:31], v7 offset:21504
  ds_read_b128 v[32:35], v7 offset:2048
  ds_read_b128 v[36:39], v7 offset:22528
  s_add_u32 m0, s39, 0
  s_add_u32 s31, s38, 0
  buffer_load_dwordx4 v6, s[8:11], s31 offen lds
  s_waitcnt lgkmcnt(4)
  v_mfma_f32_16x16x32_bf16 v[40:43], v[16:19], a[0:3], 0
  v_mfma_f32_16x16x32_bf16 v[44:47], v[20:23], a[0:3], 0
  v_mfma_f32_16x16x32_bf16 v[48:51], v[16:19], a[80:83], 0
  v_mfma_f32_16x16x32_bf16 v[52:55], v[20:23], a[80:83], 0
  v_mfma_f32_16x16x32_bf16 v[56:59], v[16:19], a[160:163], 0
  v_mfma_f32_16x16x32_bf16 v[60:63], v[20:23], a[160:163], 0
  v_mfma_f32_16x16x32_bf16 v[64:67], v[16:19], a[240:243], 0
  v_mfma_f32_16x16x32_bf16 v[68:71], v[20:23], a[240:243], 0
  ds_read_b128 v[16:19], v7 offset:3072
  ds_read_b128 v[20:23], v7 offset:23552
  s_add_u32 m0, s39, 1024
  s_add_u32 s31, s38, 64
  buffer_load_dwordx4 v6, s[8:11], s31 offen lds
  s_waitcnt lgkmcnt(4)
  v_mfma_f32_16x16x32_bf16 v[40:43], v[24:27], a[4:7], v[40:43]
  v_mfma_f32_16x16x32_bf16 v[44:47], v[28:31], a[4:7], v[44:47]
  v_mfma_f32_16x16x32_bf16 v[48:51], v[24:27], a[84:87], v[48:51]
  v_mfma_f32_16x16x32_bf16 v[52:55], v[28:31], a[84:87], v[52:55]
  v_mfma_f32_16x16x32_bf16 v[56:59], v[24:27], a[164:167], v[56:59]
  v_mfma_f32_16x16x32_bf16 v[60:63], v[28:31], a[164:167], v[60:63]
  v_mfma_f32_16x16x32_bf16 v[64:67], v[24:27], a[244:247], v[64:67]
  v_mfma_f32_16x16x32_bf16 v[68:71], v[28:31], a[244:247], v[68:71]
  ds_read_b128 v[24:27], v7 offset:4096
  ds_read_b128 v[28:31], v7 offset:24576
  s_add_u32 m0, s39, 2048
  s_add_u32 s31, s38, 128
  buffer_load_dwordx4 v6, s[8:11], s31 offen lds
  s_waitcnt lgkmcnt(4)
  v_mfma_f32_16x16x32_bf16 v[40:43], v[32:35], a[8:11], v[40:43]
  v_mfma_f32_16x16x32_bf16 v[44:47], v[36:39], a[8:11], v[44:47]
  v_mfma_f32_16x16x32_bf16 v[48:51], v[32:35], a[88:91], v[48:51]
  v_mfma_f32_16x16x32_bf16 v[52:55], v[36:39], a[88:91], v[52:55]
  v_mfma_f32_16x16x32_bf16 v[56:59], v[32:35], a[168:171], v[56:59]
  v_mfma_f32_16x16x32_bf16 v[60:63], v[36:39], a[168:171], v[60:63]
  v_mfma_f32_16x16x32_bf16 v[64:67], v[32:35], a[248:251], v[64:67]
  v_mfma_f32_16x16x32_bf16 v[68:71], v[36:39], a[248:251], v[68:71]
  ds_read_b128 v[32:35], v7 offset:5120
  ds_read_b128 v[36:39], v7 offset:25600
  s_add_u32 m0, s39, 3072
  s_add_u32 s31, s38, 192
  buffer_load_dwordx4 v6, s[8:11], s31 offen lds
  s_waitcnt lgkmcnt(4)
  v_mfma_f32_16x16x32_bf16 v[40:43], v[16:19], a[12:15], v[40:43]
  v_mfma_f32_16x16x32_bf16 v[44:47], v[20:23], a[12:15], v[44:47]
  v_mfma_f32_16x16x32_bf16 v[48:51], v[16:19], a[92:95], v[48:51]
  v_mfma_f32_16x16x32_bf16 v[52:55], v[20:23], a[92:95], v[52:55]
  v_mfma_f32_16x16x32_bf16 v[56:59], v[16:19], a[172:175], v[56:59]
  v_mfma_f32_16x16x32_bf16 v[60:63], v[20:23], a[172:175], v[60:63]
  v_mfma_f32_16x16x32_bf16 v[64:67], v[16:19], a[252:255], v[64:67]
  v_mfma_f32_16x16x32_bf16 v[68:71], v[20:23], a[252:255], v[68:71]
  ds_read_b128 v[16:19], v7 offset:6144
  ds_read_b128 v[20:23], v7 offset:26624
  s_add_u32 m0, s39, 4096
  s_add_u32 s31, s38, 256
  buffer_load_dwordx4 v6, s[8:11], s31 offen lds
  s_waitcnt lgkmcnt(4)
  v_mfma_f32_16x16x32_bf16 v[40:43], v[24:27], a[16:19], v[40:43]
  v_mfma_f32_16x16x32_bf16 v[44:47], v[28:31], a[16:19], v[44:47]
  v_mfma_f32_16x16x32_bf16 v[48:51], v[24:27], a[96:99], v[48:51]
  v_mfma_f32_16x16x32_bf16 v[52:55], v[28:31], a[96:99], v[52:55]
  v_mfma_f32_16x16x32_bf16 v[56:59], v[24:27], a[176:179], v[56:59]
  v_mfma_f32_16x16x32_bf16 v[60:63], v[28:31], a[176:179], v[60:63]
  v_mfma_f32_16x16x32_bf16 v[64:67], v[24:27], v[112:115], v[64:67]
  v_mfma_f32_16x16x32_bf16 v[68:71], v[28:31], v[112:115], v[68:71]
  ds_read_b128 v[24:27], v7 offset:7168
  ds_read_b128 v[28:31], v7 offset:27648
  s_add_u32 m0, s39, 5120
  s_add_u32 s31, s38, 320
  buffer_load_dwordx4 v6, s[8:11], s31 offen lds
  s_waitcnt lgkmcnt(4)
  v_mfma_f32_16x16x32_bf16 v[40:43], v[32:35], a[20:23], v[40:43]
  v_mfma_f32_16x16x32_bf16 v[44:47], v[36:39], a[20:23], v[44:47]
  v_mfma_f32_16x16x32_bf16 v[48:51], v[32:35], a[100:103], v[48:51]
  v_mfma_f32_16x16x32_bf16 v[52:55], v[36:39], a[100:103], v[52:55]
  v_mfma_f32_16x16x32_bf16 v[56:59], v[32:35], a[180:183], v[56:59]
  v_mfma_f32_16x16x32_bf16 v[60:63], v[36:39], a[180:183], v[60:63]
  v_mfma_f32_16x16x32_bf16 v[64:67], v[32:35], v[116:119], v[64:67]
  v_mfma_f32_16x16x32_bf16 v[68:71], v[36:39], v[116:119], v[68:71]
  ds_read_b128 v[32:35], v7 offset:8192
  ds_read_b128 v[36:39], v7 offset:28672
  s_add_u32 m0, s39, 6144
  s_add_u32 s31, s38, 384
  buffer_load_dwordx4 v6, s[8:11], s31 offen lds
  s_waitcnt lgkmcnt(4)
  v_mfma_f32_16x16x32_bf16 v[40:43], v[16:19], a[24:27], v[40:43]
  v_mfma_f32_16x16x32_bf16 v[44:47], v[20:23], a[24:27], v[44:47]
  v_mfma_f32_16x16x32_bf16 v[48:51], v[16:19], a[104:107], v[48:51]
  v_mfma_f32_16x16x32_bf16 v[52:55], v[20:23], a[104:107], v[52:55]
  v_mfma_f32_16x16x32_bf16 v[56:59], v[16:19], a[184:187], v[56:59]
  v_mfma_f32_16x16x32_bf16 v[60:63], v[20:23], a[184:187], v[60:63]
  v_mfma_f32_16x16x32_bf16 v[64:67], v[16:19], v[120:123], v[64:67]
  v_mfma_f32_16x16x32_bf16 v[68:71], v[20:23], v[120:123], v[68:71]
  ds_read_b128 v[16:19], v7 offset:9216
  ds_read_b128 v[20:23], v7 offset:29696
  s_add_u32 m0, s39, 7168
  s_add_u32 s31, s38, 448
  buffer_load_dwordx4 v6, s[8:11], s31 offen lds
  s_waitcnt lgkmcnt(4)
  v_mfma_f32_16x16x32_bf16 v[40:43], v[24:27], a[28:31], v[40:43]
  v_mfma_f32_16x16x32_bf16 v[44:47], v[28:31], a[28:31], v[44:47]
  v_mfma_f32_16x16x32_bf16 v[48:51], v[24:27], a[108:111], v[48:51]
  v_mfma_f32_16x16x32_bf16 v[52:55], v[28:31], a[108:111], v[52:55]
  v_mfma_f32_16x16x32_bf16 v[56:59], v[24:27], a[188:191], v[56:59]
  v_mfma_f32_16x16x32_bf16 v[60:63], v[28:31], a[188:191], v[60:63]
  v_mfma_f32_16x16x32_bf16 v[64:67], v[24:27], v[124:127], v[64:67]
  v_mfma_f32_16x16x32_bf16 v[68:71], v[28:31], v[124:127], v[68:71]
  ds_read_b128 v[24:27], v7 offset:10240
  ds_read_b128 v[28:31], v7 offset:30720
  s_add_u32 m0, s39, 8192
  s_add_u32 s31, s38, 512
  buffer_load_dwordx4 v6, s[8:11], s31 offen lds
  s_waitcnt lgkmcnt(4)
  v_mfma_f32_16x16x32_bf16 v[40:43], v[32:35], a[32:35], v[40:43]
  v_mfma_f32_16x16x32_bf16 v[44:47], v[36:39], a[32:35], v[44:47]
  v_mfma_f32_16x16x32_bf16 v[48:51], v[32:35], a[112:115], v[48:51]
  v_mfma_f32_16x16x32_bf16 v[52:55], v[36:39], a[112:115], v[52:55]
  v_mfma_f32_16x16x32_bf16 v[56:59], v[32:35], a[192:195], v[56:59]
  v_mfma_f32_16x16x32_bf16 v[60:63], v[36:39], a[192:195], v[60:63]
  v_mfma_f32_16x16x32_bf16 v[64:67], v[32:35], v[128:131], v[64:67]
  v_mfma_f32_16x16x32_bf16 v[68:71], v[36:39], v[128:131], v[68:71]
  ds_read_b128 v[32:35], v7 offset:11264
  ds_read_b128 v[36:39], v7 offset:31744
  s_add_u32 m0, s39, 9216
  s_add_u32 s31, s38, 576
  buffer_load_dwordx4 v6, s[8:11], s31 offen lds
  s_waitcnt lgkmcnt(4)
  v_mfma_f32_16x16x32_bf16 v[40:43], v[16:19], a[36:39], v[40:43]
  v_mfma_f32_16x16x32_bf16 v[44:47], v[20:23], a[36:39], v[44:47]
  v_mfma_f32_16x16x32_bf16 v[48:51], v[16:19], a[116:119], v[48:51]
  v_mfma_f32_16x16x32_bf16 v[52:55], v[20:23], a[116:119], v[52:55]
  v_mfma_f32_16x16x32_bf16 v[56:59], v[16:19], a[196:199], v[56:59]
  v_mfma_f32_16x16x32_bf16 v[60:63], v[20:23], a[196:199], v[60:63]
  v_mfma_f32_16x16x32_bf16 v[64:67], v[16:19], v[132:135], v[64:67]
  v_mfma_f32_16x16x32_bf16 v[68:71], v[20:23], v[132:135], v[68:71]
  ds_read_b128 v[16:19], v7 offset:12288
  ds_read_b128 v[20:23], v7 offset:32768
  s_add_u32 m0, s39, 40960
  s_add_u32 s31, s38, 163840
  buffer_load_dwordx4 v6, s[8:11], s31 offen lds
  s_waitcnt lgkmcnt(4)
  v_mfma_f32_16x16x32_bf16 v[40:43], v[24:27], a[40:43], v[40:43]
  v_mfma_f32_16x16x32_bf16 v[44:47], v[28:31], a[40:43], v[44:47]
  v_mfma_f32_16x16x32_bf16 v[48:51], v[24:27], a[120:123], v[48:51]
  v_mfma_f32_16x16x32_bf16 v[52:55], v[28:31], a[120:123], v[52:55]
  v_mfma_f32_16x16x32_bf16 v[56:59], v[24:27], a[200:203], v[56:59]
  v_mfma_f32_16x16x32_bf16 v[60:63], v[28:31], a[200:203], v[60:63]
  v_mfma_f32_16x16x32_bf16 v[64:67], v[24:27], v[136:139], v[64:67]
  v_mfma_f32_16x16x32_bf16 v[68:71], v[28:31], v[136:139], v[68:71]
  ds_read_b128 v[24:27], v7 offset:13312
  ds_read_b128 v[28:31], v7 offset:33792
  s_add_u32 m0, s39, 41984
  s_add_u32 s31, s38, 163904
  buffer_load_dwordx4 v6, s[8:11], s31 offen lds
  s_waitcnt lgkmcnt(4)
  v_mfma_f32_16x16x32_bf16 v[40:43], v[32:35], a[44:47], v[40:43]
  v_mfma_f32_16x16x32_bf16 v[44:47], v[36:39], a[44:47], v[44:47]
  v_mfma_f32_16x16x32_bf16 v[48:51], v[32:35], a[124:127], v[48:51]
  v_mfma_f32_16x16x32_bf16 v[52:55], v[36:39], a[124:127], v[52:55]
  v_mfma_f32_16x16x32_bf16 v[56:59], v[32:35], a[204:207], v[56:59]
  v_mfma_f32_16x16x32_bf16 v[60:63], v[36:39], a[204:207], v[60:63]
  v_mfma_f32_16x16x32_bf16 v[64:67], v[32:35], v[140:143], v[64:67]
  v_mfma_f32_16x16x32_bf16 v[68:71], v[36:39], v[140:143], v[68:71]
  ds_read_b128 v[32:35], v7 offset:14336
  ds_read_b128 v[36:39], v7 offset:34816
  s_add_u32 m0, s39, 43008
  s_add_u32 s31, s38, 163968
  buffer_load_dwordx4 v6, s[8:11], s31 offen lds
  s_waitcnt lgkmcnt(4)
  v_mfma_f32_16x16x32_bf16 v[40:43], v[16:19], a[48:51], v[40:43]
  v_mfma_f32_16x16x32_bf16 v[44:47], v[20:23], a[48:51], v[44:47]
  v_mfma_f32_16x16x32_bf16 v[48:51], v[16:19], a[128:131], v[48:51]
  v_mfma_f32_16x16x32_bf16 v[52:55], v[20:23], a[128:131], v[52:55]
  v_mfma_f32_16x16x32_bf16 v[56:59], v[16:19], a[208:211], v[56:59]
  v_mfma_f32_16x16x32_bf16 v[60:63], v[20:23], a[208:211], v[60:63]
  v_mfma_f32_16x16x32_bf16 v[64:67], v[16:19], v[144:147], v[64:67]
  v_mfma_f32_16x16x32_bf16 v[68:71], v[20:23], v[144:147], v[68:71]
  ds_read_b128 v[16:19], v7 offset:15360
  ds_read_b128 v[20:23], v7 offset:35840
  s_add_u32 m0, s39, 44032
  s_add_u32 s31, s38, 164032
  buffer_load_dwordx4 v6, s[8:11], s31 offen lds
  s_waitcnt lgkmcnt(4)
  v_mfma_f32_16x16x32_bf16 v[40:43], v[24:27], a[52:55], v[40:43]
  v_mfma_f32_16x16x32_bf16 v[44:47], v[28:31], a[52:55], v[44:47]
  v_mfma_f32_16x16x32_bf16 v[48:51], v[24:27], a[132:135], v[48:51]
  v_mfma_f32_16x16x32_bf16 v[52:55], v[28:31], a[132:135], v[52:55]
  v_mfma_f32_16x16x32_bf16 v[56:59], v[24:27], a[212:215], v[56:59]
  v_mfma_f32_16x16x32_bf16 v[60:63], v[28:31], a[212:215], v[60:63]
  v_mfma_f32_16x16x32_bf16 v[64:67], v[24:27], v[148:151], v[64:67]
  v_mfma_f32_16x16x32_bf16 v[68:71], v[28:31], v[148:151], v[68:71]
  ds_read_b128 v[24:27], v7 offset:16384
  ds_read_b128 v[28:31], v7 offset:36864
  s_add_u32 m0, s39, 45056
  s_add_u32 s31, s38, 164096
  buffer_load_dwordx4 v6, s[8:11], s31 offen lds
  s_waitcnt lgkmcnt(4)
  v_mfma_f32_16x16x32_bf16 v[40:43], v[32:35], a[56:59], v[40:43]
  v_mfma_f32_16x16x32_bf16 v[44:47], v[36:39], a[56:59], v[44:47]
  v_mfma_f32_16x16x32_bf16 v[48:51], v[32:35], a[136:139], v[48:51]
  v_mfma_f32_16x16x32_bf16 v[52:55], v[36:39], a[136:139], v[52:55]
  v_mfma_f32_16x16x32_bf16 v[56:59], v[32:35], a[216:219], v[56:59]
  v_mfma_f32_16x16x32_bf16 v[60:63], v[36:39], a[216:219], v[60:63]
  v_mfma_f32_16x16x32_bf16 v[64:67], v[32:35], v[152:155], v[64:67]
  v_mfma_f32_16x16x32_bf16 v[68:71], v[36:39], v[152:155], v[68:71]
  ds_read_b128 v[32:35], v7 offset:17408
  ds_read_b128 v[36:39], v7 offset:37888
  s_add_u32 m0, s39, 46080
  s_add_u32 s31, s38, 164160
  buffer_load_dwordx4 v6, s[8:11], s31 offen lds
  s_waitcnt lgkmcnt(4)
  v_mfma_f32_16x16x32_bf16 v[40:43], v[16:19], a[60:63], v[40:43]
  v_mfma_f32_16x16x32_bf16 v[44:47], v[20:23], a[60:63], v[44:47]
  v_mfma_f32_16x16x32_bf16 v[48:51], v[16:19], a[140:143], v[48:51]
  v_mfma_f32_16x16x32_bf16 v[52:55], v[20:23], a[140:143], v[52:55]
  v_mfma_f32_16x16x32_bf16 v[56:59], v[16:19], a[220:223], v[56:59]
  v_mfma_f32_16x16x32_bf16 v[60:63], v[20:23], a[220:223], v[60:63]
  v_mfma_f32_16x16x32_bf16 v[64:67], v[16:19], v[156:159], v[64:67]
  v_mfma_f32_16x16x32_bf16 v[68:71], v[20:23], v[156:159], v[68:71]
  ds_read_b128 v[16:19], v7 offset:18432
  ds_read_b128 v[20:23], v7 offset:38912
  s_add_u32 m0, s39, 47104
  s_add_u32 s31, s38, 164224
  buffer_load_dwordx4 v6, s[8:11], s31 offen lds
  s_waitcnt lgkmcnt(4)
  v_mfma_f32_16x16x32_bf16 v[40:43], v[24:27], a[64:67], v[40:43]
  v_mfma_f32_16x16x32_bf16 v[44:47], v[28:31], a[64:67], v[44:47]
  v_mfma_f32_16x16x32_bf16 v[48:51], v[24:27], a[144:147], v[48:51]
  v_mfma_f32_16x16x32_bf16 v[52:55], v[28:31], a[144:147], v[52:55]
  v_mfma_f32_16x16x32_bf16 v[56:59], v[24:27], a[224:227], v[56:59]
  v_mfma_f32_16x16x32_bf16 v[60:63], v[28:31], a[224:227], v[60:63]
  v_mfma_f32_16x16x32_bf16 v[64:67], v[24:27], v[160:163], v[64:67]
  v_mfma_f32_16x16x32_bf16 v[68:71], v[28:31], v[160:163], v[68:71]
  ds_read_b128 v[24:27], v7 offset:19456
  ds_read_b128 v[28:31], v7 offset:39936
  s_add_u32 m0, s39, 48128
  s_add_u32 s31, s38, 164288
  buffer_load_dwordx4 v6, s[8:11], s31 offen lds
  s_waitcnt lgkmcnt(4)
  v_mfma_f32_16x16x32_bf16 v[40:43], v[32:35], a[68:71], v[40:43]
  v_mfma_f32_16x16x32_bf16 v[44:47], v[36:39], a[68:71], v[44:47]
  v_mfma_f32_16x16x32_bf16 v[48:51], v[32:35], a[148:151], v[48:51]
  v_mfma_f32_16x16x32_bf16 v[52:55], v[36:39], a[148:151], v[52:55]
  v_mfma_f32_16x16x32_bf16 v[56:59], v[32:35], a[228:231], v[56:59]
  v_mfma_f32_16x16x32_bf16 v[60:63], v[36:39], a[228:231], v[60:63]
  v_mfma_f32_16x16x32_bf16 v[64:67], v[32:35], v[164:167], v[64:67]
  v_mfma_f32_16x16x32_bf16 v[68:71], v[36:39], v[164:167], v[68:71]
  s_add_u32 m0, s39, 49152
  s_add_u32 s31, s38, 164352
  buffer_load_dwordx4 v6, s[8:11], s31 offen lds
  s_waitcnt lgkmcnt(2)
  v_mfma_f32_16x16x32_bf16 v[40:43], v[16:19], a[72:75], v[40:43]
  v_mfma_f32_16x16x32_bf16 v[44:47], v[20:23], a[72:75], v[44:47]
  v_mfma_f32_16x16x32_bf16 v[48:51], v[16:19], a[152:155], v[48:51]
  v_mfma_f32_16x16x32_bf16 v[52:55], v[20:23], a[152:155], v[52:55]
  v_mfma_f32_16x16x32_bf16 v[56:59], v[16:19], a[232:235], v[56:59]
  v_mfma_f32_16x16x32_bf16 v[60:63], v[20:23], a[232:235], v[60:63]
  v_mfma_f32_16x16x32_bf16 v[64:67], v[16:19], v[168:171], v[64:67]
  v_mfma_f32_16x16x32_bf16 v[68:71], v[20:23], v[168:171], v[68:71]
  s_add_u32 m0, s39, 50176
  s_add_u32 s31, s38, 164416
  buffer_load_dwordx4 v6, s[8:11], s31 offen lds
  s_waitcnt lgkmcnt(0)
  v_mfma_f32_16x16x32_bf16 v[40:43], v[24:27], a[76:79], v[40:43]
  v_mfma_f32_16x16x32_bf16 v[44:47], v[28:31], a[76:79], v[44:47]
  v_mfma_f32_16x16x32_bf16 v[48:51], v[24:27], a[156:159], v[48:51]
  v_mfma_f32_16x16x32_bf16 v[52:55], v[28:31], a[156:159], v[52:55]
  v_mfma_f32_16x16x32_bf16 v[56:59], v[24:27], a[236:239], v[56:59]
  v_mfma_f32_16x16x32_bf16 v[60:63], v[28:31], a[236:239], v[60:63]
  v_mfma_f32_16x16x32_bf16 v[64:67], v[24:27], v[172:175], v[64:67]
  v_mfma_f32_16x16x32_bf16 v[68:71], v[28:31], v[172:175], v[68:71]
  s_waitcnt vmcnt(20)
  s_mov_b64 exec, 1
  buffer_store_dword v11, off, s[4:7], s41 sc1
  s_mov_b64 exec, -1
  v_add_u32 v11, 4, v11
  v_cvt_pk_bf16_f32 v72, v40, v41
  v_cvt_pk_bf16_f32 v73, v42, v43
  v_cvt_pk_bf16_f32 v74, v44, v45
  v_cvt_pk_bf16_f32 v75, v46, v47
  buffer_store_dwordx4 v[72:75], v1, s[4:7], s40 offen offset:0 sc1
  v_cvt_pk_bf16_f32 v76, v48, v49
  v_cvt_pk_bf16_f32 v77, v50, v51
  v_cvt_pk_bf16_f32 v78, v52, v53
  v_cvt_pk_bf16_f32 v79, v54, v55
  buffer_store_dwordx4 v[76:79], v1, s[4:7], s40 offen offset:1024 sc1
  v_cvt_pk_bf16_f32 v80, v56, v57
  v_cvt_pk_bf16_f32 v81, v58, v59
  v_cvt_pk_bf16_f32 v82, v60, v61
  v_cvt_pk_bf16_f32 v83, v62, v63
  buffer_store_dwordx4 v[80:83], v1, s[4:7], s40 offen offset:2048 sc1
  v_cvt_pk_bf16_f32 v84, v64, v65
  v_cvt_pk_bf16_f32 v85, v66, v67
  v_cvt_pk_bf16_f32 v86, v68, v69
  v_cvt_pk_bf16_f32 v87, v70, v71
  buffer_store_dwordx4 v[84:87], v1, s[4:7], s40 offen offset:3072 sc1
  s_add_u32 s40, s40, 1048576
  ds_read_b128 v[16:19], v8 offset:0
  ds_read_b128 v[20:23], v8 offset:20480
  ds_read_b128 v[24:27], v8 offset:1024
  ds_read_b128 v[28:31], v8 offset:21504
  ds_read_b128 v[32:35], v8 offset:2048
  ds_read_b128 v[36:39], v8 offset:22528
  s_waitcnt lgkmcnt(4)
  v_mfma_f32_16x16x32_bf16 v[40:43], v[16:19], a[0:3], 0
  v_mfma_f32_16x16x32_bf16 v[44:47], v[20:23], a[0:3], 0
  v_mfma_f32_16x16x32_bf16 v[48:51], v[16:19], a[80:83], 0
  v_mfma_f32_16x16x32_bf16 v[52:55], v[20:23], a[80:83], 0
  v_mfma_f32_16x16x32_bf16 v[56:59], v[16:19], a[160:163], 0
  v_mfma_f32_16x16x32_bf16 v[60:63], v[20:23], a[160:163], 0
  v_mfma_f32_16x16x32_bf16 v[64:67], v[16:19], a[240:243], 0
  v_mfma_f32_16x16x32_bf16 v[68:71], v[20:23], a[240:243], 0
  ds_read_b128 v[16:19], v8 offset:3072
  ds_read_b128 v[20:23], v8 offset:23552
  s_waitcnt lgkmcnt(4)
  v_mfma_f32_16x16x32_bf16 v[40:43], v[24:27], a[4:7], v[40:43]
  v_mfma_f32_16x16x32_bf16 v[44:47], v[28:31], a[4:7], v[44:47]
  v_mfma_f32_16x16x32_bf16 v[48:51], v[24:27], a[84:87], v[48:51]
  v_mfma_f32_16x16x32_bf16 v[52:55], v[28:31], a[84:87], v[52:55]
  v_mfma_f32_16x16x32_bf16 v[56:59], v[24:27], a[164:167], v[56:59]
  v_mfma_f32_16x16x32_bf16 v[60:63], v[28:31], a[164:167], v[60:63]
  v_mfma_f32_16x16x32_bf16 v[64:67], v[24:27], a[244:247], v[64:67]
  v_mfma_f32_16x16x32_bf16 v[68:71], v[28:31], a[244:247], v[68:71]
  ds_read_b128 v[24:27], v8 offset:4096
  ds_read_b128 v[28:31], v8 offset:24576
  s_waitcnt lgkmcnt(4)
  v_mfma_f32_16x16x32_bf16 v[40:43], v[32:35], a[8:11], v[40:43]
  v_mfma_f32_16x16x32_bf16 v[44:47], v[36:39], a[8:11], v[44:47]
  v_mfma_f32_16x16x32_bf16 v[48:51], v[32:35], a[88:91], v[48:51]
  v_mfma_f32_16x16x32_bf16 v[52:55], v[36:39], a[88:91], v[52:55]
  v_mfma_f32_16x16x32_bf16 v[56:59], v[32:35], a[168:171], v[56:59]
  v_mfma_f32_16x16x32_bf16 v[60:63], v[36:39], a[168:171], v[60:63]
  v_mfma_f32_16x16x32_bf16 v[64:67], v[32:35], a[248:251], v[64:67]
  v_mfma_f32_16x16x32_bf16 v[68:71], v[36:39], a[248:251], v[68:71]
  ds_read_b128 v[32:35], v8 offset:5120
  ds_read_b128 v[36:39], v8 offset:25600
  s_waitcnt lgkmcnt(4)
  v_mfma_f32_16x16x32_bf16 v[40:43], v[16:19], a[12:15], v[40:43]
  v_mfma_f32_16x16x32_bf16 v[44:47], v[20:23], a[12:15], v[44:47]
  v_mfma_f32_16x16x32_bf16 v[48:51], v[16:19], a[92:95], v[48:51]
  v_mfma_f32_16x16x32_bf16 v[52:55], v[20:23], a[92:95], v[52:55]
  v_mfma_f32_16x16x32_bf16 v[56:59], v[16:19], a[172:175], v[56:59]
  v_mfma_f32_16x16x32_bf16 v[60:63], v[20:23], a[172:175], v[60:63]
  v_mfma_f32_16x16x32_bf16 v[64:67], v[16:19], a[252:255], v[64:67]
  v_mfma_f32_16x16x32_bf16 v[68:71], v[20:23], a[252:255], v[68:71]
  ds_read_b128 v[16:19], v8 offset:6144
  ds_read_b128 v[20:23], v8 offset:26624
  s_waitcnt lgkmcnt(4)
  v_mfma_f32_16x16x32_bf16 v[40:43], v[24:27], a[16:19], v[40:43]
  v_mfma_f32_16x16x32_bf16 v[44:47], v[28:31], a[16:19], v[44:47]
  v_mfma_f32_16x16x32_bf16 v[48:51], v[24:27], a[96:99], v[48:51]
  v_mfma_f32_16x16x32_bf16 v[52:55], v[28:31], a[96:99], v[52:55]
  v_mfma_f32_16x16x32_bf16 v[56:59], v[24:27], a[176:179], v[56:59]
  v_mfma_f32_16x16x32_bf16 v[60:63], v[28:31], a[176:179], v[60:63]
  v_mfma_f32_16x16x32_bf16 v[64:67], v[24:27], v[112:115], v[64:67]
  v_mfma_f32_16x16x32_bf16 v[68:71], v[28:31], v[112:115], v[68:71]
  ds_read_b128 v[24:27], v8 offset:7168
  ds_read_b128 v[28:31], v8 offset:27648
  s_waitcnt lgkmcnt(4)
  v_mfma_f32_16x16x32_bf16 v[40:43], v[32:35], a[20:23], v[40:43]
  v_mfma_f32_16x16x32_bf16 v[44:47], v[36:39], a[20:23], v[44:47]
  v_mfma_f32_16x16x32_bf16 v[48:51], v[32:35], a[100:103], v[48:51]
  v_mfma_f32_16x16x32_bf16 v[52:55], v[36:39], a[100:103], v[52:55]
  v_mfma_f32_16x16x32_bf16 v[56:59], v[32:35], a[180:183], v[56:59]
  v_mfma_f32_16x16x32_bf16 v[60:63], v[36:39], a[180:183], v[60:63]
  v_mfma_f32_16x16x32_bf16 v[64:67], v[32:35], v[116:119], v[64:67]
  v_mfma_f32_16x16x32_bf16 v[68:71], v[36:39], v[116:119], v[68:71]
  ds_read_b128 v[32:35], v8 offset:8192
  ds_read_b128 v[36:39], v8 offset:28672
  s_waitcnt lgkmcnt(4)
  v_mfma_f32_16x16x32_bf16 v[40:43], v[16:19], a[24:27], v[40:43]
  v_mfma_f32_16x16x32_bf16 v[44:47], v[20:23], a[24:27], v[44:47]
  v_mfma_f32_16x16x32_bf16 v[48:51], v[16:19], a[104:107], v[48:51]
  v_mfma_f32_16x16x32_bf16 v[52:55], v[20:23], a[104:107], v[52:55]
  v_mfma_f32_16x16x32_bf16 v[56:59], v[16:19], a[184:187], v[56:59]
  v_mfma_f32_16x16x32_bf16 v[60:63], v[20:23], a[184:187], v[60:63]
  v_mfma_f32_16x16x32_bf16 v[64:67], v[16:19], v[120:123], v[64:67]
  v_mfma_f32_16x16x32_bf16 v[68:71], v[20:23], v[120:123], v[68:71]
  ds_read_b128 v[16:19], v8 offset:9216
  ds_read_b128 v[20:23], v8 offset:29696
  s_waitcnt lgkmcnt(4)
  v_mfma_f32_16x16x32_bf16 v[40:43], v[24:27], a[28:31], v[40:43]
  v_mfma_f32_16x16x32_bf16 v[44:47], v[28:31], a[28:31], v[44:47]
  v_mfma_f32_16x16x32_bf16 v[48:51], v[24:27], a[108:111], v[48:51]
  v_mfma_f32_16x16x32_bf16 v[52:55], v[28:31], a[108:111], v[52:55]
  v_mfma_f32_16x16x32_bf16 v[56:59], v[24:27], a[188:191], v[56:59]
  v_mfma_f32_16x16x32_bf16 v[60:63], v[28:31], a[188:191], v[60:63]
  v_mfma_f32_16x16x32_bf16 v[64:67], v[24:27], v[124:127], v[64:67]
  v_mfma_f32_16x16x32_bf16 v[68:71], v[28:31], v[124:127], v[68:71]
  ds_read_b128 v[24:27], v8 offset:10240
  ds_read_b128 v[28:31], v8 offset:30720
  s_waitcnt lgkmcnt(4)
  v_mfma_f32_16x16x32_bf16 v[40:43], v[32:35], a[32:35], v[40:43]
  v_mfma_f32_16x16x32_bf16 v[44:47], v[36:39], a[32:35], v[44:47]
  v_mfma_f32_16x16x32_bf16 v[48:51], v[32:35], a[112:115], v[48:51]
  v_mfma_f32_16x16x32_bf16 v[52:55], v[36:39], a[112:115], v[52:55]
  v_mfma_f32_16x16x32_bf16 v[56:59], v[32:35], a[192:195], v[56:59]
  v_mfma_f32_16x16x32_bf16 v[60:63], v[36:39], a[192:195], v[60:63]
  v_mfma_f32_16x16x32_bf16 v[64:67], v[32:35], v[128:131], v[64:67]
  v_mfma_f32_16x16x32_bf16 v[68:71], v[36:39], v[128:131], v[68:71]
  ds_read_b128 v[32:35], v8 offset:11264
  ds_read_b128 v[36:39], v8 offset:31744
  s_waitcnt lgkmcnt(4)
  v_mfma_f32_16x16x32_bf16 v[40:43], v[16:19], a[36:39], v[40:43]
  v_mfma_f32_16x16x32_bf16 v[44:47], v[20:23], a[36:39], v[44:47]
  v_mfma_f32_16x16x32_bf16 v[48:51], v[16:19], a[116:119], v[48:51]
  v_mfma_f32_16x16x32_bf16 v[52:55], v[20:23], a[116:119], v[52:55]
  v_mfma_f32_16x16x32_bf16 v[56:59], v[16:19], a[196:199], v[56:59]
  v_mfma_f32_16x16x32_bf16 v[60:63], v[20:23], a[196:199], v[60:63]
  v_mfma_f32_16x16x32_bf16 v[64:67], v[16:19], v[132:135], v[64:67]
  v_mfma_f32_16x16x32_bf16 v[68:71], v[20:23], v[132:135], v[68:71]
  ds_read_b128 v[16:19], v8 offset:12288
  ds_read_b128 v[20:23], v8 offset:32768
  s_waitcnt lgkmcnt(4)
  v_mfma_f32_16x16x32_bf16 v[40:43], v[24:27], a[40:43], v[40:43]
  v_mfma_f32_16x16x32_bf16 v[44:47], v[28:31], a[40:43], v[44:47]
  v_mfma_f32_16x16x32_bf16 v[48:51], v[24:27], a[120:123], v[48:51]
  v_mfma_f32_16x16x32_bf16 v[52:55], v[28:31], a[120:123], v[52:55]
  v_mfma_f32_16x16x32_bf16 v[56:59], v[24:27], a[200:203], v[56:59]
  v_mfma_f32_16x16x32_bf16 v[60:63], v[28:31], a[200:203], v[60:63]
  v_mfma_f32_16x16x32_bf16 v[64:67], v[24:27], v[136:139], v[64:67]
  v_mfma_f32_16x16x32_bf16 v[68:71], v[28:31], v[136:139], v[68:71]
  ds_read_b128 v[24:27], v8 offset:13312
  ds_read_b128 v[28:31], v8 offset:33792
  s_waitcnt lgkmcnt(4)
  v_mfma_f32_16x16x32_bf16 v[40:43], v[32:35], a[44:47], v[40:43]
  v_mfma_f32_16x16x32_bf16 v[44:47], v[36:39], a[44:47], v[44:47]
  v_mfma_f32_16x16x32_bf16 v[48:51], v[32:35], a[124:127], v[48:51]
  v_mfma_f32_16x16x32_bf16 v[52:55], v[36:39], a[124:127], v[52:55]
  v_mfma_f32_16x16x32_bf16 v[56:59], v[32:35], a[204:207], v[56:59]
  v_mfma_f32_16x16x32_bf16 v[60:63], v[36:39], a[204:207], v[60:63]
  v_mfma_f32_16x16x32_bf16 v[64:67], v[32:35], v[140:143], v[64:67]
  v_mfma_f32_16x16x32_bf16 v[68:71], v[36:39], v[140:143], v[68:71]
  ds_read_b128 v[32:35], v8 offset:14336
  ds_read_b128 v[36:39], v8 offset:34816
  s_waitcnt lgkmcnt(4)
  v_mfma_f32_16x16x32_bf16 v[40:43], v[16:19], a[48:51], v[40:43]
  v_mfma_f32_16x16x32_bf16 v[44:47], v[20:23], a[48:51], v[44:47]
  v_mfma_f32_16x16x32_bf16 v[48:51], v[16:19], a[128:131], v[48:51]
  v_mfma_f32_16x16x32_bf16 v[52:55], v[20:23], a[128:131], v[52:55]
  v_mfma_f32_16x16x32_bf16 v[56:59], v[16:19], a[208:211], v[56:59]
  v_mfma_f32_16x16x32_bf16 v[60:63], v[20:23], a[208:211], v[60:63]
  v_mfma_f32_16x16x32_bf16 v[64:67], v[16:19], v[144:147], v[64:67]
  v_mfma_f32_16x16x32_bf16 v[68:71], v[20:23], v[144:147], v[68:71]
  ds_read_b128 v[16:19], v8 offset:15360
  ds_read_b128 v[20:23], v8 offset:35840
  s_waitcnt lgkmcnt(4)
  v_mfma_f32_16x16x32_bf16 v[40:43], v[24:27], a[52:55], v[40:43]
  v_mfma_f32_16x16x32_bf16 v[44:47], v[28:31], a[52:55], v[44:47]
  v_mfma_f32_16x16x32_bf16 v[48:51], v[24:27], a[132:135], v[48:51]
  v_mfma_f32_16x16x32_bf16 v[52:55], v[28:31], a[132:135], v[52:55]
  v_mfma_f32_16x16x32_bf16 v[56:59], v[24:27], a[212:215], v[56:59]
  v_mfma_f32_16x16x32_bf16 v[60:63], v[28:31], a[212:215], v[60:63]
  v_mfma_f32_16x16x32_bf16 v[64:67], v[24:27], v[148:151], v[64:67]
  v_mfma_f32_16x16x32_bf16 v[68:71], v[28:31], v[148:151], v[68:71]
  ds_read_b128 v[24:27], v8 offset:16384
  ds_read_b128 v[28:31], v8 offset:36864
  s_waitcnt lgkmcnt(4)
  v_mfma_f32_16x16x32_bf16 v[40:43], v[32:35], a[56:59], v[40:43]
  v_mfma_f32_16x16x32_bf16 v[44:47], v[36:39], a[56:59], v[44:47]
  v_mfma_f32_16x16x32_bf16 v[48:51], v[32:35], a[136:139], v[48:51]
  v_mfma_f32_16x16x32_bf16 v[52:55], v[36:39], a[136:139], v[52:55]
  v_mfma_f32_16x16x32_bf16 v[56:59], v[32:35], a[216:219], v[56:59]
  v_mfma_f32_16x16x32_bf16 v[60:63], v[36:39], a[216:219], v[60:63]
  v_mfma_f32_16x16x32_bf16 v[64:67], v[32:35], v[152:155], v[64:67]
  v_mfma_f32_16x16x32_bf16 v[68:71], v[36:39], v[152:155], v[68:71]
  ds_read_b128 v[32:35], v8 offset:17408
  ds_read_b128 v[36:39], v8 offset:37888
  s_waitcnt lgkmcnt(4)
  v_mfma_f32_16x16x32_bf16 v[40:43], v[16:19], a[60:63], v[40:43]
  v_mfma_f32_16x16x32_bf16 v[44:47], v[20:23], a[60:63], v[44:47]
  v_mfma_f32_16x16x32_bf16 v[48:51], v[16:19], a[140:143], v[48:51]
  v_mfma_f32_16x16x32_bf16 v[52:55], v[20:23], a[140:143], v[52:55]
  v_mfma_f32_16x16x32_bf16 v[56:59], v[16:19], a[220:223], v[56:59]
  v_mfma_f32_16x16x32_bf16 v[60:63], v[20:23], a[220:223], v[60:63]
  v_mfma_f32_16x16x32_bf16 v[64:67], v[16:19], v[156:159], v[64:67]
  v_mfma_f32_16x16x32_bf16 v[68:71], v[20:23], v[156:159], v[68:71]
  ds_read_b128 v[16:19], v8 offset:18432
  ds_read_b128 v[20:23], v8 offset:38912
  s_waitcnt lgkmcnt(4)
  v_mfma_f32_16x16x32_bf16 v[40:43], v[24:27], a[64:67], v[40:43]
  v_mfma_f32_16x16x32_bf16 v[44:47], v[28:31], a[64:67], v[44:47]
  v_mfma_f32_16x16x32_bf16 v[48:51], v[24:27], a[144:147], v[48:51]
  v_mfma_f32_16x16x32_bf16 v[52:55], v[28:31], a[144:147], v[52:55]
  v_mfma_f32_16x16x32_bf16 v[56:59], v[24:27], a[224:227], v[56:59]
  v_mfma_f32_16x16x32_bf16 v[60:63], v[28:31], a[224:227], v[60:63]
  v_mfma_f32_16x16x32_bf16 v[64:67], v[24:27], v[160:163], v[64:67]
  v_mfma_f32_16x16x32_bf16 v[68:71], v[28:31], v[160:163], v[68:71]
  ds_read_b128 v[24:27], v8 offset:19456
  ds_read_b128 v[28:31], v8 offset:39936
  s_waitcnt lgkmcnt(4)
  v_mfma_f32_16x16x32_bf16 v[40:43], v[32:35], a[68:71], v[40:43]
  v_mfma_f32_16x16x32_bf16 v[44:47], v[36:39], a[68:71], v[44:47]
  v_mfma_f32_16x16x32_bf16 v[48:51], v[32:35], a[148:151], v[48:51]
  v_mfma_f32_16x16x32_bf16 v[52:55], v[36:39], a[148:151], v[52:55]
  v_mfma_f32_16x16x32_bf16 v[56:59], v[32:35], a[228:231], v[56:59]
  v_mfma_f32_16x16x32_bf16 v[60:63], v[36:39], a[228:231], v[60:63]
  v_mfma_f32_16x16x32_bf16 v[64:67], v[32:35], v[164:167], v[64:67]
  v_mfma_f32_16x16x32_bf16 v[68:71], v[36:39], v[164:167], v[68:71]
  s_waitcnt lgkmcnt(2)
  v_mfma_f32_16x16x32_bf16 v[40:43], v[16:19], a[72:75], v[40:43]
  v_mfma_f32_16x16x32_bf16 v[44:47], v[20:23], a[72:75], v[44:47]
  v_mfma_f32_16x16x32_bf16 v[48:51], v[16:19], a[152:155], v[48:51]
  v_mfma_f32_16x16x32_bf16 v[52:55], v[20:23], a[152:155], v[52:55]
  v_mfma_f32_16x16x32_bf16 v[56:59], v[16:19], a[232:235], v[56:59]
  v_mfma_f32_16x16x32_bf16 v[60:63], v[20:23], a[232:235], v[60:63]
  v_mfma_f32_16x16x32_bf16 v[64:67], v[16:19], v[168:171], v[64:67]
  v_mfma_f32_16x16x32_bf16 v[68:71], v[20:23], v[168:171], v[68:71]
  s_waitcnt lgkmcnt(0)
  v_mfma_f32_16x16x32_bf16 v[40:43], v[24:27], a[76:79], v[40:43]
  v_mfma_f32_16x16x32_bf16 v[44:47], v[28:31], a[76:79], v[44:47]
  v_mfma_f32_16x16x32_bf16 v[48:51], v[24:27], a[156:159], v[48:51]
  v_mfma_f32_16x16x32_bf16 v[52:55], v[28:31], a[156:159], v[52:55]
  v_mfma_f32_16x16x32_bf16 v[56:59], v[24:27], a[236:239], v[56:59]
  v_mfma_f32_16x16x32_bf16 v[60:63], v[28:31], a[236:239], v[60:63]
  v_mfma_f32_16x16x32_bf16 v[64:67], v[24:27], v[172:175], v[64:67]
  v_mfma_f32_16x16x32_bf16 v[68:71], v[28:31], v[172:175], v[68:71]
  s_waitcnt vmcnt(0)
  s_mov_b64 exec, 1
  buffer_store_dword v11, off, s[4:7], s41 sc1
  s_mov_b64 exec, -1
  v_add_u32 v11, 4, v11
  v_cvt_pk_bf16_f32 v72, v40, v41
  v_cvt_pk_bf16_f32 v73, v42, v43
  v_cvt_pk_bf16_f32 v74, v44, v45
  v_cvt_pk_bf16_f32 v75, v46, v47
  buffer_store_dwordx4 v[72:75], v1, s[4:7], s40 offen offset:0 sc1
  v_cvt_pk_bf16_f32 v76, v48, v49
  v_cvt_pk_bf16_f32 v77, v50, v51
  v_cvt_pk_bf16_f32 v78, v52, v53
  v_cvt_pk_bf16_f32 v79, v54, v55
  buffer_store_dwordx4 v[76:79], v1, s[4:7], s40 offen offset:1024 sc1
  v_cvt_pk_bf16_f32 v80, v56, v57
  v_cvt_pk_bf16_f32 v81, v58, v59
  v_cvt_pk_bf16_f32 v82, v60, v61
  v_cvt_pk_bf16_f32 v83, v62, v63
  buffer_store_dwordx4 v[80:83], v1, s[4:7], s40 offen offset:2048 sc1
  v_cvt_pk_bf16_f32 v84, v64, v65
  v_cvt_pk_bf16_f32 v85, v66, v67
  v_cvt_pk_bf16_f32 v86, v68, v69
  v_cvt_pk_bf16_f32 v87, v70, v71
  buffer_store_dwordx4 v[84:87], v1, s[4:7], s40 offen offset:3072 sc1
  s_add_u32 s40, s40, 1048576
  s_cmp_lg_u32 s46, 0
  s_cbranch_scc1 L_89
  ds_read_b128 v[16:19], v12 offset:0
  ds_read_b128 v[20:23], v12 offset:1024
  ds_read_b128 v[24:27], v12 offset:2048
  ds_read_b128 v[28:31], v12 offset:3072
  ds_read_b128 v[32:35], v12 offset:4096
  ds_read_b128 v[36:39], v12 offset:5120
  s_waitcnt lgkmcnt(5)
  v_mfma_f32_16x16x32_bf16 v[88:91], v[176:179], v[16:19], 0
  ds_read_b128 v[16:19], v12 offset:6144
  s_waitcnt lgkmcnt(5)
  v_mfma_f32_16x16x32_bf16 v[88:91], v[180:183], v[20:23], v[88:91]
  ds_read_b128 v[20:23], v12 offset:7168
  s_waitcnt lgkmcnt(5)
  v_mfma_f32_16x16x32_bf16 v[88:91], v[184:187], v[24:27], v[88:91]
  ds_read_b128 v[24:27], v12 offset:8192
  s_waitcnt lgkmcnt(5)
  v_mfma_f32_16x16x32_bf16 v[88:91], v[188:191], v[28:31], v[88:91]
  ds_read_b128 v[28:31], v12 offset:9216
  s_waitcnt lgkmcnt(5)
  v_mfma_f32_16x16x32_bf16 v[88:91], v[192:195], v[32:35], v[88:91]
  ds_read_b128 v[32:35], v12 offset:10240
  s_waitcnt lgkmcnt(5)
  v_mfma_f32_16x16x32_bf16 v[88:91], v[196:199], v[36:39], v[88:91]
  ds_read_b128 v[36:39], v12 offset:11264
  s_waitcnt lgkmcnt(5)
  v_mfma_f32_16x16x32_bf16 v[88:91], v[200:203], v[16:19], v[88:91]
  ds_read_b128 v[16:19], v12 offset:12288
  s_waitcnt lgkmcnt(5)
  v_mfma_f32_16x16x32_bf16 v[88:91], v[204:207], v[20:23], v[88:91]
  ds_read_b128 v[20:23], v12 offset:13312
  s_waitcnt lgkmcnt(5)
  v_mfma_f32_16x16x32_bf16 v[88:91], v[208:211], v[24:27], v[88:91]
  ds_read_b128 v[24:27], v12 offset:14336
  s_waitcnt lgkmcnt(5)
  v_mfma_f32_16x16x32_bf16 v[88:91], v[212:215], v[28:31], v[88:91]
  ds_read_b128 v[28:31], v12 offset:15360
  s_waitcnt lgkmcnt(5)
  v_mfma_f32_16x16x32_bf16 v[88:91], v[216:219], v[32:35], v[88:91]
  ds_read_b128 v[32:35], v12 offset:16384
  s_waitcnt lgkmcnt(5)
  v_mfma_f32_16x16x32_bf16 v[88:91], v[220:223], v[36:39], v[88:91]
  ds_read_b128 v[36:39], v12 offset:17408
  s_waitcnt lgkmcnt(5)
  v_mfma_f32_16x16x32_bf16 v[88:91], v[224:227], v[16:19], v[88:91]
  ds_read_b128 v[16:19], v12 offset:18432
  s_waitcnt lgkmcnt(5)
  v_mfma_f32_16x16x32_bf16 v[88:91], v[228:231], v[20:23], v[88:91]
  ds_read_b128 v[20:23], v12 offset:19456
  s_waitcnt lgkmcnt(5)
  v_mfma_f32_16x16x32_bf16 v[88:91], v[232:235], v[24:27], v[88:91]
  s_waitcnt lgkmcnt(4)
  v_mfma_f32_16x16x32_bf16 v[88:91], v[236:239], v[28:31], v[88:91]
  s_waitcnt lgkmcnt(3)
  v_mfma_f32_16x16x32_bf16 v[88:91], v[240:243], v[32:35], v[88:91]
  s_waitcnt lgkmcnt(2)
  v_mfma_f32_16x16x32_bf16 v[88:91], v[244:247], v[36:39], v[88:91]
  s_waitcnt lgkmcnt(1)
  v_mfma_f32_16x16x32_bf16 v[88:91], v[248:251], v[16:19], v[88:91]
  s_waitcnt lgkmcnt(0)
  v_mfma_f32_16x16x32_bf16 v[88:91], v[252:255], v[20:23], v[88:91]
  s_nop 6
  s_branch L_90
L_89:
  ds_read_b128 v[16:19], v12 offset:0
  ds_read_b128 v[20:23], v12 offset:1024
  ds_read_b128 v[24:27], v12 offset:2048
  ds_read_b128 v[28:31], v12 offset:3072
  ds_read_b128 v[32:35], v12 offset:4096
  ds_read_b128 v[36:39], v12 offset:5120
  s_waitcnt lgkmcnt(5)
  v_mfma_f32_16x16x32_bf16 v[88:91], v[16:19], v[176:179], 0
  ds_read_b128 v[16:19], v12 offset:6144
  s_waitcnt lgkmcnt(5)
  v_mfma_f32_16x16x32_bf16 v[88:91], v[20:23], v[180:183], v[88:91]
  ds_read_b128 v[20:23], v12 offset:7168
  s_waitcnt lgkmcnt(5)
  v_mfma_f32_16x16x32_bf16 v[88:91], v[24:27], v[184:187], v[88:91]
  ds_read_b128 v[24:27], v12 offset:8192
  s_waitcnt lgkmcnt(5)
  v_mfma_f32_16x16x32_bf16 v[88:91], v[28:31], v[188:191], v[88:91]
  ds_read_b128 v[28:31], v12 offset:9216
  s_waitcnt lgkmcnt(5)
  v_mfma_f32_16x16x32_bf16 v[88:91], v[32:35], v[192:195], v[88:91]
  ds_read_b128 v[32:35], v12 offset:10240
  s_waitcnt lgkmcnt(5)
  v_mfma_f32_16x16x32_bf16 v[88:91], v[36:39], v[196:199], v[88:91]
  ds_read_b128 v[36:39], v12 offset:11264
  s_waitcnt lgkmcnt(5)
  v_mfma_f32_16x16x32_bf16 v[88:91], v[16:19], v[200:203], v[88:91]
  ds_read_b128 v[16:19], v12 offset:12288
  s_waitcnt lgkmcnt(5)
  v_mfma_f32_16x16x32_bf16 v[88:91], v[20:23], v[204:207], v[88:91]
  ds_read_b128 v[20:23], v12 offset:13312
  s_waitcnt lgkmcnt(5)
  v_mfma_f32_16x16x32_bf16 v[88:91], v[24:27], v[208:211], v[88:91]
  ds_read_b128 v[24:27], v12 offset:14336
  s_waitcnt lgkmcnt(5)
  v_mfma_f32_16x16x32_bf16 v[88:91], v[28:31], v[212:215], v[88:91]
  ds_read_b128 v[28:31], v12 offset:15360
  s_waitcnt lgkmcnt(5)
  v_mfma_f32_16x16x32_bf16 v[88:91], v[32:35], v[216:219], v[88:91]
  ds_read_b128 v[32:35], v12 offset:16384
  s_waitcnt lgkmcnt(5)
  v_mfma_f32_16x16x32_bf16 v[88:91], v[36:39], v[220:223], v[88:91]
  ds_read_b128 v[36:39], v12 offset:17408
  s_waitcnt lgkmcnt(5)
  v_mfma_f32_16x16x32_bf16 v[88:91], v[16:19], v[224:227], v[88:91]
  ds_read_b128 v[16:19], v12 offset:18432
  s_waitcnt lgkmcnt(5)
  v_mfma_f32_16x16x32_bf16 v[88:91], v[20:23], v[228:231], v[88:91]
  ds_read_b128 v[20:23], v12 offset:19456
  s_waitcnt lgkmcnt(5)
  v_mfma_f32_16x16x32_bf16 v[88:91], v[24:27], v[232:235], v[88:91]
  s_waitcnt lgkmcnt(4)
  v_mfma_f32_16x16x32_bf16 v[88:91], v[28:31], v[236:239], v[88:91]
  s_waitcnt lgkmcnt(3)
  v_mfma_f32_16x16x32_bf16 v[88:91], v[32:35], v[240:243], v[88:91]
  s_waitcnt lgkmcnt(2)
  v_mfma_f32_16x16x32_bf16 v[88:91], v[36:39], v[244:247], v[88:91]
  s_waitcnt lgkmcnt(1)
  v_mfma_f32_16x16x32_bf16 v[88:91], v[16:19], v[248:251], v[88:91]
  s_waitcnt lgkmcnt(0)
  v_mfma_f32_16x16x32_bf16 v[88:91], v[20:23], v[252:255], v[88:91]
L_90:
  s_nop 7
  v_fma_f32 v92, v88, s45, v10
  v_fma_f32 v93, v89, s45, v10
  v_fma_f32 v94, v90, s45, v10
  v_fma_f32 v95, v91, s45, v10
  v_cvt_pk_bf16_f32 v92, v92, v93
  v_cvt_pk_bf16_f32 v93, v94, v95
  buffer_store_dwordx2 v[92:93], v9, s[4:7], s44 offen sc1
  s_add_u32 s44, s44, s43
  v_add_u32 v7, s47, v7
  v_add_u32 v8, s47, v8
  v_add_u32 v12, s47, v12
  s_sub_u32 s47, 0, s47
  s_add_u32 s42, s42, 1
  s_cmp_lt_u32 s42, 8
  s_cbranch_scc1 L_pN
L_pE:
  s_waitcnt vmcnt(0)
  s_mov_b64 exec, 1
  buffer_store_dword v11, off, s[4:7], s41 sc1
  s_mov_b64 exec, -1
  s_barrier
  s_lshl_b32 s31, s29, 2
  s_add_u32 s31, s31, 9216
  s_mov_b64 exec, 1
  buffer_store_dword v11, off, s[4:7], s31 sc1
  s_mov_b64 exec, -1
  v_lshlrev_b32 v9, 2, v0
  s_mov_b32 s38, 9216
wf_91:
  buffer_load_dword v12, v9, s[4:7], s38 offen offset:0 sc1
  buffer_load_dword v13, v9, s[4:7], s38 offen offset:256 sc1
  buffer_load_dword v14, v9, s[4:7], s38 offen offset:512 sc1
  s_waitcnt vmcnt(0)
  v_min_u32 v12, v12, v13
  v_min_u32 v12, v12, v14
  v_cmp_ge_u32 vcc, 0, v12
  s_cbranch_vccz wf_92
  s_sleep 4
  s_sub_u32 s30, s30, 1
  s_cbranch_scc0 wf_91
  s_mov_b32 s30, 0
wf_92:
  v_lshrrev_b32 v2, 5, v0
  v_and_b32 v3, 31, v0
  v_cmp_eq_u32 vcc, 0, v2
  v_mov_b32 v12, 0x7ff00000
  v_mul_u32_u24 v13, 40, v3
  v_lshl_add_u32 v4, v2, 4, v13
  v_lshl_add_u32 v6, v2, 3, v13
  v_add_u32 v13, 32, v13
  v_cndmask_b32 v5, v12, v13, vcc
  v_and_b32 v13, 19, v3
  v_and_b32 v14, 4, v3
  v_lshl_add_u32 v13, v14, 1, v13
  v_and_b32 v14, 8, v3
  v_lshrrev_b32 v14, 1, v14
  v_add_u32 v13, v13, v14
  v_mul_u32_u24 v13, 40, v13
  v_add_u32 v14, 32, v13
  v_cndmask_b32 v14, v12, v14, vcc
  v_lshl_add_u32 v13, v2, 4, v13
  v_lshlrev_b32 v15, 12, v3
  v_lshl_add_u32 v15, v2, 4, v15
  v_cmp_ge_u32 vcc, 20, v3
  s_nop 1
  v_cndmask_b32 v15, v12, v15, vcc
  v_lshlrev_b32 v8, 4, v3
  s_mul_i32 s38, s28, 20480
  s_add_u32 s38, s38, 7340032
  s_lshl_b32 s39, s28, 10
  s_add_u32 s39, s39, 7471104
  s_mul_i32 s32, s29, 3
  s_sub_u32 s32, s32, 64
  s_cmp_lt_u32 s29, 32
  s_cselect_b32 s32, s29, s32
  s_cselect_b32 s33, 1, 3
  s_lshl_b32 s32, s32, 2
  s_mul_i32 s37, s28, 3072
  buffer_load_dwordx4 a[0:3], v13, s[4:7], s38 offen offset:0
  buffer_load_dwordx2 a[4:5], v14, s[4:7], s38 offen offset:0
  buffer_load_dwordx4 a[96:99], v15, s[4:7], s39 offen offset:0
  buffer_load_dwordx4 a[100:103], v15, s[4:7], s39 offen offset:32
  buffer_load_dwordx4 a[6:9], v13, s[4:7], s38 offen offset:1280
  buffer_load_dwordx2 a[10:11], v14, s[4:7], s38 offen offset:1280
  buffer_load_dwordx4 a[104:107], v15, s[4:7], s39 offen offset:64
  buffer_load_dwordx4 a[108:111], v15, s[4:7], s39 offen offset:96
  buffer_load_dwordx4 a[12:15], v13, s[4:7], s38 offen offset:2560
  buffer_load_dwordx2 a[16:17], v14, s[4:7], s38 offen offset:2560
  s_add_u32 s38, s38, 3840
  buffer_load_dwordx4 a[112:115], v15, s[4:7], s39 offen offset:128
  buffer_load_dwordx4 a[116:119], v15, s[4:7], s39 offen offset:160
  buffer_load_dwordx4 a[18:21], v13, s[4:7], s38 offen offset:0
  buffer_load_dwordx2 a[22:23], v14, s[4:7], s38 offen offset:0
  buffer_load_dwordx4 a[120:123], v15, s[4:7], s39 offen offset:192
  buffer_load_dwordx4 a[124:127], v15, s[4:7], s39 offen offset:224
  buffer_load_dwordx4 a[24:27], v13, s[4:7], s38 offen offset:1280
  buffer_load_dwordx2 a[28:29], v14, s[4:7], s38 offen offset:1280
  buffer_load_dwordx4 a[128:131], v15, s[4:7], s39 offen offset:256
  buffer_load_dwordx4 a[132:135], v15, s[4:7], s39 offen offset:288
  buffer_load_dwordx4 a[30:33], v13, s[4:7], s38 offen offset:2560
  buffer_load_dwordx2 a[34:35], v14, s[4:7], s38 offen offset:2560
  s_add_u32 s38, s38, 3840
  buffer_load_dwordx4 a[136:139], v15, s[4:7], s39 offen offset:320
  buffer_load_dwordx4 a[140:143], v15, s[4:7], s39 offen offset:352
  buffer_load_dwordx4 a[36:39], v13, s[4:7], s38 offen offset:0
  buffer_load_dwordx2 a[40:41], v14, s[4:7], s38 offen offset:0
  buffer_load_dwordx4 a[144:147], v15, s[4:7], s39 offen offset:384
  buffer_load_dwordx4 a[148:151], v15, s[4:7], s39 offen offset:416
  buffer_load_dwordx4 a[42:45], v13, s[4:7], s38 offen offset:1280
  buffer_load_dwordx2 a[46:47], v14, s[4:7], s38 offen offset:1280
  buffer_load_dwordx4 a[152:155], v15, s[4:7], s39 offen offset:448
  buffer_load_dwordx4 a[156:159], v15, s[4:7], s39 offen offset:480
  buffer_load_dwordx4 a[48:51], v13, s[4:7], s38 offen offset:2560
  buffer_load_dwordx2 a[52:53], v14, s[4:7], s38 offen offset:2560
  s_add_u32 s38, s38, 3840
  buffer_load_dwordx4 a[160:163], v15, s[4:7], s39 offen offset:512
  buffer_load_dwordx4 a[164:167], v15, s[4:7], s39 offen offset:544
  buffer_load_dwordx4 a[54:57], v13, s[4:7], s38 offen offset:0
  buffer_load_dwordx2 a[58:59], v14, s[4:7], s38 offen offset:0
  buffer_load_dwordx4 a[168:171], v15, s[4:7], s39 offen offset:576
  buffer_load_dwordx4 a[172:175], v15, s[4:7], s39 offen offset:608
  buffer_load_dwordx4 a[60:63], v13, s[4:7], s38 offen offset:1280
  buffer_load_dwordx2 a[64:65], v14, s[4:7], s38 offen offset:1280
  buffer_load_dwordx4 a[176:179], v15, s[4:7], s39 offen offset:640
  buffer_load_dwordx4 a[180:183], v15, s[4:7], s39 offen offset:672
  buffer_load_dwordx4 a[66:69], v13, s[4:7], s38 offen offset:2560
  buffer_load_dwordx2 a[70:71], v14, s[4:7], s38 offen offset:2560
  s_add_u32 s38, s38, 3840
  buffer_load_dwordx4 a[184:187], v15, s[4:7], s39 offen offset:704
  buffer_load_dwordx4 a[188:191], v15, s[4:7], s39 offen offset:736
  s_waitcnt vmcnt(16)
  buffer_load_dwordx4 a[72:75], v13, s[4:7], s38 offen offset:0
  buffer_load_dwordx2 a[76:77], v14, s[4:7], s38 offen offset:0
  buffer_load_dwordx4 a[192:195], v15, s[4:7], s39 offen offset:768
  buffer_load_dwordx4 a[196:199], v15, s[4:7], s39 offen offset:800
  buffer_load_dwordx4 a[78:81], v13, s[4:7], s38 offen offset:1280
  buffer_load_dwordx2 a[82:83], v14, s[4:7], s38 offen offset:1280
  buffer_load_dwordx4 a[200:203], v15, s[4:7], s39 offen offset:832
  buffer_load_dwordx4 a[204:207], v15, s[4:7], s39 offen offset:864
  buffer_load_dwordx4 a[84:87], v13, s[4:7], s38 offen offset:2560
  buffer_load_dwordx2 a[88:89], v14, s[4:7], s38 offen offset:2560
  s_add_u32 s38, s38, 3840
  buffer_load_dwordx4 a[208:211], v15, s[4:7], s39 offen offset:896
  buffer_load_dwordx4 a[212:215], v15, s[4:7], s39 offen offset:928
  buffer_load_dwordx4 a[90:93], v13, s[4:7], s38 offen offset:0
  buffer_load_dwordx2 a[94:95], v14, s[4:7], s38 offen offset:0
  buffer_load_dwordx4 a[216:219], v15, s[4:7], s39 offen offset:960
  buffer_load_dwordx4 a[220:223], v15, s[4:7], s39 offen offset:992
  s_mul_i32 s36, s32, 1280
  s_add_u32 s36, s36, 4194304
  s_mov_b32 s34, 0
  buffer_load_dwordx4 v[24:27], v4, s[4:7], s36 offen
  buffer_load_dwordx2 v[28:29], v5, s[4:7], s36 offen
  s_add_u32 s36, s36, 1280
L_aI:
  s_mov_b32 s35, 0
  v_mov_b32 v32, 0
  v_mov_b32 v33, 0
  v_mov_b32 v34, 0
  v_mov_b32 v35, 0
  v_mov_b32 v36, 0
  v_mov_b32 v37, 0
  v_mov_b32 v38, 0
  v_mov_b32 v39, 0
  v_mov_b32 v40, 0
  v_mov_b32 v41, 0
  v_mov_b32 v42, 0
  v_mov_b32 v43, 0
  v_mov_b32 v44, 0
  v_mov_b32 v45, 0
  v_mov_b32 v46, 0
  v_mov_b32 v47, 0
L_aR:
  s_add_u32 s38, s32, s28
  s_lshl_b32 s38, s38, 1
  s_add_u32 s38, s38, 7557120
  buffer_load_ushort v10, off, s[4:7], s38
  v_add_u32 v11, s37, v1
L_aT:
  s_waitcnt vmcnt(0)
  v_mov_b32 v16, v24
  v_mov_b32 v17, v25
  v_mov_b32 v18, v26
  v_mov_b32 v19, v27
  v_mov_b32 v20, v28
  v_mov_b32 v21, v29
  buffer_load_dwordx4 v[24:27], v4, s[4:7], s36 offen
  buffer_load_dwordx2 v[28:29], v5, s[4:7], s36 offen
  s_add_u32 s36, s36, 1280
  s_cmp_eq_u32 s35, 0
  s_cbranch_scc1 L_aF
  s_lshl_b32 s38, s34, 10
  v_lshrrev_b32 v12, 2, v8
  v_add_u32 v12, s38, v12
  ds_read_b32 v32, v12 offset:49152
  ds_read_b32 v33, v12 offset:49280
  ds_read_b32 v34, v12 offset:49408
  ds_read_b32 v35, v12 offset:49536
  ds_read_b32 v36, v12 offset:49664
  ds_read_b32 v37, v12 offset:49792
  ds_read_b32 v38, v12 offset:49920
  ds_read_b32 v39, v12 offset:50048
  s_waitcnt lgkmcnt(0)
  v_max_f32 v32, v32, v33
  v_max_f32 v32, v32, v34
  v_max_f32 v32, v32, v35
  v_max_f32 v32, v32, v36
  v_max_f32 v32, v32, v37
  v_max_f32 v32, v32, v38
  v_max_f32 v32, v32, v39
  v_sub_f32 v32, 0, v32
  v_mov_b32 v33, v32
  v_mov_b32 v34, v32
  v_mov_b32 v35, v32
  v_mov_b32 v36, v32
  v_mov_b32 v37, v32
  v_mov_b32 v38, v32
  v_mov_b32 v39, v32
  v_mov_b32 v40, v32
  v_mov_b32 v41, v32
  v_mov_b32 v42, v32
  v_mov_b32 v43, v32
  v_mov_b32 v44, v32
  v_mov_b32 v45, v32
  v_mov_b32 v46, v32
  v_mov_b32 v47, v32
L_aF:
  s_nop 1
  v_mfma_f32_32x32x16_bf16 v[48:63], a[0:3], v[16:19], v[32:47]
  s_nop 9
  v_mfma_f32_32x32x8_bf16 v[48:63], a[4:5], v[20:21], v[48:63]
  v_mfma_f32_32x32x16_bf16 v[64:79], a[6:9], v[16:19], v[32:47]
  s_nop 7
  v_exp_f32 v48, v48
  v_exp_f32 v49, v49
  v_exp_f32 v50, v50
  v_exp_f32 v51, v51
  v_exp_f32 v52, v52
  v_exp_f32 v53, v53
  v_exp_f32 v54, v54
  v_exp_f32 v55, v55
  v_cvt_pk_bf16_f32 v80, v48, v49
  v_cvt_pk_bf16_f32 v81, v50, v51
  v_mfma_f32_32x32x8_bf16 v[64:79], a[10:11], v[20:21], v[64:79]
  v_exp_f32 v56, v56
  v_cvt_pk_bf16_f32 v82, v52, v53
  v_exp_f32 v57, v57
  v_cvt_pk_bf16_f32 v83, v54, v55
  v_exp_f32 v58, v58
  v_exp_f32 v59, v59
  v_mfma_f32_32x32x16_bf16 v[96:111], a[96:99], v[80:83], 0
  v_exp_f32 v60, v60
  v_exp_f32 v61, v61
  v_exp_f32 v62, v62
  v_exp_f32 v63, v63
  v_cvt_pk_bf16_f32 v84, v56, v57
  v_cvt_pk_bf16_f32 v85, v58, v59
  v_cvt_pk_bf16_f32 v86, v60, v61
  v_cvt_pk_bf16_f32 v87, v62, v63
  v_mfma_f32_32x32x16_bf16 v[48:63], a[12:15], v[16:19], v[32:47]
  v_exp_f32 v64, v64
  v_exp_f32 v65, v65
  v_exp_f32 v66, v66
  v_exp_f32 v67, v67
  v_mfma_f32_32x32x16_bf16 v[96:111], a[100:103], v[84:87], v[96:111]
  v_exp_f32 v68, v68
  v_exp_f32 v69, v69
  v_exp_f32 v70, v70
  v_exp_f32 v71, v71
  v_cvt_pk_bf16_f32 v80, v64, v65
  v_cvt_pk_bf16_f32 v81, v66, v67
  v_mfma_f32_32x32x8_bf16 v[48:63], a[16:17], v[20:21], v[48:63]
  v_exp_f32 v72, v72
  v_cvt_pk_bf16_f32 v82, v68, v69
  v_exp_f32 v73, v73
  v_cvt_pk_bf16_f32 v83, v70, v71
  v_exp_f32 v74, v74
  v_exp_f32 v75, v75
  v_mfma_f32_32x32x16_bf16 v[96:111], a[104:107], v[80:83], v[96:111]
  v_exp_f32 v76, v76
  v_exp_f32 v77, v77
  v_exp_f32 v78, v78
  v_exp_f32 v79, v79
  v_cvt_pk_bf16_f32 v84, v72, v73
  v_cvt_pk_bf16_f32 v85, v74, v75
  v_cvt_pk_bf16_f32 v86, v76, v77
  v_cvt_pk_bf16_f32 v87, v78, v79
  v_mfma_f32_32x32x16_bf16 v[64:79], a[18:21], v[16:19], v[32:47]
  v_exp_f32 v48, v48
  v_exp_f32 v49, v49
  v_exp_f32 v50, v50
  v_exp_f32 v51, v51
  v_mfma_f32_32x32x16_bf16 v[96:111], a[108:111], v[84:87], v[96:111]
  v_exp_f32 v52, v52
  v_exp_f32 v53, v53
  v_exp_f32 v54, v54
  v_exp_f32 v55, v55
  v_cvt_pk_bf16_f32 v80, v48, v49
  v_cvt_pk_bf16_f32 v81, v50, v51
  v_mfma_f32_32x32x8_bf16 v[64:79], a[22:23], v[20:21], v[64:79]
  v_exp_f32 v56, v56
  v_cvt_pk_bf16_f32 v82, v52, v53
  v_exp_f32 v57, v57
  v_cvt_pk_bf16_f32 v83, v54, v55
  v_exp_f32 v58, v58
  v_exp_f32 v59, v59
  v_mfma_f32_32x32x16_bf16 v[96:111], a[112:115], v[80:83], v[96:111]
  v_exp_f32 v60, v60
  v_exp_f32 v61, v61
  v_exp_f32 v62, v62
  v_exp_f32 v63, v63
  v_cvt_pk_bf16_f32 v84, v56, v57
  v_cvt_pk_bf16_f32 v85, v58, v59
  v_cvt_pk_bf16_f32 v86, v60, v61
  v_cvt_pk_bf16_f32 v87, v62, v63
  v_mfma_f32_32x32x16_bf16 v[48:63], a[24:27], v[16:19], v[32:47]
  v_exp_f32 v64, v64
  v_exp_f32 v65, v65
  v_exp_f32 v66, v66
  v_exp_f32 v67, v67
  v_mfma_f32_32x32x16_bf16 v[96:111], a[116:119], v[84:87], v[96:111]
  v_exp_f32 v68, v68
  v_exp_f32 v69, v69
  v_exp_f32 v70, v70
  v_exp_f32 v71, v71
  v_cvt_pk_bf16_f32 v80, v64, v65
  v_cvt_pk_bf16_f32 v81, v66, v67
  v_mfma_f32_32x32x8_bf16 v[48:63], a[28:29], v[20:21], v[48:63]
  v_exp_f32 v72, v72
  v_cvt_pk_bf16_f32 v82, v68, v69
  v_exp_f32 v73, v73
  v_cvt_pk_bf16_f32 v83, v70, v71
  v_exp_f32 v74, v74
  v_exp_f32 v75, v75
  v_mfma_f32_32x32x16_bf16 v[96:111], a[120:123], v[80:83], v[96:111]
  v_exp_f32 v76, v76
  v_exp_f32 v77, v77
  v_exp_f32 v78, v78
  v_exp_f32 v79, v79
  v_cvt_pk_bf16_f32 v84, v72, v73
  v_cvt_pk_bf16_f32 v85, v74, v75
  v_cvt_pk_bf16_f32 v86, v76, v77
  v_cvt_pk_bf16_f32 v87, v78, v79
  v_mfma_f32_32x32x16_bf16 v[64:79], a[30:33], v[16:19], v[32:47]
  v_exp_f32 v48, v48
  v_exp_f32 v49, v49
  v_exp_f32 v50, v50
  v_exp_f32 v51, v51
  v_mfma_f32_32x32x16_bf16 v[96:111], a[124:127], v[84:87], v[96:111]
  v_exp_f32 v52, v52
  v_exp_f32 v53, v53
  v_exp_f32 v54, v54
  v_exp_f32 v55, v55
  v_cvt_pk_bf16_f32 v80, v48, v49
  v_cvt_pk_bf16_f32 v81, v50, v51
  v_mfma_f32_32x32x8_bf16 v[64:79], a[34:35], v[20:21], v[64:79]
  v_exp_f32 v56, v56
  v_cvt_pk_bf16_f32 v82, v52, v53
  v_exp_f32 v57, v57
  v_cvt_pk_bf16_f32 v83, v54, v55
  v_exp_f32 v58, v58
  v_exp_f32 v59, v59
  v_mfma_f32_32x32x16_bf16 v[96:111], a[128:131], v[80:83], v[96:111]
  v_exp_f32 v60, v60
  v_exp_f32 v61, v61
  v_exp_f32 v62, v62
  v_exp_f32 v63, v63
  v_cvt_pk_bf16_f32 v84, v56, v57
  v_cvt_pk_bf16_f32 v85, v58, v59
  v_cvt_pk_bf16_f32 v86, v60, v61
  v_cvt_pk_bf16_f32 v87, v62, v63
  v_mfma_f32_32x32x16_bf16 v[48:63], a[36:39], v[16:19], v[32:47]
  v_exp_f32 v64, v64
  v_exp_f32 v65, v65
  v_exp_f32 v66, v66
  v_exp_f32 v67, v67
  v_mfma_f32_32x32x16_bf16 v[96:111], a[132:135], v[84:87], v[96:111]
  v_exp_f32 v68, v68
  v_exp_f32 v69, v69
  v_exp_f32 v70, v70
  v_exp_f32 v71, v71
  v_cvt_pk_bf16_f32 v80, v64, v65
  v_cvt_pk_bf16_f32 v81, v66, v67
  v_mfma_f32_32x32x8_bf16 v[48:63], a[40:41], v[20:21], v[48:63]
  v_exp_f32 v72, v72
  v_cvt_pk_bf16_f32 v82, v68, v69
  v_exp_f32 v73, v73
  v_cvt_pk_bf16_f32 v83, v70, v71
  v_exp_f32 v74, v74
  v_exp_f32 v75, v75
  v_mfma_f32_32x32x16_bf16 v[96:111], a[136:139], v[80:83], v[96:111]
  v_exp_f32 v76, v76
  v_exp_f32 v77, v77
  v_exp_f32 v78, v78
  v_exp_f32 v79, v79
  v_cvt_pk_bf16_f32 v84, v72, v73
  v_cvt_pk_bf16_f32 v85, v74, v75
  v_cvt_pk_bf16_f32 v86, v76, v77
  v_cvt_pk_bf16_f32 v87, v78, v79
  v_mfma_f32_32x32x16_bf16 v[64:79], a[42:45], v[16:19], v[32:47]
  v_exp_f32 v48, v48
  v_exp_f32 v49, v49
  v_exp_f32 v50, v50
  v_exp_f32 v51, v51
  v_mfma_f32_32x32x16_bf16 v[96:111], a[140:143], v[84:87], v[96:111]
  v_exp_f32 v52, v52
  v_exp_f32 v53, v53
  v_exp_f32 v54, v54
  v_exp_f32 v55, v55
  v_cvt_pk_bf16_f32 v80, v48, v49
  v_cvt_pk_bf16_f32 v81, v50, v51
  v_mfma_f32_32x32x8_bf16 v[64:79], a[46:47], v[20:21], v[64:79]
  v_exp_f32 v56, v56
  v_cvt_pk_bf16_f32 v82, v52, v53
  v_exp_f32 v57, v57
  v_cvt_pk_bf16_f32 v83, v54, v55
  v_exp_f32 v58, v58
  v_exp_f32 v59, v59
  v_mfma_f32_32x32x16_bf16 v[96:111], a[144:147], v[80:83], v[96:111]
  v_exp_f32 v60, v60
  v_exp_f32 v61, v61
  v_exp_f32 v62, v62
  v_exp_f32 v63, v63
  v_cvt_pk_bf16_f32 v84, v56, v57
  v_cvt_pk_bf16_f32 v85, v58, v59
  v_cvt_pk_bf16_f32 v86, v60, v61
  v_cvt_pk_bf16_f32 v87, v62, v63
  v_mfma_f32_32x32x16_bf16 v[48:63], a[48:51], v[16:19], v[32:47]
  v_exp_f32 v64, v64
  v_exp_f32 v65, v65
  v_exp_f32 v66, v66
  v_exp_f32 v67, v67
  v_mfma_f32_32x32x16_bf16 v[96:111], a[148:151], v[84:87], v[96:111]
  v_exp_f32 v68, v68
  v_exp_f32 v69, v69
  v_exp_f32 v70, v70
  v_exp_f32 v71, v71
  v_cvt_pk_bf16_f32 v80, v64, v65
  v_cvt_pk_bf16_f32 v81, v66, v67
  v_mfma_f32_32x32x8_bf16 v[48:63], a[52:53], v[20:21], v[48:63]
  v_exp_f32 v72, v72
  v_cvt_pk_bf16_f32 v82, v68, v69
  v_exp_f32 v73, v73
  v_cvt_pk_bf16_f32 v83, v70, v71
  v_exp_f32 v74, v74
  v_exp_f32 v75, v75
  v_mfma_f32_32x32x16_bf16 v[96:111], a[152:155], v[80:83], v[96:111]
  v_exp_f32 v76, v76
  v_exp_f32 v77, v77
  v_exp_f32 v78, v78
  v_exp_f32 v79, v79
  v_cvt_pk_bf16_f32 v84, v72, v73
  v_cvt_pk_bf16_f32 v85, v74, v75
  v_cvt_pk_bf16_f32 v86, v76, v77
  v_cvt_pk_bf16_f32 v87, v78, v79
  v_mfma_f32_32x32x16_bf16 v[64:79], a[54:57], v[16:19], v[32:47]
  v_exp_f32 v48, v48
  v_exp_f32 v49, v49
  v_exp_f32 v50, v50
  v_exp_f32 v51, v51
  v_mfma_f32_32x32x16_bf16 v[96:111], a[156:159], v[84:87], v[96:111]
  v_exp_f32 v52, v52
  v_exp_f32 v53, v53
  v_exp_f32 v54, v54
  v_exp_f32 v55, v55
  v_cvt_pk_bf16_f32 v80, v48, v49
  v_cvt_pk_bf16_f32 v81, v50, v51
  v_mfma_f32_32x32x8_bf16 v[64:79], a[58:59], v[20:21], v[64:79]
  v_exp_f32 v56, v56
  v_cvt_pk_bf16_f32 v82, v52, v53
  v_exp_f32 v57, v57
  v_cvt_pk_bf16_f32 v83, v54, v55
  v_exp_f32 v58, v58
  v_exp_f32 v59, v59
  v_mfma_f32_32x32x16_bf16 v[96:111], a[160:163], v[80:83], v[96:111]
  v_exp_f32 v60, v60
  v_exp_f32 v61, v61
  v_exp_f32 v62, v62
  v_exp_f32 v63, v63
  v_cvt_pk_bf16_f32 v84, v56, v57
  v_cvt_pk_bf16_f32 v85, v58, v59
  v_cvt_pk_bf16_f32 v86, v60, v61
  v_cvt_pk_bf16_f32 v87, v62, v63
  v_mfma_f32_32x32x16_bf16 v[48:63], a[60:63], v[16:19], v[32:47]
  v_exp_f32 v64, v64
  v_exp_f32 v65, v65
  v_exp_f32 v66, v66
  v_exp_f32 v67, v67
  v_mfma_f32_32x32x16_bf16 v[96:111], a[164:167], v[84:87], v[96:111]
  v_exp_f32 v68, v68
  v_exp_f32 v69, v69
  v_exp_f32 v70, v70
  v_exp_f32 v71, v71
  v_cvt_pk_bf16_f32 v80, v64, v65
  v_cvt_pk_bf16_f32 v81, v66, v67
  v_mfma_f32_32x32x8_bf16 v[48:63], a[64:65], v[20:21], v[48:63]
  v_exp_f32 v72, v72
  v_cvt_pk_bf16_f32 v82, v68, v69
  v_exp_f32 v73, v73
  v_cvt_pk_bf16_f32 v83, v70, v71
  v_exp_f32 v74, v74
  v_exp_f32 v75, v75
  v_mfma_f32_32x32x16_bf16 v[96:111], a[168:171], v[80:83], v[96:111]
  v_exp_f32 v76, v76
  v_exp_f32 v77, v77
  v_exp_f32 v78, v78
  v_exp_f32 v79, v79
  v_cvt_pk_bf16_f32 v84, v72, v73
  v_cvt_pk_bf16_f32 v85, v74, v75
  v_cvt_pk_bf16_f32 v86, v76, v77
  v_cvt_pk_bf16_f32 v87, v78, v79
  v_mfma_f32_32x32x16_bf16 v[64:79], a[66:69], v[16:19], v[32:47]
  v_exp_f32 v48, v48
  v_exp_f32 v49, v49
  v_exp_f32 v50, v50
  v_exp_f32 v51, v51
  v_mfma_f32_32x32x16_bf16 v[96:111], a[172:175], v[84:87], v[96:111]
  v_exp_f32 v52, v52
  v_exp_f32 v53, v53
  v_exp_f32 v54, v54
  v_exp_f32 v55, v55
  v_cvt_pk_bf16_f32 v80, v48, v49
  v_cvt_pk_bf16_f32 v81, v50, v51
  v_mfma_f32_32x32x8_bf16 v[64:79], a[70:71], v[20:21], v[64:79]
  v_exp_f32 v56, v56
  v_cvt_pk_bf16_f32 v82, v52, v53
  v_exp_f32 v57, v57
  v_cvt_pk_bf16_f32 v83, v54, v55
  v_exp_f32 v58, v58
  v_exp_f32 v59, v59
  v_mfma_f32_32x32x16_bf16 v[96:111], a[176:179], v[80:83], v[96:111]
  v_exp_f32 v60, v60
  v_exp_f32 v61, v61
  v_exp_f32 v62, v62
  v_exp_f32 v63, v63
  v_cvt_pk_bf16_f32 v84, v56, v57
  v_cvt_pk_bf16_f32 v85, v58, v59
  v_cvt_pk_bf16_f32 v86, v60, v61
  v_cvt_pk_bf16_f32 v87, v62, v63
  v_mfma_f32_32x32x16_bf16 v[48:63], a[72:75], v[16:19], v[32:47]
  v_exp_f32 v64, v64
  v_exp_f32 v65, v65
  v_exp_f32 v66, v66
  v_exp_f32 v67, v67
  v_mfma_f32_32x32x16_bf16 v[96:111], a[180:183], v[84:87], v[96:111]
  v_exp_f32 v68, v68
  v_exp_f32 v69, v69
  v_exp_f32 v70, v70
  v_exp_f32 v71, v71
  v_cvt_pk_bf16_f32 v80, v64, v65
  v_cvt_pk_bf16_f32 v81, v66, v67
  v_mfma_f32_32x32x8_bf16 v[48:63], a[76:77], v[20:21], v[48:63]
  v_exp_f32 v72, v72
  v_cvt_pk_bf16_f32 v82, v68, v69
  v_exp_f32 v73, v73
  v_cvt_pk_bf16_f32 v83, v70, v71
  v_exp_f32 v74, v74
  v_exp_f32 v75, v75
  v_mfma_f32_32x32x16_bf16 v[96:111], a[184:187], v[80:83], v[96:111]
  v_exp_f32 v76, v76
  v_exp_f32 v77, v77
  v_exp_f32 v78, v78
  v_exp_f32 v79, v79
  v_cvt_pk_bf16_f32 v84, v72, v73
  v_cvt_pk_bf16_f32 v85, v74, v75
  v_cvt_pk_bf16_f32 v86, v76, v77
  v_cvt_pk_bf16_f32 v87, v78, v79
  v_mfma_f32_32x32x16_bf16 v[64:79], a[78:81], v[16:19], v[32:47]
  v_exp_f32 v48, v48
  v_exp_f32 v49, v49
  v_exp_f32 v50, v50
  v_exp_f32 v51, v51
  v_mfma_f32_32x32x16_bf16 v[96:111], a[188:191], v[84:87], v[96:111]
  v_exp_f32 v52, v52
  v_exp_f32 v53, v53
  v_exp_f32 v54, v54
  v_exp_f32 v55, v55
  v_cvt_pk_bf16_f32 v80, v48, v49
  v_cvt_pk_bf16_f32 v81, v50, v51
  v_mfma_f32_32x32x8_bf16 v[64:79], a[82:83], v[20:21], v[64:79]
  v_exp_f32 v56, v56
  v_cvt_pk_bf16_f32 v82, v52, v53
  v_exp_f32 v57, v57
  v_cvt_pk_bf16_f32 v83, v54, v55
  v_exp_f32 v58, v58
  v_exp_f32 v59, v59
  v_mfma_f32_32x32x16_bf16 v[96:111], a[192:195], v[80:83], v[96:111]
  v_exp_f32 v60, v60
  v_exp_f32 v61, v61
  v_exp_f32 v62, v62
  v_exp_f32 v63, v63
  v_cvt_pk_bf16_f32 v84, v56, v57
  v_cvt_pk_bf16_f32 v85, v58, v59
  v_cvt_pk_bf16_f32 v86, v60, v61
  v_cvt_pk_bf16_f32 v87, v62, v63
  v_mfma_f32_32x32x16_bf16 v[48:63], a[84:87], v[16:19], v[32:47]
  v_exp_f32 v64, v64
  v_exp_f32 v65, v65
  v_exp_f32 v66, v66
  v_exp_f32 v67, v67
  v_mfma_f32_32x32x16_bf16 v[96:111], a[196:199], v[84:87], v[96:111]
  v_exp_f32 v68, v68
  v_exp_f32 v69, v69
  v_exp_f32 v70, v70
  v_exp_f32 v71, v71
  v_cvt_pk_bf16_f32 v80, v64, v65
  v_cvt_pk_bf16_f32 v81, v66, v67
  v_mfma_f32_32x32x8_bf16 v[48:63], a[88:89], v[20:21], v[48:63]
  v_exp_f32 v72, v72
  v_cvt_pk_bf16_f32 v82, v68, v69
  v_exp_f32 v73, v73
  v_cvt_pk_bf16_f32 v83, v70, v71
  v_exp_f32 v74, v74
  v_exp_f32 v75, v75
  v_mfma_f32_32x32x16_bf16 v[96:111], a[200:203], v[80:83], v[96:111]
  v_exp_f32 v76, v76
  v_exp_f32 v77, v77
  v_exp_f32 v78, v78
  v_exp_f32 v79, v79
  v_cvt_pk_bf16_f32 v84, v72, v73
  v_cvt_pk_bf16_f32 v85, v74, v75
  v_cvt_pk_bf16_f32 v86, v76, v77
  v_cvt_pk_bf16_f32 v87, v78, v79
  v_mfma_f32_32x32x16_bf16 v[64:79], a[90:93], v[16:19], v[32:47]
  v_exp_f32 v48, v48
  v_exp_f32 v49, v49
  v_exp_f32 v50, v50
  v_exp_f32 v51, v51
  v_mfma_f32_32x32x16_bf16 v[96:111], a[204:207], v[84:87], v[96:111]
  v_exp_f32 v52, v52
  v_exp_f32 v53, v53
  v_exp_f32 v54, v54
  v_exp_f32 v55, v55
  v_cvt_pk_bf16_f32 v80, v48, v49
  v_cvt_pk_bf16_f32 v81, v50, v51
  v_mfma_f32_32x32x8_bf16 v[64:79], a[94:95], v[20:21], v[64:79]
  v_exp_f32 v56, v56
  v_cvt_pk_bf16_f32 v82, v52, v53
  v_exp_f32 v57, v57
  v_cvt_pk_bf16_f32 v83, v54, v55
  v_exp_f32 v58, v58
  v_exp_f32 v59, v59
  v_mfma_f32_32x32x16_bf16 v[96:111], a[208:211], v[80:83], v[96:111]
  v_exp_f32 v60, v60
  v_exp_f32 v61, v61
  v_exp_f32 v62, v62
  v_exp_f32 v63, v63
  v_cvt_pk_bf16_f32 v84, v56, v57
  v_cvt_pk_bf16_f32 v85, v58, v59
  v_cvt_pk_bf16_f32 v86, v60, v61
  v_cvt_pk_bf16_f32 v87, v62, v63
  v_exp_f32 v64, v64
  v_exp_f32 v65, v65
  v_exp_f32 v66, v66
  v_exp_f32 v67, v67
  v_mfma_f32_32x32x16_bf16 v[96:111], a[212:215], v[84:87], v[96:111]
  v_exp_f32 v68, v68
  v_exp_f32 v69, v69
  v_exp_f32 v70, v70
  v_exp_f32 v71, v71
  v_cvt_pk_bf16_f32 v80, v64, v65
  v_cvt_pk_bf16_f32 v81, v66, v67
  v_exp_f32 v72, v72
  v_cvt_pk_bf16_f32 v82, v68, v69
  v_exp_f32 v73, v73
  v_cvt_pk_bf16_f32 v83, v70, v71
  v_exp_f32 v74, v74
  v_exp_f32 v75, v75
  v_mfma_f32_32x32x16_bf16 v[96:111], a[216:219], v[80:83], v[96:111]
  v_exp_f32 v76, v76
  v_exp_f32 v77, v77
  v_exp_f32 v78, v78
  v_exp_f32 v79, v79
  v_cvt_pk_bf16_f32 v84, v72, v73
  v_cvt_pk_bf16_f32 v85, v74, v75
  v_cvt_pk_bf16_f32 v86, v76, v77
  v_cvt_pk_bf16_f32 v87, v78, v79
  s_nop 1
  v_mfma_f32_32x32x16_bf16 v[96:111], a[220:223], v[84:87], v[96:111]
  s_nop 11
  ds_write_b128 v11, v[96:99] offset:0
  ds_write_b128 v11, v[100:103] offset:1024
  ds_write_b128 v11, v[104:107] offset:2048
  v_add_u32 v11, 12288, v11
  s_add_u32 s34, s34, 1
  s_cmp_lt_u32 s34, 4
  s_cbranch_scc1 L_aT
  s_mov_b32 s34, 0
  s_lshl_b32 s38, s37, 2
  v_add_u32 v12, s38, v1
  v_add_u32 v13, s38, v8
  s_waitcnt lgkmcnt(0)
  s_barrier
  ds_read_b32 v80, v13 offset:2560
  ds_read_b128 v[112:115], v12 offset:0
  ds_read_b128 v[116:119], v12 offset:1024
  ds_read_b128 v[120:123], v12 offset:2048
  ds_read_b32 v81, v13 offset:5632
  ds_read_b128 v[124:127], v12 offset:3072
  ds_read_b128 v[128:131], v12 offset:4096
  ds_read_b128 v[132:135], v12 offset:5120
  ds_read_b32 v82, v13 offset:8704
  ds_read_b128 v[136:139], v12 offset:6144
  ds_read_b128 v[140:143], v12 offset:7168
  ds_read_b128 v[144:147], v12 offset:8192
  ds_read_b32 v83, v13 offset:11776
  ds_read_b128 v[148:151], v12 offset:9216
  ds_read_b128 v[152:155], v12 offset:10240
  ds_read_b128 v[156:159], v12 offset:11264
  v_lshlrev_b32 v10, 16, v10
  v_mul_f32 v10, 0xbfb8aa3b, v10
  v_exp_f32 v10, v10
  s_waitcnt lgkmcnt(0)
  v_add_f32 v80, v80, v81
  v_add_f32 v82, v82, v83
  v_add_f32 v10, 1.0, v10
  v_add_f32 v80, v80, v82
  v_rcp_f32 v10, v10
  v_rcp_f32 v81, v80
  v_subrev_u32 v80, 0x21800000, v80
  v_cmp_le_u32 vcc, 0x3c000000, v80
  v_mul_f32 v10, v10, v81
  s_or_b32 s38, vcc_lo, vcc_hi
  v_mov_b32 v12, s38
  s_lshl_b32 s39, s28, 2
  v_mov_b32 v13, s39
  ds_write_b32 v13, v12 offset:53248
  v_mov_b32 v13, 0
  v_add_f32 v112, v112, v124
  v_add_f32 v113, v113, v125
  v_add_f32 v114, v114, v126
  v_add_f32 v115, v115, v127
  v_add_f32 v116, v116, v128
  v_add_f32 v117, v117, v129
  v_add_f32 v118, v118, v130
  v_add_f32 v119, v119, v131
  v_add_f32 v120, v120, v132
  v_add_f32 v121, v121, v133
  v_add_f32 v122, v122, v134
  v_add_f32 v123, v123, v135
  v_add_f32 v112, v112, v136
  v_add_f32 v113, v113, v137
  v_add_f32 v114, v114, v138
  v_add_f32 v115, v115, v139
  v_add_f32 v116, v116, v140
  v_add_f32 v117, v117, v141
  v_add_f32 v118, v118, v142
  v_add_f32 v119, v119, v143
  v_add_f32 v120, v120, v144
  v_add_f32 v121, v121, v145
  v_add_f32 v122, v122, v146
  v_add_f32 v123, v123, v147
  v_add_f32 v112, v112, v148
  v_add_f32 v113, v113, v149
  v_add_f32 v114, v114, v150
  v_add_f32 v115, v115, v151
  v_add_f32 v116, v116, v152
  v_add_f32 v117, v117, v153
  v_add_f32 v118, v118, v154
  v_add_f32 v119, v119, v155
  v_add_f32 v120, v120, v156
  v_add_f32 v121, v121, v157
  v_add_f32 v122, v122, v158
  v_add_f32 v123, v123, v159
  s_waitcnt lgkmcnt(0)
  s_barrier
  ds_read_b128 v[80:83], v13 offset:53248
  v_mul_f32 v112, v112, v10
  v_mul_f32 v113, v113, v10
  v_mul_f32 v114, v114, v10
  v_mul_f32 v115, v115, v10
  v_mul_f32 v116, v116, v10
  v_mul_f32 v117, v117, v10
  v_mul_f32 v118, v118, v10
  v_mul_f32 v119, v119, v10
  v_mul_f32 v120, v120, v10
  v_mul_f32 v121, v121, v10
  v_mul_f32 v122, v122, v10
  v_mul_f32 v123, v123, v10
  v_cvt_pk_bf16_f32 v112, v112, v113
  v_cvt_pk_bf16_f32 v113, v114, v115
  v_cvt_pk_bf16_f32 v114, v116, v117
  v_cvt_pk_bf16_f32 v115, v118, v119
  v_cvt_pk_bf16_f32 v116, v120, v121
  v_cvt_pk_bf16_f32 v117, v122, v123
  s_waitcnt lgkmcnt(0)
  v_or3_b32 v80, v80, v81, v82
  v_or_b32 v80, v80, v83
  s_nop 0
  v_readfirstlane_b32 s38, v80
  s_cmp_lg_u32 s35, 0
  s_cselect_b32 s38, 0, s38
  s_cmp_lg_u32 s38, 0
  s_cbranch_scc1 L_aS
  s_add_u32 s38, s32, s28
  s_mul_i32 s38, s38, 1280
  s_add_u32 s38, s38, 8388608
  buffer_store_dwordx2 v[112:113], v6, s[4:7], s38 offen sc1
  buffer_store_dwordx2 v[114:115], v6, s[4:7], s38 offen offset:16 sc1
  buffer_store_dwordx2 v[116:117], v5, s[4:7], s38 offen sc1
  s_add_u32 s32, s32, 4
  s_sub_u32 s33, s33, 1
  s_cmp_lg_u32 s33, 0
  s_cbranch_scc1 L_aI
  s_branch L_aE
L_aS:
  s_waitcnt vmcnt(0)
  s_mul_i32 s36, s32, 1280
  s_add_u32 s36, s36, 4194304
  s_mov_b32 s34, 0
  buffer_load_dwordx4 v[24:27], v4, s[4:7], s36 offen
  buffer_load_dwordx2 v[28:29], v5, s[4:7], s36 offen
  s_add_u32 s36, s36, 1280
  s_lshl_b32 s38, s28, 8
  v_add_u32 v11, s38, v9
L_aM:
  s_waitcnt vmcnt(0)
  v_mov_b32 v16, v24
  v_mov_b32 v17, v25
  v_mov_b32 v18, v26
  v_mov_b32 v19, v27
  v_mov_b32 v20, v28
  v_mov_b32 v21, v29
  buffer_load_dwordx4 v[24:27], v4, s[4:7], s36 offen
  buffer_load_dwordx2 v[28:29], v5, s[4:7], s36 offen
  s_add_u32 s36, s36, 1280
  v_mfma_f32_32x32x16_bf16 v[48:63], a[0:3], v[16:19], 0
  s_nop 9
  v_mfma_f32_32x32x8_bf16 v[48:63], a[4:5], v[20:21], v[48:63]
  s_nop 11
  v_mov_b32 v12, v48
  v_max3_f32 v12, v12, v48, v49
  v_max3_f32 v12, v12, v50, v51
  v_max3_f32 v12, v12, v52, v53
  v_max3_f32 v12, v12, v54, v55
  v_max3_f32 v12, v12, v56, v57
  v_max3_f32 v12, v12, v58, v59
  v_max3_f32 v12, v12, v60, v61
  v_max3_f32 v12, v12, v62, v63
  v_mfma_f32_32x32x16_bf16 v[64:79], a[6:9], v[16:19], 0
  s_nop 9
  v_mfma_f32_32x32x8_bf16 v[64:79], a[10:11], v[20:21], v[64:79]
  s_nop 11
  v_max3_f32 v12, v12, v64, v65
  v_max3_f32 v12, v12, v66, v67
  v_max3_f32 v12, v12, v68, v69
  v_max3_f32 v12, v12, v70, v71
  v_max3_f32 v12, v12, v72, v73
  v_max3_f32 v12, v12, v74, v75
  v_max3_f32 v12, v12, v76, v77
  v_max3_f32 v12, v12, v78, v79
  v_mfma_f32_32x32x16_bf16 v[48:63], a[12:15], v[16:19], 0
  s_nop 9
  v_mfma_f32_32x32x8_bf16 v[48:63], a[16:17], v[20:21], v[48:63]
  s_nop 11
  v_max3_f32 v12, v12, v48, v49
  v_max3_f32 v12, v12, v50, v51
  v_max3_f32 v12, v12, v52, v53
  v_max3_f32 v12, v12, v54, v55
  v_max3_f32 v12, v12, v56, v57
  v_max3_f32 v12, v12, v58, v59
  v_max3_f32 v12, v12, v60, v61
  v_max3_f32 v12, v12, v62, v63
  v_mfma_f32_32x32x16_bf16 v[64:79], a[18:21], v[16:19], 0
  s_nop 9
  v_mfma_f32_32x32x8_bf16 v[64:79], a[22:23], v[20:21], v[64:79]
  s_nop 11
  v_max3_f32 v12, v12, v64, v65
  v_max3_f32 v12, v12, v66, v67
  v_max3_f32 v12, v12, v68, v69
  v_max3_f32 v12, v12, v70, v71
  v_max3_f32 v12, v12, v72, v73
  v_max3_f32 v12, v12, v74, v75
  v_max3_f32 v12, v12, v76, v77
  v_max3_f32 v12, v12, v78, v79
  v_mfma_f32_32x32x16_bf16 v[48:63], a[24:27], v[16:19], 0
  s_nop 9
  v_mfma_f32_32x32x8_bf16 v[48:63], a[28:29], v[20:21], v[48:63]
  s_nop 11
  v_max3_f32 v12, v12, v48, v49
  v_max3_f32 v12, v12, v50, v51
  v_max3_f32 v12, v12, v52, v53
  v_max3_f32 v12, v12, v54, v55
  v_max3_f32 v12, v12, v56, v57
  v_max3_f32 v12, v12, v58, v59
  v_max3_f32 v12, v12, v60, v61
  v_max3_f32 v12, v12, v62, v63
  v_mfma_f32_32x32x16_bf16 v[64:79], a[30:33], v[16:19], 0
  s_nop 9
  v_mfma_f32_32x32x8_bf16 v[64:79], a[34:35], v[20:21], v[64:79]
  s_nop 11
  v_max3_f32 v12, v12, v64, v65
  v_max3_f32 v12, v12, v66, v67
  v_max3_f32 v12, v12, v68, v69
  v_max3_f32 v12, v12, v70, v71
  v_max3_f32 v12, v12, v72, v73
  v_max3_f32 v12, v12, v74, v75
  v_max3_f32 v12, v12, v76, v77
  v_max3_f32 v12, v12, v78, v79
  v_mfma_f32_32x32x16_bf16 v[48:63], a[36:39], v[16:19], 0
  s_nop 9
  v_mfma_f32_32x32x8_bf16 v[48:63], a[40:41], v[20:21], v[48:63]
  s_nop 11
  v_max3_f32 v12, v12, v48, v49
  v_max3_f32 v12, v12, v50, v51
  v_max3_f32 v12, v12, v52, v53
  v_max3_f32 v12, v12, v54, v55
  v_max3_f32 v12, v12, v56, v57
  v_max3_f32 v12, v12, v58, v59
  v_max3_f32 v12, v12, v60, v61
  v_max3_f32 v12, v12, v62, v63
  v_mfma_f32_32x32x16_bf16 v[64:79], a[42:45], v[16:19], 0
  s_nop 9
  v_mfma_f32_32x32x8_bf16 v[64:79], a[46:47], v[20:21], v[64:79]
  s_nop 11
  v_max3_f32 v12, v12, v64, v65
  v_max3_f32 v12, v12, v66, v67
  v_max3_f32 v12, v12, v68, v69
  v_max3_f32 v12, v12, v70, v71
  v_max3_f32 v12, v12, v72, v73
  v_max3_f32 v12, v12, v74, v75
  v_max3_f32 v12, v12, v76, v77
  v_max3_f32 v12, v12, v78, v79
  v_mfma_f32_32x32x16_bf16 v[48:63], a[48:51], v[16:19], 0
  s_nop 9
  v_mfma_f32_32x32x8_bf16 v[48:63], a[52:53], v[20:21], v[48:63]
  s_nop 11
  v_max3_f32 v12, v12, v48, v49
  v_max3_f32 v12, v12, v50, v51
  v_max3_f32 v12, v12, v52, v53
  v_max3_f32 v12, v12, v54, v55
  v_max3_f32 v12, v12, v56, v57
  v_max3_f32 v12, v12, v58, v59
  v_max3_f32 v12, v12, v60, v61
  v_max3_f32 v12, v12, v62, v63
  v_mfma_f32_32x32x16_bf16 v[64:79], a[54:57], v[16:19], 0
  s_nop 9
  v_mfma_f32_32x32x8_bf16 v[64:79], a[58:59], v[20:21], v[64:79]
  s_nop 11
  v_max3_f32 v12, v12, v64, v65
  v_max3_f32 v12, v12, v66, v67
  v_max3_f32 v12, v12, v68, v69
  v_max3_f32 v12, v12, v70, v71
  v_max3_f32 v12, v12, v72, v73
  v_max3_f32 v12, v12, v74, v75
  v_max3_f32 v12, v12, v76, v77
  v_max3_f32 v12, v12, v78, v79
  v_mfma_f32_32x32x16_bf16 v[48:63], a[60:63], v[16:19], 0
  s_nop 9
  v_mfma_f32_32x32x8_bf16 v[48:63], a[64:65], v[20:21], v[48:63]
  s_nop 11
  v_max3_f32 v12, v12, v48, v49
  v_max3_f32 v12, v12, v50, v51
  v_max3_f32 v12, v12, v52, v53
  v_max3_f32 v12, v12, v54, v55
  v_max3_f32 v12, v12, v56, v57
  v_max3_f32 v12, v12, v58, v59
  v_max3_f32 v12, v12, v60, v61
  v_max3_f32 v12, v12, v62, v63
  v_mfma_f32_32x32x16_bf16 v[64:79], a[66:69], v[16:19], 0
  s_nop 9
  v_mfma_f32_32x32x8_bf16 v[64:79], a[70:71], v[20:21], v[64:79]
  s_nop 11
  v_max3_f32 v12, v12, v64, v65
  v_max3_f32 v12, v12, v66, v67
  v_max3_f32 v12, v12, v68, v69
  v_max3_f32 v12, v12, v70, v71
  v_max3_f32 v12, v12, v72, v73
  v_max3_f32 v12, v12, v74, v75
  v_max3_f32 v12, v12, v76, v77
  v_max3_f32 v12, v12, v78, v79
  v_mfma_f32_32x32x16_bf16 v[48:63], a[72:75], v[16:19], 0
  s_nop 9
  v_mfma_f32_32x32x8_bf16 v[48:63], a[76:77], v[20:21], v[48:63]
  s_nop 11
  v_max3_f32 v12, v12, v48, v49
  v_max3_f32 v12, v12, v50, v51
  v_max3_f32 v12, v12, v52, v53
  v_max3_f32 v12, v12, v54, v55
  v_max3_f32 v12, v12, v56, v57
  v_max3_f32 v12, v12, v58, v59
  v_max3_f32 v12, v12, v60, v61
  v_max3_f32 v12, v12, v62, v63
  v_mfma_f32_32x32x16_bf16 v[64:79], a[78:81], v[16:19], 0
  s_nop 9
  v_mfma_f32_32x32x8_bf16 v[64:79], a[82:83], v[20:21], v[64:79]
  s_nop 11
  v_max3_f32 v12, v12, v64, v65
  v_max3_f32 v12, v12, v66, v67
  v_max3_f32 v12, v12, v68, v69
  v_max3_f32 v12, v12, v70, v71
  v_max3_f32 v12, v12, v72, v73
  v_max3_f32 v12, v12, v74, v75
  v_max3_f32 v12, v12, v76, v77
  v_max3_f32 v12, v12, v78, v79
  v_mfma_f32_32x32x16_bf16 v[48:63], a[84:87], v[16:19], 0
  s_nop 9
  v_mfma_f32_32x32x8_bf16 v[48:63], a[88:89], v[20:21], v[48:63]
  s_nop 11
  v_max3_f32 v12, v12, v48, v49
  v_max3_f32 v12, v12, v50, v51
  v_max3_f32 v12, v12, v52, v53
  v_max3_f32 v12, v12, v54, v55
  v_max3_f32 v12, v12, v56, v57
  v_max3_f32 v12, v12, v58, v59
  v_max3_f32 v12, v12, v60, v61
  v_max3_f32 v12, v12, v62, v63
  v_mfma_f32_32x32x16_bf16 v[64:79], a[90:93], v[16:19], 0
  s_nop 9
  v_mfma_f32_32x32x8_bf16 v[64:79], a[94:95], v[20:21], v[64:79]
  s_nop 11
  v_max3_f32 v12, v12, v64, v65
  v_max3_f32 v12, v12, v66, v67
  v_max3_f32 v12, v12, v68, v69
  v_max3_f32 v12, v12, v70, v71
  v_max3_f32 v12, v12, v72, v73
  v_max3_f32 v12, v12, v74, v75
  v_max3_f32 v12, v12, v76, v77
  v_max3_f32 v12, v12, v78, v79
  ds_write_b32 v11, v12 offset:49152
  v_add_u32 v11, 1024, v11
  s_add_u32 s34, s34, 1
  s_cmp_lt_u32 s34, 4
  s_cbranch_scc1 L_aM
  s_waitcnt vmcnt(0) lgkmcnt(0)
  s_barrier
  s_mov_b32 s35, 1
  s_mul_i32 s36, s32, 1280
  s_add_u32 s36, s36, 4194304
  s_mov_b32 s34, 0
  buffer_load_dwordx4 v[24:27], v4, s[4:7], s36 offen
  buffer_load_dwordx2 v[28:29], v5, s[4:7], s36 offen
  s_add_u32 s36, s36, 1280
  s_branch L_aR
L_aE:
  s_waitcnt vmcnt(0)
  s_barrier
  v_mov_b32 v12, 1
  s_lshl_b32 s31, s29, 2
  s_add_u32 s31, s31, 13312
  s_mov_b64 exec, 1
  buffer_store_dword v12, off, s[4:7], s31 sc1
  s_mov_b64 exec, -1
  s_cmp_ge_u32 s29, 32
  s_cbranch_scc1 L_t2
  v_and_b32 v2, 15, v0
  v_lshrrev_b32 v3, 4, v0
  v_and_b32 v4, 1, v0
  v_lshl_add_u32 v4, v4, 4, 12
  v_mov_b32 v7, 0x3f80
  v_and_b32 v8, 2, v0
  v_cmp_eq_u32 vcc, 0, v8
  s_nop 1
  v_cndmask_b32 v7, 1.0, v7, vcc
  v_lshrrev_b32 v8, 2, v2
  v_cmp_eq_u32 vcc, v8, v3
  s_nop 1
  v_cndmask_b32 v244, 0, v7, vcc
  v_mov_b32 v245, 0
  v_mov_b32 v246, 0
  v_mov_b32 v247, v244
  v_lshlrev_b32 v5, 1, v2
  v_lshrrev_b32 v7, 2, v2
  v_lshlrev_b32 v6, 15, v7
  v_lshl_add_u32 v6, v3, 6, v6
  v_and_b32 v7, 3, v0
  v_lshl_add_u32 v6, v7, 4, v6
  v_lshlrev_b32 v3, 2, v3
  v_mov_b32 v8, 0xff7fffff
  v_mov_b32 v226, 0
  v_mov_b32 v227, 0
  s_mov_b32 s32, s28
  s_lshl_b32 s31, s28, 5
  s_add_u32 s31, s31, s29
  s_lshl_b32 s33, s31, 13
  s_add_u32 s33, s33, 33554432
  s_lshl_b32 s34, s31, 11
  s_add_u32 s34, s34, 16777216
  s_lshl_b32 s35, s31, 11
  s_add_u32 s35, s35, 26214400
  s_lshl_b32 s39, s31, 2
  s_add_u32 s39, s39, 8192
  s_lshl_b32 s36, s28, 6
  s_add_u32 s36, s36, 7557120
  s_lshl_b32 s37, s28, 18
  s_lshl_b32 s31, s29, 10
  s_add_u32 s37, s37, s31
  s_add_u32 s37, s37, 83886080
  s_lshl_b32 s38, s29, 7
  s_add_u32 s38, s38, 4096
  s_mov_b32 s40, 0x3e0293ee
  v_add_u32 v7, 0, v3
  v_cmp_le_u32 s[42:43], v7, v2
  v_add_u32 v7, 1, v3
  v_cmp_le_u32 s[44:45], v7, v2
  v_add_u32 v7, 2, v3
  v_cmp_le_u32 s[46:47], v7, v2
  v_add_u32 v7, 3, v3
  v_cmp_le_u32 s[48:49], v7, v2
  v_mov_b32 v233, 0
  v_mov_b32 v234, 0
  v_mov_b32 v237, 0
  v_mov_b32 v238, 0
L_t1:
  s_add_u32 s31, s33, 0
  buffer_load_dwordx4 v[16:19], v1, s[4:7], s31 offen offset:0
  buffer_load_dwordx4 v[20:23], v1, s[4:7], s31 offen offset:1024
  buffer_load_dwordx4 v[24:27], v1, s[4:7], s31 offen offset:2048
  buffer_load_dwordx4 v[28:31], v1, s[4:7], s31 offen offset:3072
  s_add_u32 s31, s33, 4096
  buffer_load_dwordx4 v[32:35], v1, s[4:7], s31 offen offset:0
  buffer_load_dwordx4 v[36:39], v1, s[4:7], s31 offen offset:1024
  buffer_load_dwordx4 v[40:43], v1, s[4:7], s31 offen offset:2048
  buffer_load_dwordx4 v[44:47], v1, s[4:7], s31 offen offset:3072
  s_add_u32 s31, s33, 16777216
  buffer_load_dwordx4 v[48:51], v1, s[4:7], s31 offen offset:0
  buffer_load_dwordx4 v[52:55], v1, s[4:7], s31 offen offset:1024
  buffer_load_dwordx4 v[56:59], v1, s[4:7], s31 offen offset:2048
  buffer_load_dwordx4 v[60:63], v1, s[4:7], s31 offen offset:3072
  s_add_u32 s31, s33, 16781312
  buffer_load_dwordx4 v[64:67], v1, s[4:7], s31 offen offset:0
  buffer_load_dwordx4 v[68:71], v1, s[4:7], s31 offen offset:1024
  buffer_load_dwordx4 v[72:75], v1, s[4:7], s31 offen offset:2048
  buffer_load_dwordx4 v[76:79], v1, s[4:7], s31 offen offset:3072
  s_add_u32 s31, s33, 33554432
  buffer_load_dwordx4 v[80:83], v1, s[4:7], s31 offen offset:0
  buffer_load_dwordx4 v[84:87], v1, s[4:7], s31 offen offset:1024
  buffer_load_dwordx4 v[88:91], v1, s[4:7], s31 offen offset:2048
  buffer_load_dwordx4 v[92:95], v1, s[4:7], s31 offen offset:3072
  s_add_u32 s31, s33, 33558528
  buffer_load_dwordx4 v[96:99], v1, s[4:7], s31 offen offset:0
  buffer_load_dwordx4 v[100:103], v1, s[4:7], s31 offen offset:1024
  buffer_load_dwordx4 v[104:107], v1, s[4:7], s31 offen offset:2048
  buffer_load_dwordx4 v[108:111], v1, s[4:7], s31 offen offset:3072
  buffer_load_ushort v240, v5, s[4:7], s36 offen offset:0
  buffer_load_ushort v241, v5, s[4:7], s36 offen offset:32
  s_waitcnt vmcnt(10)
  v_mfma_f32_16x16x32_bf16 v[136:139], v[48:51], v[16:19], 0
  v_mfma_f32_16x16x32_bf16 v[140:143], v[48:51], v[20:23], 0
  v_mfma_f32_16x16x32_bf16 v[144:147], v[52:55], v[20:23], 0
  v_mfma_f32_16x16x32_bf16 v[136:139], v[56:59], v[24:27], v[136:139]
  v_mfma_f32_16x16x32_bf16 v[140:143], v[56:59], v[28:31], v[140:143]
  v_mfma_f32_16x16x32_bf16 v[144:147], v[60:63], v[28:31], v[144:147]
  v_mfma_f32_16x16x32_bf16 v[136:139], v[64:67], v[32:35], v[136:139]
  v_mfma_f32_16x16x32_bf16 v[140:143], v[64:67], v[36:39], v[140:143]
  v_mfma_f32_16x16x32_bf16 v[144:147], v[68:71], v[36:39], v[144:147]
  v_mfma_f32_16x16x32_bf16 v[136:139], v[72:75], v[40:43], v[136:139]
  v_mfma_f32_16x16x32_bf16 v[140:143], v[72:75], v[44:47], v[140:143]
  v_mfma_f32_16x16x32_bf16 v[144:147], v[76:79], v[44:47], v[144:147]
wf_93:
  buffer_load_dword v7, v4, s[4:7], s38 offen offset:0 sc1
  s_waitcnt vmcnt(0)
  v_cmp_ge_u32 vcc, s32, v7
  s_cbranch_vccz wf_94
  s_sleep 2
  s_sub_u32 s30, s30, 1
  s_cbranch_scc0 wf_93
  s_mov_b32 s30, 0
wf_94:
  buffer_load_dwordx4 v[248:251], v1, s[4:7], s34 offen offset:0 sc1
  buffer_load_dwordx4 v[252:255], v1, s[4:7], s34 offen offset:1024 sc1
  buffer_load_dwordx4 v[128:131], v1, s[4:7], s35 offen offset:0 sc1
  buffer_load_dwordx4 v[132:135], v1, s[4:7], s35 offen offset:1024 sc1
  v_cndmask_b32 v136, v8, v136, s[42:43]
  v_cndmask_b32 v137, v8, v137, s[44:45]
  v_cndmask_b32 v138, v8, v138, s[46:47]
  v_cndmask_b32 v139, v8, v139, s[48:49]
  v_cndmask_b32 v144, v8, v144, s[42:43]
  v_cndmask_b32 v145, v8, v145, s[44:45]
  v_cndmask_b32 v146, v8, v146, s[46:47]
  v_cndmask_b32 v147, v8, v147, s[48:49]
  v_lshlrev_b32 v240, 16, v240
  v_mul_f32 v240, 0x3fb8aa3b, v240
  v_exp_f32 v240, v240
  v_lshlrev_b32 v241, 16, v241
  v_mul_f32 v241, 0x3fb8aa3b, v241
  v_exp_f32 v241, v241
  v_max3_f32 v10, v136, v137, v138
  v_max3_f32 v11, v140, v141, v142
  v_max_f32 v10, v10, v139
  v_max3_f32 v11, v11, v143, v144
  v_add_f32 v240, 1.0, v240
  v_max3_f32 v11, v11, v145, v146
  v_add_f32 v241, 1.0, v241
  v_max_f32 v11, v11, v147
  s_waitcnt vmcnt(2)
  v_mfma_f32_16x16x16_bf16 v[160:163], v[248:249], v[244:245], 0
  v_mfma_f32_16x16x16_bf16 v[164:167], v[248:249], v[246:247], 0
  v_mfma_f32_16x16x16_bf16 v[168:171], v[250:251], v[244:245], 0
  v_mfma_f32_16x16x16_bf16 v[172:175], v[250:251], v[246:247], 0
  v_mfma_f32_16x16x16_bf16 v[176:179], v[252:253], v[244:245], 0
  v_mfma_f32_16x16x16_bf16 v[180:183], v[252:253], v[246:247], 0
  v_mfma_f32_16x16x16_bf16 v[184:187], v[254:255], v[244:245], 0
  v_mfma_f32_16x16x16_bf16 v[188:191], v[254:255], v[246:247], 0
  v_cvt_pk_bf16_f32 v112, v160, v161
  v_cvt_pk_bf16_f32 v113, v162, v163
  v_cvt_pk_bf16_f32 v114, v164, v165
  v_cvt_pk_bf16_f32 v115, v166, v167
  v_cvt_pk_bf16_f32 v116, v168, v169
  v_cvt_pk_bf16_f32 v117, v170, v171
  v_cvt_pk_bf16_f32 v118, v172, v173
  v_cvt_pk_bf16_f32 v119, v174, v175
  v_cvt_pk_bf16_f32 v120, v176, v177
  v_cvt_pk_bf16_f32 v121, v178, v179
  v_cvt_pk_bf16_f32 v122, v180, v181
  v_cvt_pk_bf16_f32 v123, v182, v183
  v_cvt_pk_bf16_f32 v124, v184, v185
  v_cvt_pk_bf16_f32 v125, v186, v187
  v_cvt_pk_bf16_f32 v126, v188, v189
  v_cvt_pk_bf16_f32 v127, v190, v191
  v_mfma_f32_16x16x32_bf16 v[148:151], v[112:115], v[16:19], 0
  v_mfma_f32_16x16x32_bf16 v[152:155], v[112:115], v[20:23], 0
  v_mfma_f32_16x16x32_bf16 v[148:151], v[116:119], v[24:27], v[148:151]
  v_mfma_f32_16x16x32_bf16 v[152:155], v[116:119], v[28:31], v[152:155]
  v_mfma_f32_16x16x32_bf16 v[148:151], v[120:123], v[32:35], v[148:151]
  v_mfma_f32_16x16x32_bf16 v[152:155], v[120:123], v[36:39], v[152:155]
  v_mfma_f32_16x16x32_bf16 v[148:151], v[124:127], v[40:43], v[148:151]
  v_mfma_f32_16x16x32_bf16 v[152:155], v[124:127], v[44:47], v[152:155]
  s_nop 3
  v_max3_f32 v10, v10, v148, v150
  s_nop 2
  v_max3_f32 v11, v11, v152, v154
  v_mov_b32 v12, v10
  v_mov_b32 v13, v11
  s_nop 0
  v_permlane16_swap_b32 v10, v12
  v_permlane16_swap_b32 v11, v13
  v_max_f32 v10, v10, v12
  v_max_f32 v11, v11, v13
  v_mov_b32 v12, v10
  v_mov_b32 v13, v11
  s_nop 0
  v_permlane32_swap_b32 v10, v12
  v_permlane32_swap_b32 v11, v13
  v_max_f32 v10, v10, v12
  v_max_f32 v11, v11, v13
  v_mul_f32 v10, s40, v10
  v_mul_f32 v11, s40, v11
  v_fma_f32 v136, v136, s40, -v10
  v_fma_f32 v137, v137, s40, -v10
  v_fma_f32 v138, v138, s40, -v10
  v_fma_f32 v139, v139, s40, -v10
  v_fma_f32 v148, v148, s40, -v10
  v_fma_f32 v150, v150, s40, -v10
  v_fma_f32 v140, v140, s40, -v11
  v_fma_f32 v141, v141, s40, -v11
  v_fma_f32 v142, v142, s40, -v11
  v_fma_f32 v143, v143, s40, -v11
  v_fma_f32 v144, v144, s40, -v11
  v_fma_f32 v145, v145, s40, -v11
  v_fma_f32 v146, v146, s40, -v11
  v_fma_f32 v147, v147, s40, -v11
  v_fma_f32 v152, v152, s40, -v11
  v_fma_f32 v154, v154, s40, -v11
  v_exp_f32 v136, v136
  v_exp_f32 v137, v137
  v_exp_f32 v138, v138
  v_exp_f32 v139, v139
  v_exp_f32 v148, v148
  v_exp_f32 v150, v150
  v_exp_f32 v140, v140
  v_exp_f32 v141, v141
  v_exp_f32 v142, v142
  v_exp_f32 v143, v143
  v_exp_f32 v144, v144
  v_exp_f32 v145, v145
  v_exp_f32 v146, v146
  v_exp_f32 v147, v147
  v_exp_f32 v152, v152
  v_exp_f32 v154, v154
  v_cvt_pk_bf16_f32 v224, v136, v137
  v_cvt_pk_bf16_f32 v225, v138, v139
  v_cvt_pk_bf16_f32 v228, v140, v141
  v_cvt_pk_bf16_f32 v229, v142, v143
  v_cvt_pk_bf16_f32 v230, v144, v145
  v_cvt_pk_bf16_f32 v231, v146, v147
  v_cvt_pk_bf16_f32 v232, v148, v150
  v_cvt_pk_bf16_f32 v235, v148, v150
  v_cvt_pk_bf16_f32 v236, v152, v154
  v_cvt_pk_bf16_f32 v239, v152, v154
  v_mfma_f32_16x16x32_bf16 v[160:163], v[80:83], v[224:227], 0
  v_mfma_f32_16x16x32_bf16 v[164:167], v[84:87], v[224:227], 0
  v_mfma_f32_16x16x32_bf16 v[168:171], v[88:91], v[224:227], 0
  v_mfma_f32_16x16x32_bf16 v[172:175], v[92:95], v[224:227], 0
  v_mfma_f32_16x16x32_bf16 v[176:179], v[96:99], v[224:227], 0
  v_mfma_f32_16x16x32_bf16 v[180:183], v[100:103], v[224:227], 0
  v_mfma_f32_16x16x32_bf16 v[184:187], v[104:107], v[224:227], 0
  v_mfma_f32_16x16x32_bf16 v[188:191], v[108:111], v[224:227], 0
  v_add_f32 v10, v136, v137
  v_add_f32 v10, v10, v138
  v_add_f32 v10, v10, v139
  v_add_f32 v10, v10, v148
  v_add_f32 v10, v10, v150
  v_mfma_f32_16x16x32_bf16 v[192:195], v[80:83], v[228:231], 0
  v_mfma_f32_16x16x32_bf16 v[196:199], v[84:87], v[228:231], 0
  v_mfma_f32_16x16x32_bf16 v[200:203], v[88:91], v[228:231], 0
  v_mfma_f32_16x16x32_bf16 v[204:207], v[92:95], v[228:231], 0
  v_mfma_f32_16x16x32_bf16 v[208:211], v[96:99], v[228:231], 0
  v_mfma_f32_16x16x32_bf16 v[212:215], v[100:103], v[228:231], 0
  v_mfma_f32_16x16x32_bf16 v[216:219], v[104:107], v[228:231], 0
  v_mfma_f32_16x16x32_bf16 v[220:223], v[108:111], v[228:231], 0
  v_add_f32 v11, v140, v141
  v_add_f32 v11, v11, v142
  v_add_f32 v11, v11, v143
  v_add_f32 v11, v11, v144
  v_add_f32 v11, v11, v145
  v_add_f32 v11, v11, v146
  v_add_f32 v11, v11, v147
  v_add_f32 v11, v11, v152
  v_add_f32 v11, v11, v154
  s_waitcnt vmcnt(0)
  v_mfma_f32_16x16x16_bf16 v[160:163], v[128:129], v[232:233], v[160:163]
  v_mfma_f32_16x16x16_bf16 v[164:167], v[128:129], v[234:235], v[164:167]
  v_mfma_f32_16x16x16_bf16 v[168:171], v[130:131], v[232:233], v[168:171]
  v_mfma_f32_16x16x16_bf16 v[172:175], v[130:131], v[234:235], v[172:175]
  v_mfma_f32_16x16x16_bf16 v[176:179], v[132:133], v[232:233], v[176:179]
  v_mfma_f32_16x16x16_bf16 v[180:183], v[132:133], v[234:235], v[180:183]
  v_mfma_f32_16x16x16_bf16 v[184:187], v[134:135], v[232:233], v[184:187]
  v_mfma_f32_16x16x16_bf16 v[188:191], v[134:135], v[234:235], v[188:191]
  v_mov_b32 v12, v10
  v_mov_b32 v13, v11
  s_nop 0
  v_permlane16_swap_b32 v10, v12
  v_permlane16_swap_b32 v11, v13
  v_add_f32 v10, v10, v12
  v_add_f32 v11, v11, v13
  v_mov_b32 v12, v10
  v_mov_b32 v13, v11
  s_nop 0
  v_permlane32_swap_b32 v10, v12
  v_permlane32_swap_b32 v11, v13
  v_add_f32 v10, v10, v12
  v_add_f32 v11, v11, v13
  v_mul_f32 v10, v10, v240
  v_mul_f32 v11, v11, v241
  v_rcp_f32 v10, v10
  v_rcp_f32 v11, v11
  v_mfma_f32_16x16x16_bf16 v[192:195], v[128:129], v[236:237], v[192:195]
  v_mfma_f32_16x16x16_bf16 v[196:199], v[128:129], v[238:239], v[196:199]
  v_mfma_f32_16x16x16_bf16 v[200:203], v[130:131], v[236:237], v[200:203]
  v_mfma_f32_16x16x16_bf16 v[204:207], v[130:131], v[238:239], v[204:207]
  v_mfma_f32_16x16x16_bf16 v[208:211], v[132:133], v[236:237], v[208:211]
  v_mfma_f32_16x16x16_bf16 v[212:215], v[132:133], v[238:239], v[212:215]
  v_mfma_f32_16x16x16_bf16 v[216:219], v[134:135], v[236:237], v[216:219]
  v_mfma_f32_16x16x16_bf16 v[220:223], v[134:135], v[238:239], v[220:223]
  v_mul_f32 v160, v160, v10
  v_mul_f32 v161, v161, v10
  v_mul_f32 v162, v162, v10
  v_mul_f32 v163, v163, v10
  v_mul_f32 v164, v164, v10
  v_mul_f32 v165, v165, v10
  v_mul_f32 v166, v166, v10
  v_mul_f32 v167, v167, v10
  v_cvt_pk_bf16_f32 v160, v160, v161
  v_cvt_pk_bf16_f32 v161, v162, v163
  v_cvt_pk_bf16_f32 v162, v164, v165
  v_cvt_pk_bf16_f32 v163, v166, v167
  buffer_store_dwordx4 v[160:163], v6, s[4:7], s37 offen offset:0 sc1
  v_mul_f32 v168, v168, v10
  v_mul_f32 v169, v169, v10
  v_mul_f32 v170, v170, v10
  v_mul_f32 v171, v171, v10
  v_mul_f32 v172, v172, v10
  v_mul_f32 v173, v173, v10
  v_mul_f32 v174, v174, v10
  v_mul_f32 v175, v175, v10
  v_cvt_pk_bf16_f32 v168, v168, v169
  v_cvt_pk_bf16_f32 v169, v170, v171
  v_cvt_pk_bf16_f32 v170, v172, v173
  v_cvt_pk_bf16_f32 v171, v174, v175
  buffer_store_dwordx4 v[168:171], v6, s[4:7], s37 offen offset:256 sc1
  v_mul_f32 v176, v176, v10
  v_mul_f32 v177, v177, v10
  v_mul_f32 v178, v178, v10
  v_mul_f32 v179, v179, v10
  v_mul_f32 v180, v180, v10
  v_mul_f32 v181, v181, v10
  v_mul_f32 v182, v182, v10
  v_mul_f32 v183, v183, v10
  v_cvt_pk_bf16_f32 v176, v176, v177
  v_cvt_pk_bf16_f32 v177, v178, v179
  v_cvt_pk_bf16_f32 v178, v180, v181
  v_cvt_pk_bf16_f32 v179, v182, v183
  buffer_store_dwordx4 v[176:179], v6, s[4:7], s37 offen offset:512 sc1
  v_mul_f32 v184, v184, v10
  v_mul_f32 v185, v185, v10
  v_mul_f32 v186, v186, v10
  v_mul_f32 v187, v187, v10
  v_mul_f32 v188, v188, v10
  v_mul_f32 v189, v189, v10
  v_mul_f32 v190, v190, v10
  v_mul_f32 v191, v191, v10
  v_cvt_pk_bf16_f32 v184, v184, v185
  v_cvt_pk_bf16_f32 v185, v186, v187
  v_cvt_pk_bf16_f32 v186, v188, v189
  v_cvt_pk_bf16_f32 v187, v190, v191
  buffer_store_dwordx4 v[184:187], v6, s[4:7], s37 offen offset:768 sc1
  s_add_u32 s37, s37, 131072
  v_mul_f32 v192, v192, v11
  v_mul_f32 v193, v193, v11
  v_mul_f32 v194, v194, v11
  v_mul_f32 v195, v195, v11
  v_mul_f32 v196, v196, v11
  v_mul_f32 v197, v197, v11
  v_mul_f32 v198, v198, v11
  v_mul_f32 v199, v199, v11
  v_cvt_pk_bf16_f32 v192, v192, v193
  v_cvt_pk_bf16_f32 v193, v194, v195
  v_cvt_pk_bf16_f32 v194, v196, v197
  v_cvt_pk_bf16_f32 v195, v198, v199
  buffer_store_dwordx4 v[192:195], v6, s[4:7], s37 offen offset:0 sc1
  v_mul_f32 v200, v200, v11
  v_mul_f32 v201, v201, v11
  v_mul_f32 v202, v202, v11
  v_mul_f32 v203, v203, v11
  v_mul_f32 v204, v204, v11
  v_mul_f32 v205, v205, v11
  v_mul_f32 v206, v206, v11
  v_mul_f32 v207, v207, v11
  v_cvt_pk_bf16_f32 v200, v200, v201
  v_cvt_pk_bf16_f32 v201, v202, v203
  v_cvt_pk_bf16_f32 v202, v204, v205
  v_cvt_pk_bf16_f32 v203, v206, v207
  buffer_store_dwordx4 v[200:203], v6, s[4:7], s37 offen offset:256 sc1
  v_mul_f32 v208, v208, v11
  v_mul_f32 v209, v209, v11
  v_mul_f32 v210, v210, v11
  v_mul_f32 v211, v211, v11
  v_mul_f32 v212, v212, v11
  v_mul_f32 v213, v213, v11
  v_mul_f32 v214, v214, v11
  v_mul_f32 v215, v215, v11
  v_cvt_pk_bf16_f32 v208, v208, v209
  v_cvt_pk_bf16_f32 v209, v210, v211
  v_cvt_pk_bf16_f32 v210, v212, v213
  v_cvt_pk_bf16_f32 v211, v214, v215
  buffer_store_dwordx4 v[208:211], v6, s[4:7], s37 offen offset:512 sc1
  v_mul_f32 v216, v216, v11
  v_mul_f32 v217, v217, v11
  v_mul_f32 v218, v218, v11
  v_mul_f32 v219, v219, v11
  v_mul_f32 v220, v220, v11
  v_mul_f32 v221, v221, v11
  v_mul_f32 v222, v222, v11
  v_mul_f32 v223, v223, v11
  v_cvt_pk_bf16_f32 v216, v216, v217
  v_cvt_pk_bf16_f32 v217, v218, v219
  v_cvt_pk_bf16_f32 v218, v220, v221
  v_cvt_pk_bf16_f32 v219, v222, v223
  buffer_store_dwordx4 v[216:219], v6, s[4:7], s37 offen offset:768 sc1
  s_add_u32 s37, s37, 917504
  s_add_u32 s32, s32, 4
  v_mov_b32 v7, s32
  s_add_u32 s33, s33, 1048576
  s_add_u32 s34, s34, 262144
  s_add_u32 s35, s35, 262144
  s_add_u32 s36, s36, 256
  s_waitcnt vmcnt(0)
  s_mov_b64 exec, 1
  buffer_store_dword v7, off, s[4:7], s39 sc1
  s_mov_b64 exec, -1
  s_cmp_lt_u32 s32, 64
  s_cbranch_scc1 L_t1
  s_endpgm
L_t2:
  s_mov_b32 s12, s84
  s_mov_b32 s13, s85
  s_mov_b32 s14, 5242880
  s_mov_b32 s15, 0x20000
  s_mov_b32 s16, s72
  s_mov_b32 s17, s73
  s_mov_b32 s18, 819200
  s_mov_b32 s19, 0x20000
  s_mov_b32 s24, s90
  s_mov_b32 s25, s91
  s_mov_b32 s26, 2621440
  s_mov_b32 s27, 0x20000
  s_sub_u32 s31, s29, 32
  s_mul_i32 s33, s31, 3277
  s_lshr_b32 s33, s33, 16
  s_mul_i32 s32, s33, 20
  s_sub_u32 s32, s31, s32
  s_lshl_b32 s32, s32, 6
  s_mul_i32 s34, s28, 40960
  s_mul_i32 s35, s28, 1310720
  s_add_u32 s35, s35, s32
  s_mul_i32 s36, s28, 204800
  s_add_u32 s36, s36, s32
  v_lshrrev_b32 v2, 2, v0
  v_and_b32 v3, 3, v0
  v_mul_u32_u24 v4, 1280, v2
  v_lshl_add_u32 v4, v3, 4, v4
  v_add_u32 v5, s34, v1
  v_lshrrev_b32 v12, 4, v0
  v_lshl_add_u32 v6, v12, 8, v5
  v_and_b32 v10, 3, v2
  v_lshlrev_b32 v7, 18, v10
  v_lshl_add_u32 v7, v12, 6, v7
  v_lshl_add_u32 v7, v3, 4, v7
  v_lshl_add_u32 v2, v10, 5, v3
  v_mul_u32_u24 v2, 1280, v2
  v_lshl_add_u32 v8, v12, 4, v2
  v_lshlrev_b32 v11, 3, v0
  s_add_u32 m0, s34, 0
  s_add_u32 s31, s35, 0
  buffer_load_dwordx4 v4, s[12:15], s31 offen lds
  s_add_u32 m0, s34, 1024
  s_add_u32 s31, s35, 20480
  buffer_load_dwordx4 v4, s[12:15], s31 offen lds
  s_add_u32 m0, s34, 2048
  s_add_u32 s31, s35, 40960
  buffer_load_dwordx4 v4, s[12:15], s31 offen lds
  s_add_u32 m0, s34, 3072
  s_add_u32 s31, s35, 61440
  buffer_load_dwordx4 v4, s[12:15], s31 offen lds
  s_add_u32 m0, s34, 4096
  s_add_u32 s31, s35, 81920
  buffer_load_dwordx4 v4, s[12:15], s31 offen lds
  s_add_u32 m0, s34, 5120
  s_add_u32 s31, s35, 102400
  buffer_load_dwordx4 v4, s[12:15], s31 offen lds
  s_add_u32 m0, s34, 6144
  s_add_u32 s31, s35, 122880
  buffer_load_dwordx4 v4, s[12:15], s31 offen lds
  s_add_u32 m0, s34, 7168
  s_add_u32 s31, s35, 143360
  buffer_load_dwordx4 v4, s[12:15], s31 offen lds
  s_add_u32 m0, s34, 8192
  s_add_u32 s31, s35, 163840
  buffer_load_dwordx4 v4, s[12:15], s31 offen lds
  s_add_u32 m0, s34, 9216
  s_add_u32 s31, s35, 184320
  buffer_load_dwordx4 v4, s[12:15], s31 offen lds
  s_add_u32 m0, s34, 10240
  s_add_u32 s31, s35, 204800
  buffer_load_dwordx4 v4, s[12:15], s31 offen lds
  s_add_u32 m0, s34, 11264
  s_add_u32 s31, s35, 225280
  buffer_load_dwordx4 v4, s[12:15], s31 offen lds
  s_add_u32 m0, s34, 12288
  s_add_u32 s31, s35, 245760
  buffer_load_dwordx4 v4, s[12:15], s31 offen lds
  s_add_u32 m0, s34, 13312
  s_add_u32 s31, s35, 266240
  buffer_load_dwordx4 v4, s[12:15], s31 offen lds
  s_add_u32 m0, s34, 14336
  s_add_u32 s31, s35, 286720
  buffer_load_dwordx4 v4, s[12:15], s31 offen lds
  s_add_u32 m0, s34, 15360
  s_add_u32 s31, s35, 307200
  buffer_load_dwordx4 v4, s[12:15], s31 offen lds
  s_add_u32 m0, s34, 16384
  s_add_u32 s31, s35, 327680
  buffer_load_dwordx4 v4, s[12:15], s31 offen lds
  s_add_u32 m0, s34, 17408
  s_add_u32 s31, s35, 348160
  buffer_load_dwordx4 v4, s[12:15], s31 offen lds
  s_add_u32 m0, s34, 18432
  s_add_u32 s31, s35, 368640
  buffer_load_dwordx4 v4, s[12:15], s31 offen lds
  s_add_u32 m0, s34, 19456
  s_add_u32 s31, s35, 389120
  buffer_load_dwordx4 v4, s[12:15], s31 offen lds
  s_add_u32 m0, s34, 20480
  s_add_u32 s31, s35, 409600
  buffer_load_dwordx4 v4, s[12:15], s31 offen lds
  s_add_u32 m0, s34, 21504
  s_add_u32 s31, s35, 430080
  buffer_load_dwordx4 v4, s[12:15], s31 offen lds
  s_add_u32 m0, s34, 22528
  s_add_u32 s31, s35, 450560
  buffer_load_dwordx4 v4, s[12:15], s31 offen lds
  s_add_u32 m0, s34, 23552
  s_add_u32 s31, s35, 471040
  buffer_load_dwordx4 v4, s[12:15], s31 offen lds
  s_add_u32 m0, s34, 24576
  s_add_u32 s31, s35, 491520
  buffer_load_dwordx4 v4, s[12:15], s31 offen lds
  s_add_u32 m0, s34, 25600
  s_add_u32 s31, s35, 512000
  buffer_load_dwordx4 v4, s[12:15], s31 offen lds
  s_add_u32 m0, s34, 26624
  s_add_u32 s31, s35, 532480
  buffer_load_dwordx4 v4, s[12:15], s31 offen lds
  s_add_u32 m0, s34, 27648
  s_add_u32 s31, s35, 552960
  buffer_load_dwordx4 v4, s[12:15], s31 offen lds
  s_add_u32 m0, s34, 28672
  s_add_u32 s31, s35, 573440
  buffer_load_dwordx4 v4, s[12:15], s31 offen lds
  s_add_u32 m0, s34, 29696
  s_add_u32 s31, s35, 593920
  buffer_load_dwordx4 v4, s[12:15], s31 offen lds
  s_add_u32 m0, s34, 30720
  s_add_u32 s31, s35, 614400
  buffer_load_dwordx4 v4, s[12:15], s31 offen lds
  s_add_u32 m0, s34, 31744
  s_add_u32 s31, s35, 634880
  buffer_load_dwordx4 v4, s[12:15], s31 offen lds
  s_add_u32 m0, s34, 32768
  s_add_u32 s31, s35, 655360
  buffer_load_dwordx4 v4, s[12:15], s31 offen lds
  s_add_u32 m0, s34, 33792
  s_add_u32 s31, s35, 675840
  buffer_load_dwordx4 v4, s[12:15], s31 offen lds
  s_add_u32 m0, s34, 34816
  s_add_u32 s31, s35, 696320
  buffer_load_dwordx4 v4, s[12:15], s31 offen lds
  s_add_u32 m0, s34, 35840
  s_add_u32 s31, s35, 716800
  buffer_load_dwordx4 v4, s[12:15], s31 offen lds
  s_add_u32 m0, s34, 36864
  s_add_u32 s31, s35, 737280
  buffer_load_dwordx4 v4, s[12:15], s31 offen lds
  s_add_u32 m0, s34, 37888
  s_add_u32 s31, s35, 757760
  buffer_load_dwordx4 v4, s[12:15], s31 offen lds
  s_add_u32 m0, s34, 38912
  s_add_u32 s31, s35, 778240
  buffer_load_dwordx4 v4, s[12:15], s31 offen lds
  s_add_u32 m0, s34, 39936
  s_add_u32 s31, s35, 798720
  buffer_load_dwordx4 v4, s[12:15], s31 offen lds
  s_waitcnt vmcnt(38)
  ds_read_b64_tr_b16 a[0:1], v5 offset:0
  ds_read_b64_tr_b16 a[2:3], v5 offset:1024
  ds_read_b64_tr_b16 a[4:5], v5 offset:8
  ds_read_b64_tr_b16 a[6:7], v5 offset:1032
  s_waitcnt lgkmcnt(0)
  s_add_u32 m0, s34, 0
  s_add_u32 s31, s35, 819200
  buffer_load_dwordx4 v4, s[12:15], s31 offen lds
  s_add_u32 m0, s34, 1024
  s_add_u32 s31, s35, 839680
  buffer_load_dwordx4 v4, s[12:15], s31 offen lds
  s_waitcnt vmcnt(38)
  ds_read_b64_tr_b16 a[8:9], v5 offset:2048
  ds_read_b64_tr_b16 a[10:11], v5 offset:3072
  ds_read_b64_tr_b16 a[12:13], v5 offset:2056
  ds_read_b64_tr_b16 a[14:15], v5 offset:3080
  s_waitcnt lgkmcnt(0)
  s_add_u32 m0, s34, 2048
  s_add_u32 s31, s35, 860160
  buffer_load_dwordx4 v4, s[12:15], s31 offen lds
  s_add_u32 m0, s34, 3072
  s_add_u32 s31, s35, 880640
  buffer_load_dwordx4 v4, s[12:15], s31 offen lds
  s_waitcnt vmcnt(38)
  ds_read_b64_tr_b16 a[16:17], v5 offset:4096
  ds_read_b64_tr_b16 a[18:19], v5 offset:5120
  ds_read_b64_tr_b16 a[20:21], v5 offset:4104
  ds_read_b64_tr_b16 a[22:23], v5 offset:5128
  s_waitcnt lgkmcnt(0)
  s_add_u32 m0, s34, 4096
  s_add_u32 s31, s35, 901120
  buffer_load_dwordx4 v4, s[12:15], s31 offen lds
  s_add_u32 m0, s34, 5120
  s_add_u32 s31, s35, 921600
  buffer_load_dwordx4 v4, s[12:15], s31 offen lds
  s_waitcnt vmcnt(38)
  ds_read_b64_tr_b16 a[24:25], v5 offset:6144
  ds_read_b64_tr_b16 a[26:27], v5 offset:7168
  ds_read_b64_tr_b16 a[28:29], v5 offset:6152
  ds_read_b64_tr_b16 a[30:31], v5 offset:7176
  s_waitcnt lgkmcnt(0)
  s_add_u32 m0, s34, 6144
  s_add_u32 s31, s35, 942080
  buffer_load_dwordx4 v4, s[12:15], s31 offen lds
  s_add_u32 m0, s34, 7168
  s_add_u32 s31, s35, 962560
  buffer_load_dwordx4 v4, s[12:15], s31 offen lds
  s_waitcnt vmcnt(38)
  ds_read_b64_tr_b16 a[32:33], v5 offset:8192
  ds_read_b64_tr_b16 a[34:35], v5 offset:9216
  ds_read_b64_tr_b16 a[36:37], v5 offset:8200
  ds_read_b64_tr_b16 a[38:39], v5 offset:9224
  s_waitcnt lgkmcnt(0)
  s_add_u32 m0, s34, 8192
  s_add_u32 s31, s35, 983040
  buffer_load_dwordx4 v4, s[12:15], s31 offen lds
  s_add_u32 m0, s34, 9216
  s_add_u32 s31, s35, 1003520
  buffer_load_dwordx4 v4, s[12:15], s31 offen lds
  s_waitcnt vmcnt(38)
  ds_read_b64_tr_b16 a[40:41], v5 offset:10240
  ds_read_b64_tr_b16 a[42:43], v5 offset:11264
  ds_read_b64_tr_b16 a[44:45], v5 offset:10248
  ds_read_b64_tr_b16 a[46:47], v5 offset:11272
  s_waitcnt lgkmcnt(0)
  s_add_u32 m0, s34, 10240
  s_add_u32 s31, s35, 1024000
  buffer_load_dwordx4 v4, s[12:15], s31 offen lds
  s_add_u32 m0, s34, 11264
  s_add_u32 s31, s35, 1044480
  buffer_load_dwordx4 v4, s[12:15], s31 offen lds
  s_waitcnt vmcnt(38)
  ds_read_b64_tr_b16 a[48:49], v5 offset:12288
  ds_read_b64_tr_b16 a[50:51], v5 offset:13312
  ds_read_b64_tr_b16 a[52:53], v5 offset:12296
  ds_read_b64_tr_b16 a[54:55], v5 offset:13320
  s_waitcnt lgkmcnt(0)
  s_add_u32 m0, s34, 12288
  s_add_u32 s31, s35, 1064960
  buffer_load_dwordx4 v4, s[12:15], s31 offen lds
  s_add_u32 m0, s34, 13312
  s_add_u32 s31, s35, 1085440
  buffer_load_dwordx4 v4, s[12:15], s31 offen lds
  s_waitcnt vmcnt(38)
  ds_read_b64_tr_b16 a[56:57], v5 offset:14336
  ds_read_b64_tr_b16 a[58:59], v5 offset:15360
  ds_read_b64_tr_b16 a[60:61], v5 offset:14344
  ds_read_b64_tr_b16 a[62:63], v5 offset:15368
  s_waitcnt lgkmcnt(0)
  s_add_u32 m0, s34, 14336
  s_add_u32 s31, s35, 1105920
  buffer_load_dwordx4 v4, s[12:15], s31 offen lds
  s_add_u32 m0, s34, 15360
  s_add_u32 s31, s35, 1126400
  buffer_load_dwordx4 v4, s[12:15], s31 offen lds
  s_waitcnt vmcnt(38)
  ds_read_b64_tr_b16 a[64:65], v5 offset:16384
  ds_read_b64_tr_b16 a[66:67], v5 offset:17408
  ds_read_b64_tr_b16 a[68:69], v5 offset:16392
  ds_read_b64_tr_b16 a[70:71], v5 offset:17416
  s_waitcnt lgkmcnt(0)
  s_add_u32 m0, s34, 16384
  s_add_u32 s31, s35, 1146880
  buffer_load_dwordx4 v4, s[12:15], s31 offen lds
  s_add_u32 m0, s34, 17408
  s_add_u32 s31, s35, 1167360
  buffer_load_dwordx4 v4, s[12:15], s31 offen lds
  s_waitcnt vmcnt(38)
  ds_read_b64_tr_b16 a[72:73], v5 offset:18432
  ds_read_b64_tr_b16 a[74:75], v5 offset:19456
  ds_read_b64_tr_b16 a[76:77], v5 offset:18440
  ds_read_b64_tr_b16 a[78:79], v5 offset:19464
  s_waitcnt lgkmcnt(0)
  s_add_u32 m0, s34, 18432
  s_add_u32 s31, s35, 1187840
  buffer_load_dwordx4 v4, s[12:15], s31 offen lds
  s_add_u32 m0, s34, 19456
  s_add_u32 s31, s35, 1208320
  buffer_load_dwordx4 v4, s[12:15], s31 offen lds
  s_waitcnt vmcnt(38)
  ds_read_b64_tr_b16 a[80:81], v5 offset:20480
  ds_read_b64_tr_b16 a[82:83], v5 offset:21504
  ds_read_b64_tr_b16 a[84:85], v5 offset:20488
  ds_read_b64_tr_b16 a[86:87], v5 offset:21512
  s_waitcnt lgkmcnt(0)
  s_add_u32 m0, s34, 20480
  s_add_u32 s31, s35, 1228800
  buffer_load_dwordx4 v4, s[12:15], s31 offen lds
  s_add_u32 m0, s34, 21504
  s_add_u32 s31, s35, 1249280
  buffer_load_dwordx4 v4, s[12:15], s31 offen lds
  s_waitcnt vmcnt(38)
  ds_read_b64_tr_b16 a[88:89], v5 offset:22528
  ds_read_b64_tr_b16 a[90:91], v5 offset:23552
  ds_read_b64_tr_b16 a[92:93], v5 offset:22536
  ds_read_b64_tr_b16 a[94:95], v5 offset:23560
  s_waitcnt lgkmcnt(0)
  s_add_u32 m0, s34, 22528
  s_add_u32 s31, s35, 1269760
  buffer_load_dwordx4 v4, s[12:15], s31 offen lds
  s_add_u32 m0, s34, 23552
  s_add_u32 s31, s35, 1290240
  buffer_load_dwordx4 v4, s[12:15], s31 offen lds
  s_waitcnt vmcnt(38)
  ds_read_b64_tr_b16 a[96:97], v5 offset:24576
  ds_read_b64_tr_b16 a[98:99], v5 offset:25600
  ds_read_b64_tr_b16 a[100:101], v5 offset:24584
  ds_read_b64_tr_b16 a[102:103], v5 offset:25608
  s_waitcnt lgkmcnt(0)
  s_add_u32 m0, s34, 24576
  s_add_u32 s31, s36, 0
  buffer_load_dwordx4 v4, s[16:19], s31 offen lds
  s_add_u32 m0, s34, 25600
  s_add_u32 s31, s36, 20480
  buffer_load_dwordx4 v4, s[16:19], s31 offen lds
  s_waitcnt vmcnt(38)
  ds_read_b64_tr_b16 a[104:105], v5 offset:26624
  ds_read_b64_tr_b16 a[106:107], v5 offset:27648
  ds_read_b64_tr_b16 a[108:109], v5 offset:26632
  ds_read_b64_tr_b16 a[110:111], v5 offset:27656
  s_waitcnt lgkmcnt(0)
  s_add_u32 m0, s34, 26624
  s_add_u32 s31, s36, 40960
  buffer_load_dwordx4 v4, s[16:19], s31 offen lds
  s_add_u32 m0, s34, 27648
  s_add_u32 s31, s36, 61440
  buffer_load_dwordx4 v4, s[16:19], s31 offen lds
  s_waitcnt vmcnt(38)
  ds_read_b64_tr_b16 a[112:113], v5 offset:28672
  ds_read_b64_tr_b16 a[114:115], v5 offset:29696
  ds_read_b64_tr_b16 a[116:117], v5 offset:28680
  ds_read_b64_tr_b16 a[118:119], v5 offset:29704
  s_waitcnt lgkmcnt(0)
  s_add_u32 m0, s34, 28672
  s_add_u32 s31, s36, 81920
  buffer_load_dwordx4 v4, s[16:19], s31 offen lds
  s_add_u32 m0, s34, 29696
  s_add_u32 s31, s36, 102400
  buffer_load_dwordx4 v4, s[16:19], s31 offen lds
  s_waitcnt vmcnt(38)
  ds_read_b64_tr_b16 a[120:121], v5 offset:30720
  ds_read_b64_tr_b16 a[122:123], v5 offset:31744
  ds_read_b64_tr_b16 a[124:125], v5 offset:30728
  ds_read_b64_tr_b16 a[126:127], v5 offset:31752
  s_waitcnt lgkmcnt(0)
  s_add_u32 m0, s34, 30720
  s_add_u32 s31, s36, 122880
  buffer_load_dwordx4 v4, s[16:19], s31 offen lds
  s_add_u32 m0, s34, 31744
  s_add_u32 s31, s36, 143360
  buffer_load_dwordx4 v4, s[16:19], s31 offen lds
  s_waitcnt vmcnt(38)
  ds_read_b64_tr_b16 a[128:129], v5 offset:32768
  ds_read_b64_tr_b16 a[130:131], v5 offset:33792
  ds_read_b64_tr_b16 a[132:133], v5 offset:32776
  ds_read_b64_tr_b16 a[134:135], v5 offset:33800
  s_waitcnt lgkmcnt(0)
  s_add_u32 m0, s34, 32768
  s_add_u32 s31, s36, 163840
  buffer_load_dwordx4 v4, s[16:19], s31 offen lds
  s_add_u32 m0, s34, 33792
  s_add_u32 s31, s36, 184320
  buffer_load_dwordx4 v4, s[16:19], s31 offen lds
  s_waitcnt vmcnt(38)
  ds_read_b64_tr_b16 a[136:137], v5 offset:34816
  ds_read_b64_tr_b16 a[138:139], v5 offset:35840
  ds_read_b64_tr_b16 a[140:141], v5 offset:34824
  ds_read_b64_tr_b16 a[142:143], v5 offset:35848
  s_waitcnt vmcnt(36)
  ds_read_b64_tr_b16 a[144:145], v5 offset:36864
  ds_read_b64_tr_b16 a[146:147], v5 offset:37888
  ds_read_b64_tr_b16 a[148:149], v5 offset:36872
  ds_read_b64_tr_b16 a[150:151], v5 offset:37896
  s_waitcnt vmcnt(34)
  ds_read_b64_tr_b16 a[152:153], v5 offset:38912
  ds_read_b64_tr_b16 a[154:155], v5 offset:39936
  ds_read_b64_tr_b16 a[156:157], v5 offset:38920
  ds_read_b64_tr_b16 a[158:159], v5 offset:39944
  s_waitcnt vmcnt(32)
  ds_read_b64_tr_b16 a[160:161], v5 offset:0
  ds_read_b64_tr_b16 a[162:163], v5 offset:1024
  ds_read_b64_tr_b16 a[164:165], v5 offset:8
  ds_read_b64_tr_b16 a[166:167], v5 offset:1032
  s_waitcnt vmcnt(30)
  ds_read_b64_tr_b16 a[168:169], v5 offset:2048
  ds_read_b64_tr_b16 a[170:171], v5 offset:3072
  ds_read_b64_tr_b16 a[172:173], v5 offset:2056
  ds_read_b64_tr_b16 a[174:175], v5 offset:3080
  s_waitcnt vmcnt(28)
  ds_read_b64_tr_b16 a[176:177], v5 offset:4096
  ds_read_b64_tr_b16 a[178:179], v5 offset:5120
  ds_read_b64_tr_b16 a[180:181], v5 offset:4104
  ds_read_b64_tr_b16 a[182:183], v5 offset:5128
  s_waitcnt vmcnt(26)
  ds_read_b64_tr_b16 a[184:185], v5 offset:6144
  ds_read_b64_tr_b16 a[186:187], v5 offset:7168
  ds_read_b64_tr_b16 a[188:189], v5 offset:6152
  ds_read_b64_tr_b16 a[190:191], v5 offset:7176
  s_waitcnt vmcnt(24)
  ds_read_b64_tr_b16 a[192:193], v5 offset:8192
  ds_read_b64_tr_b16 a[194:195], v5 offset:9216
  ds_read_b64_tr_b16 a[196:197], v5 offset:8200
  ds_read_b64_tr_b16 a[198:199], v5 offset:9224
  s_waitcnt vmcnt(22)
  ds_read_b64_tr_b16 a[200:201], v5 offset:10240
  ds_read_b64_tr_b16 a[202:203], v5 offset:11264
  ds_read_b64_tr_b16 a[204:205], v5 offset:10248
  ds_read_b64_tr_b16 a[206:207], v5 offset:11272
  s_waitcnt vmcnt(20)
  ds_read_b64_tr_b16 a[208:209], v5 offset:12288
  ds_read_b64_tr_b16 a[210:211], v5 offset:13312
  ds_read_b64_tr_b16 a[212:213], v5 offset:12296
  ds_read_b64_tr_b16 a[214:215], v5 offset:13320
  s_waitcnt vmcnt(18)
  ds_read_b64_tr_b16 a[216:217], v5 offset:14336
  ds_read_b64_tr_b16 a[218:219], v5 offset:15360
  ds_read_b64_tr_b16 a[220:221], v5 offset:14344
  ds_read_b64_tr_b16 a[222:223], v5 offset:15368
  s_waitcnt vmcnt(16)
  ds_read_b64_tr_b16 a[224:225], v5 offset:16384
  ds_read_b64_tr_b16 a[226:227], v5 offset:17408
  ds_read_b64_tr_b16 a[228:229], v5 offset:16392
  ds_read_b64_tr_b16 a[230:231], v5 offset:17416
  s_waitcnt vmcnt(14)
  ds_read_b64_tr_b16 a[232:233], v5 offset:18432
  ds_read_b64_tr_b16 a[234:235], v5 offset:19456
  ds_read_b64_tr_b16 a[236:237], v5 offset:18440
  ds_read_b64_tr_b16 a[238:239], v5 offset:19464
  s_waitcnt vmcnt(12)
  ds_read_b64_tr_b16 a[240:241], v5 offset:20480
  ds_read_b64_tr_b16 a[242:243], v5 offset:21504
  ds_read_b64_tr_b16 a[244:245], v5 offset:20488
  ds_read_b64_tr_b16 a[246:247], v5 offset:21512
  s_waitcnt vmcnt(10)
  ds_read_b64_tr_b16 a[248:249], v5 offset:22528
  ds_read_b64_tr_b16 a[250:251], v5 offset:23552
  ds_read_b64_tr_b16 a[252:253], v5 offset:22536
  ds_read_b64_tr_b16 a[254:255], v5 offset:23560
  s_waitcnt vmcnt(8)
  ds_read_b64_tr_b16 v[16:17], v6 offset:24576
  ds_read_b64_tr_b16 v[18:19], v6 offset:24832
  ds_read_b64_tr_b16 v[20:21], v6 offset:24584
  ds_read_b64_tr_b16 v[22:23], v6 offset:24840
  s_waitcnt vmcnt(6)
  ds_read_b64_tr_b16 v[24:25], v6 offset:26624
  ds_read_b64_tr_b16 v[26:27], v6 offset:26880
  ds_read_b64_tr_b16 v[28:29], v6 offset:26632
  ds_read_b64_tr_b16 v[30:31], v6 offset:26888
  s_waitcnt vmcnt(4)
  ds_read_b64_tr_b16 v[32:33], v6 offset:28672
  ds_read_b64_tr_b16 v[34:35], v6 offset:28928
  ds_read_b64_tr_b16 v[36:37], v6 offset:28680
  ds_read_b64_tr_b16 v[38:39], v6 offset:28936
  s_waitcnt vmcnt(2)
  ds_read_b64_tr_b16 v[40:41], v6 offset:30720
  ds_read_b64_tr_b16 v[42:43], v6 offset:30976
  ds_read_b64_tr_b16 v[44:45], v6 offset:30728
  ds_read_b64_tr_b16 v[46:47], v6 offset:30984
  s_waitcnt vmcnt(0)
  ds_read_b64_tr_b16 v[48:49], v6 offset:32768
  ds_read_b64_tr_b16 v[50:51], v6 offset:33024
  ds_read_b64_tr_b16 v[52:53], v6 offset:32776
  ds_read_b64_tr_b16 v[54:55], v6 offset:33032
  v_lshlrev_b32 v2, 2, v0
  s_mov_b32 s31, 13312
wf_95:
  buffer_load_dword v56, v2, s[4:7], s31 offen offset:0 sc1
  buffer_load_dword v57, v2, s[4:7], s31 offen offset:256 sc1
  buffer_load_dword v58, v2, s[4:7], s31 offen offset:512 sc1
  s_waitcnt vmcnt(0)
  v_min_u32 v56, v56, v57
  v_min_u32 v56, v56, v58
  v_cmp_ge_u32 vcc, 0, v56
  s_cbranch_vccz wf_96
  s_sleep 4
  s_sub_u32 s30, s30, 1
  s_cbranch_scc0 wf_95
  s_mov_b32 s30, 0
wf_96:
  s_mov_b32 s37, 0
  s_lshl_b32 s39, s33, 15
  s_lshl_b32 s31, s28, 13
  s_add_u32 s39, s39, s31
  s_add_u32 s39, s39, 83886080
  s_mul_i32 s40, s33, 5120
  s_add_u32 s32, s32, s40
  s_mul_i32 s31, s28, 320
  s_add_u32 s40, s40, s31
  s_add_u32 s40, s40, 8388608
  s_lshl_b32 s31, s28, 11
  v_add_u32 v5, s31, v1
  v_mov_b32 v4, 0x7ff00000
  v_mov_b32 v6, 0
  s_mov_b32 s41, 8192
  s_waitcnt lgkmcnt(0)
  s_barrier
L_t2L:
  s_cmp_lg_u32 s28, 0
  s_cbranch_scc1 L_t2B
L_t2P:
  buffer_load_dwordx2 v[2:3], v11, s[4:7], s41 offen sc1
  s_mov_b32 s38, 0
  s_waitcnt vmcnt(0)
  v_min_u32 v2, v2, v3
  v_max_u32 v2, v2, v12
  v_subrev_u32 v2, s37, v2
  v_cmp_ge_u32 vcc, 0, v2
  s_cmp_eq_u64 vcc, 0
  s_addc_u32 s38, s38, 0
  v_cmp_ge_u32 vcc, 1, v2
  s_cmp_eq_u64 vcc, 0
  s_addc_u32 s38, s38, 0
  v_cmp_ge_u32 vcc, 2, v2
  s_cmp_eq_u64 vcc, 0
  s_addc_u32 s38, s38, 0
  v_cmp_ge_u32 vcc, 3, v2
  s_cmp_eq_u64 vcc, 0
  s_addc_u32 s38, s38, 0
  s_add_u32 s31, s37, s38
  s_cmp_eq_u32 s31, 64
  s_cbranch_scc1 L_t2G
  s_min_u32 s31, s31, 61
  s_sub_u32 s38, s31, s37
  s_cmp_lg_u32 s38, 0
  s_cbranch_scc1 L_t2G
  s_sleep 4
  s_sub_u32 s30, s30, 1
  s_cbranch_scc0 L_t2P
  s_mov_b32 s30, 0
  s_mov_b32 s38, 1
L_t2G:
  v_mov_b32 v2, s38
  ds_write_b32 v6, v2 offset:8192
  s_waitcnt lgkmcnt(0)
L_t2B:
  s_barrier
  ds_read_b32 v2, v6 offset:8192
  s_add_u32 s31, s39, 4096
  s_waitcnt lgkmcnt(0)
  v_cmp_gt_u32 vcc, v2, v10
  v_readfirstlane_b32 s38, v2
  s_nop 0
  v_cndmask_b32 v13, v4, v7, vcc
  v_cndmask_b32 v14, v4, v8, vcc
  buffer_load_dwordx4 v[56:59], v13, s[4:7], s39 offen offset:0
  buffer_load_dwordx4 v[60:63], v13, s[4:7], s39 offen offset:256
  buffer_load_dwordx4 v[64:67], v13, s[4:7], s39 offen offset:512
  buffer_load_dwordx4 v[68:71], v13, s[4:7], s39 offen offset:768
  buffer_load_dwordx4 v[72:75], v13, s[4:7], s39 offen offset:1024
  buffer_load_dwordx4 v[76:79], v13, s[4:7], s39 offen offset:1280
  buffer_load_dwordx4 v[80:83], v13, s[4:7], s39 offen offset:1536
  buffer_load_dwordx4 v[84:87], v13, s[4:7], s39 offen offset:1792
  buffer_load_dwordx4 v[88:91], v13, s[4:7], s39 offen offset:2048
  buffer_load_dwordx4 v[92:95], v13, s[4:7], s39 offen offset:2304
  buffer_load_dwordx4 v[96:99], v13, s[4:7], s39 offen offset:2560
  buffer_load_dwordx4 v[100:103], v13, s[4:7], s39 offen offset:2816
  buffer_load_dwordx4 v[104:107], v13, s[4:7], s39 offen offset:3072
  buffer_load_dwordx4 v[108:111], v13, s[4:7], s39 offen offset:3328
  buffer_load_dwordx4 v[112:115], v13, s[4:7], s39 offen offset:3584
  buffer_load_dwordx4 v[116:119], v13, s[4:7], s39 offen offset:3840
  buffer_load_dwordx4 v[120:123], v13, s[4:7], s31 offen offset:0
  buffer_load_dwordx4 v[124:127], v13, s[4:7], s31 offen offset:256
  buffer_load_dwordx4 v[128:131], v13, s[4:7], s31 offen offset:512
  buffer_load_dwordx4 v[132:135], v13, s[4:7], s31 offen offset:768
  buffer_load_dwordx4 v[136:139], v13, s[4:7], s31 offen offset:1024
  buffer_load_dwordx4 v[140:143], v13, s[4:7], s31 offen offset:1280
  buffer_load_dwordx4 v[144:147], v13, s[4:7], s31 offen offset:1536
  buffer_load_dwordx4 v[148:151], v13, s[4:7], s31 offen offset:1792
  buffer_load_dwordx4 v[152:155], v13, s[4:7], s31 offen offset:2048
  buffer_load_dwordx4 v[156:159], v13, s[4:7], s31 offen offset:2304
  buffer_load_dwordx4 v[160:163], v13, s[4:7], s31 offen offset:2560
  buffer_load_dwordx4 v[164:167], v13, s[4:7], s31 offen offset:2816
  buffer_load_dwordx4 v[168:171], v13, s[4:7], s31 offen offset:3072
  buffer_load_dwordx4 v[172:175], v13, s[4:7], s31 offen offset:3328
  buffer_load_dwordx4 v[176:179], v13, s[4:7], s31 offen offset:3584
  buffer_load_dwordx4 v[180:183], v13, s[4:7], s31 offen offset:3840
  buffer_load_dwordx4 v[184:187], v14, s[4:7], s40 offen offset:0
  buffer_load_dwordx4 v[188:191], v14, s[4:7], s40 offen offset:64
  buffer_load_dwordx4 v[192:195], v14, s[4:7], s40 offen offset:128
  buffer_load_dwordx4 v[196:199], v14, s[4:7], s40 offen offset:192
  buffer_load_dwordx4 v[200:203], v14, s[4:7], s40 offen offset:256
  s_waitcnt vmcnt(36)
  v_mfma_f32_16x16x32_bf16 v[204:207], a[0:3], v[56:59], 0
  v_mfma_f32_16x16x32_bf16 v[208:211], a[4:7], v[56:59], 0
  s_waitcnt vmcnt(35)
  v_mfma_f32_16x16x32_bf16 v[204:207], a[8:11], v[60:63], v[204:207]
  v_mfma_f32_16x16x32_bf16 v[208:211], a[12:15], v[60:63], v[208:211]
  s_waitcnt vmcnt(34)
  v_mfma_f32_16x16x32_bf16 v[204:207], a[16:19], v[64:67], v[204:207]
  v_mfma_f32_16x16x32_bf16 v[208:211], a[20:23], v[64:67], v[208:211]
  s_waitcnt vmcnt(33)
  v_mfma_f32_16x16x32_bf16 v[204:207], a[24:27], v[68:71], v[204:207]
  v_mfma_f32_16x16x32_bf16 v[208:211], a[28:31], v[68:71], v[208:211]
  s_waitcnt vmcnt(32)
  v_mfma_f32_16x16x32_bf16 v[204:207], a[32:35], v[72:75], v[204:207]
  v_mfma_f32_16x16x32_bf16 v[208:211], a[36:39], v[72:75], v[208:211]
  s_waitcnt vmcnt(31)
  v_mfma_f32_16x16x32_bf16 v[204:207], a[40:43], v[76:79], v[204:207]
  v_mfma_f32_16x16x32_bf16 v[208:211], a[44:47], v[76:79], v[208:211]
  s_waitcnt vmcnt(30)
  v_mfma_f32_16x16x32_bf16 v[204:207], a[48:51], v[80:83], v[204:207]
  v_mfma_f32_16x16x32_bf16 v[208:211], a[52:55], v[80:83], v[208:211]
  s_waitcnt vmcnt(29)
  v_mfma_f32_16x16x32_bf16 v[204:207], a[56:59], v[84:87], v[204:207]
  v_mfma_f32_16x16x32_bf16 v[208:211], a[60:63], v[84:87], v[208:211]
  s_waitcnt vmcnt(28)
  v_mfma_f32_16x16x32_bf16 v[204:207], a[64:67], v[88:91], v[204:207]
  v_mfma_f32_16x16x32_bf16 v[208:211], a[68:71], v[88:91], v[208:211]
  s_waitcnt vmcnt(27)
  v_mfma_f32_16x16x32_bf16 v[204:207], a[72:75], v[92:95], v[204:207]
  v_mfma_f32_16x16x32_bf16 v[208:211], a[76:79], v[92:95], v[208:211]
  s_waitcnt vmcnt(26)
  v_mfma_f32_16x16x32_bf16 v[204:207], a[80:83], v[96:99], v[204:207]
  v_mfma_f32_16x16x32_bf16 v[208:211], a[84:87], v[96:99], v[208:211]
  s_waitcnt vmcnt(25)
  v_mfma_f32_16x16x32_bf16 v[204:207], a[88:91], v[100:103], v[204:207]
  v_mfma_f32_16x16x32_bf16 v[208:211], a[92:95], v[100:103], v[208:211]
  s_waitcnt vmcnt(24)
  v_mfma_f32_16x16x32_bf16 v[204:207], a[96:99], v[104:107], v[204:207]
  v_mfma_f32_16x16x32_bf16 v[208:211], a[100:103], v[104:107], v[208:211]
  s_waitcnt vmcnt(23)
  v_mfma_f32_16x16x32_bf16 v[204:207], a[104:107], v[108:111], v[204:207]
  v_mfma_f32_16x16x32_bf16 v[208:211], a[108:111], v[108:111], v[208:211]
  s_waitcnt vmcnt(22)
  v_mfma_f32_16x16x32_bf16 v[204:207], a[112:115], v[112:115], v[204:207]
  v_mfma_f32_16x16x32_bf16 v[208:211], a[116:119], v[112:115], v[208:211]
  s_waitcnt vmcnt(21)
  v_mfma_f32_16x16x32_bf16 v[204:207], a[120:123], v[116:119], v[204:207]
  v_mfma_f32_16x16x32_bf16 v[208:211], a[124:127], v[116:119], v[208:211]
  s_waitcnt vmcnt(20)
  v_mfma_f32_16x16x32_bf16 v[204:207], a[128:131], v[120:123], v[204:207]
  v_mfma_f32_16x16x32_bf16 v[208:211], a[132:135], v[120:123], v[208:211]
  s_waitcnt vmcnt(19)
  v_mfma_f32_16x16x32_bf16 v[204:207], a[136:139], v[124:127], v[204:207]
  v_mfma_f32_16x16x32_bf16 v[208:211], a[140:143], v[124:127], v[208:211]
  s_waitcnt vmcnt(18)
  v_mfma_f32_16x16x32_bf16 v[204:207], a[144:147], v[128:131], v[204:207]
  v_mfma_f32_16x16x32_bf16 v[208:211], a[148:151], v[128:131], v[208:211]
  s_waitcnt vmcnt(17)
  v_mfma_f32_16x16x32_bf16 v[204:207], a[152:155], v[132:135], v[204:207]
  v_mfma_f32_16x16x32_bf16 v[208:211], a[156:159], v[132:135], v[208:211]
  s_waitcnt vmcnt(16)
  v_mfma_f32_16x16x32_bf16 v[204:207], a[160:163], v[136:139], v[204:207]
  v_mfma_f32_16x16x32_bf16 v[208:211], a[164:167], v[136:139], v[208:211]
  s_waitcnt vmcnt(15)
  v_mfma_f32_16x16x32_bf16 v[204:207], a[168:171], v[140:143], v[204:207]
  v_mfma_f32_16x16x32_bf16 v[208:211], a[172:175], v[140:143], v[208:211]
  s_waitcnt vmcnt(14)
  v_mfma_f32_16x16x32_bf16 v[204:207], a[176:179], v[144:147], v[204:207]
  v_mfma_f32_16x16x32_bf16 v[208:211], a[180:183], v[144:147], v[208:211]
  s_waitcnt vmcnt(13)
  v_mfma_f32_16x16x32_bf16 v[204:207], a[184:187], v[148:151], v[204:207]
  v_mfma_f32_16x16x32_bf16 v[208:211], a[188:191], v[148:151], v[208:211]
  s_waitcnt vmcnt(12)
  v_mfma_f32_16x16x32_bf16 v[204:207], a[192:195], v[152:155], v[204:207]
  v_mfma_f32_16x16x32_bf16 v[208:211], a[196:199], v[152:155], v[208:211]
  s_waitcnt vmcnt(11)
  v_mfma_f32_16x16x32_bf16 v[204:207], a[200:203], v[156:159], v[204:207]
  v_mfma_f32_16x16x32_bf16 v[208:211], a[204:207], v[156:159], v[208:211]
  s_waitcnt vmcnt(10)
  v_mfma_f32_16x16x32_bf16 v[204:207], a[208:211], v[160:163], v[204:207]
  v_mfma_f32_16x16x32_bf16 v[208:211], a[212:215], v[160:163], v[208:211]
  s_waitcnt vmcnt(9)
  v_mfma_f32_16x16x32_bf16 v[204:207], a[216:219], v[164:167], v[204:207]
  v_mfma_f32_16x16x32_bf16 v[208:211], a[220:223], v[164:167], v[208:211]
  s_waitcnt vmcnt(8)
  v_mfma_f32_16x16x32_bf16 v[204:207], a[224:227], v[168:171], v[204:207]
  v_mfma_f32_16x16x32_bf16 v[208:211], a[228:231], v[168:171], v[208:211]
  s_waitcnt vmcnt(7)
  v_mfma_f32_16x16x32_bf16 v[204:207], a[232:235], v[172:175], v[204:207]
  v_mfma_f32_16x16x32_bf16 v[208:211], a[236:239], v[172:175], v[208:211]
  s_waitcnt vmcnt(6)
  v_mfma_f32_16x16x32_bf16 v[204:207], a[240:243], v[176:179], v[204:207]
  v_mfma_f32_16x16x32_bf16 v[208:211], a[244:247], v[176:179], v[208:211]
  s_waitcnt vmcnt(5)
  v_mfma_f32_16x16x32_bf16 v[204:207], a[248:251], v[180:183], v[204:207]
  v_mfma_f32_16x16x32_bf16 v[208:211], a[252:255], v[180:183], v[208:211]
  s_waitcnt vmcnt(4)
  v_mfma_f32_16x16x32_bf16 v[204:207], v[16:19], v[184:187], v[204:207]
  v_mfma_f32_16x16x32_bf16 v[208:211], v[20:23], v[184:187], v[208:211]
  s_waitcnt vmcnt(3)
  v_mfma_f32_16x16x32_bf16 v[204:207], v[24:27], v[188:191], v[204:207]
  v_mfma_f32_16x16x32_bf16 v[208:211], v[28:31], v[188:191], v[208:211]
  s_waitcnt vmcnt(2)
  v_mfma_f32_16x16x32_bf16 v[204:207], v[32:35], v[192:195], v[204:207]
  v_mfma_f32_16x16x32_bf16 v[208:211], v[36:39], v[192:195], v[208:211]
  s_waitcnt vmcnt(1)
  v_mfma_f32_16x16x32_bf16 v[204:207], v[40:43], v[196:199], v[204:207]
  v_mfma_f32_16x16x32_bf16 v[208:211], v[44:47], v[196:199], v[208:211]
  s_waitcnt vmcnt(0)
  v_mfma_f32_16x16x32_bf16 v[204:207], v[48:51], v[200:203], v[204:207]
  v_mfma_f32_16x16x32_bf16 v[208:211], v[52:55], v[200:203], v[208:211]
  s_lshl_b32 s31, s38, 18
  s_add_u32 s39, s39, s31
  s_mul_i32 s31, s38, 40960
  s_add_u32 s40, s40, s31
  s_add_u32 s37, s37, s38
  ds_write_b128 v5, v[204:207]
  s_nop 1
  ds_write_b128 v5, v[208:211] offset:1024
  s_waitcnt lgkmcnt(0)
  s_barrier
  s_cmp_lg_u32 s28, 1
  s_cbranch_scc1 L_t2N
  ds_read_b128 v[212:215], v1 offset:0
  ds_read_b128 v[216:219], v1 offset:1024
  ds_read_b128 v[220:223], v1 offset:2048
  ds_read_b128 v[224:227], v1 offset:3072
  ds_read_b128 v[228:231], v1 offset:4096
  ds_read_b128 v[232:235], v1 offset:5120
  ds_read_b128 v[236:239], v1 offset:6144
  ds_read_b128 v[240:243], v1 offset:7168
  s_waitcnt lgkmcnt(0)
  v_add_f32 v212, v212, v220
  v_add_f32 v213, v213, v221
  v_add_f32 v214, v214, v222
  v_add_f32 v215, v215, v223
  v_add_f32 v216, v216, v224
  v_add_f32 v217, v217, v225
  v_add_f32 v218, v218, v226
  v_add_f32 v219, v219, v227
  v_add_f32 v212, v212, v228
  v_add_f32 v213, v213, v229
  v_add_f32 v214, v214, v230
  v_add_f32 v215, v215, v231
  v_add_f32 v216, v216, v232
  v_add_f32 v217, v217, v233
  v_add_f32 v218, v218, v234
  v_add_f32 v219, v219, v235
  v_add_f32 v212, v212, v236
  v_add_f32 v213, v213, v237
  v_add_f32 v214, v214, v238
  v_add_f32 v215, v215, v239
  v_add_f32 v216, v216, v240
  v_add_f32 v217, v217, v241
  v_add_f32 v218, v218, v242
  v_add_f32 v219, v219, v243
  v_cvt_pk_bf16_f32 v212, v212, v213
  v_cvt_pk_bf16_f32 v213, v214, v215
  v_cvt_pk_bf16_f32 v214, v216, v217
  v_cvt_pk_bf16_f32 v215, v218, v219
  buffer_store_dwordx4 v[212:215], v14, s[24:27], s32 offen
  s_add_u32 s32, s32, s31
L_t2N:
  s_cmp_lt_u32 s37, 64
  s_cbranch_scc1 L_t2L
L_exit:
  s_endpgm
.section .rodata,"a"
.p2align 6
.amdhsa_kernel gated_mix__grouped_kv_mqa__memory_aug_recurrent_mem_tr__prompt_kernel
  .amdhsa_next_free_vgpr 512
  .amdhsa_next_free_sgpr 102
  .amdhsa_accum_offset 256
  .amdhsa_group_segment_fixed_size 0
  .amdhsa_kernarg_size 128
  .amdhsa_user_sgpr_count 2
  .amdhsa_user_sgpr_kernarg_segment_ptr 1
  .amdhsa_system_sgpr_workgroup_id_x 1
.end_amdhsa_kernel
```
